```python
import torch

def _softmax(x, axis=-1):
    return torch.softmax(x, dim=axis)
def _gelu(x):
    return torch.nn.functional.gelu(x, approximate="tanh")
def _silu(x):
    return torch.nn.functional.silu(x)
def _sigmoid(x):
    return torch.sigmoid(x)
def _layernorm(x, axis=-1, eps=1e-5):
    m = x.mean(dim=axis, keepdim=True)
    v = x.var(dim=axis, keepdim=True, unbiased=False)
    return (x - m) / torch.sqrt(v + eps)
def _scatter_add(tgt, idx, src, axis=0):
    return tgt.clone().index_add_(axis, idx, src)
def _segment_sum(src, seg, n):
    out = torch.zeros((n,) + src.shape[1:], dtype=src.dtype)
    return out.index_add_(0, seg, src)
def _pad(x, pw):
    flat = tuple(v for pair in reversed(pw) for v in pair)
    return torch.nn.functional.pad(x, flat)

kernel_name = 'interleave_layers__spectral_gfnet__softmax_full_mha__prompt'

def setup_inputs():

    _w = (lambda a: (lambda t: t.to(torch.bfloat16) if t.is_floating_point() else t)(torch.as_tensor(a)))
    def _A_setup():
        B, S, D = 1, 2048, 512
        Df = D // 2 + 1
        return {
            "x": _w((lambda *s: torch.randn(*s, dtype=torch.bfloat16) * 0.05)(B, S, D)),
            "w_r": _w((lambda *s: torch.randn(*s, dtype=torch.bfloat16) * 0.8)(S, Df) * 0.02),
            "w_i": _w((lambda *s: torch.randn(*s, dtype=torch.bfloat16) * 0.8)(S, Df) * 0.02),
        }
    _A_in = _A_setup()

    def _B_setup():
        B, S, D = 1, 2048, 512
        return {
            "x": _w((lambda *s: torch.randn(*s, dtype=torch.bfloat16) * 0.05)(B, S, D)),
            "wqkv": _w((lambda *s: torch.randn(*s, dtype=torch.bfloat16) * 0.05)(D, 3 * D)),
            "wo": _w((lambda *s: torch.randn(*s, dtype=torch.bfloat16) * 0.05)(D, D)),
        }
    _B_in = _B_setup()

    return {
        "A_x": _A_in["x"],
        "A_w_r": _A_in["w_r"],
        "A_w_i": _A_in["w_i"],
        "B_x": _B_in["x"],
        "B_wqkv": _B_in["wqkv"],
        "B_wo": _B_in["wo"],
    }

def reference(A_x, A_w_r, A_w_i, B_x, B_wqkv, B_wo):
    def _A_ref(x, w_r, w_i):
        B, S, D = x.shape
        X = (lambda x, axes=(-2,-1): torch.fft.rfft2(x.float(), dim=axes))(x, axes=(-2, -1))
        W = w_r + 1j * w_i
        X = X * W
        y = (lambda x, s, axes=(-2,-1): torch.fft.irfft2(x, s=s, dim=axes).to(torch.bfloat16))(X, (S, D), axes=(-2, -1))
        return y

    def _B_ref(x, wqkv, wo):
        B, S, D = x.shape
        H = 32; Dh = D // H
        qkv = (lambda x, *d: x.permute(*d))((x @ wqkv).reshape(B, S, 3, H, Dh), 2, 0, 3, 1, 4)
        q, k, v = qkv[0], qkv[1], qkv[2]
        scale = Dh ** -0.5
        scores = torch.einsum("bhqd,bhkd->bhqk", q, k) * scale
        p = _softmax(scores, axis=-1)
        o = torch.einsum("bhqk,bhkd->bhqd", p, v)
        return (lambda x, *d: x.permute(*d))(o, 0, 2, 1, 3).reshape(B, S, D) @ wo

    x = A_x
    x = x + _A_ref(_layernorm(x, axis=-1), A_w_r, A_w_i)
    x = x + _B_ref(_layernorm(x, axis=-1), B_wqkv, B_wo)
    x = x + _A_ref(_layernorm(x, axis=-1), A_w_r, A_w_i)
    x = x + _B_ref(_layernorm(x, axis=-1), B_wqkv, B_wo)
    return x
```

```asm
; @launch kernel=prep_kernel grid=(256,1,1) block=(512,1,1) lds=157696
; @launch kernel=mha1_kernel grid=(256,1,1) block=(512,1,1) lds=160768
; @launch kernel=mha2_kernel grid=(256,1,1) block=(512,1,1) lds=160768
.amdgcn_target "amdgcn-amd-amdhsa--gfx950"
.text
.globl prep_kernel
.p2align 8
.type prep_kernel,@function
prep_kernel:
    s_cmp_ge_u32 s2, 256
    s_cbranch_scc1 L_prep_end
    s_load_dwordx4 s[72:75], s[0:1], 0
    s_load_dwordx2 s[76:77], s[0:1], 16
    s_load_dwordx4 s[12:15], s[0:1], 32
    s_load_dwordx2 s[8:9], s[0:1], 64
    s_mov_b32 s10, 0x1c00000
    s_mov_b32 s11, 0x00020000
    s_getpc_b64 s[16:17]
    v_lshlrev_b32 v4, 6, v0
    v_cmp_gt_u32 vcc, code_begin-prep_kernel-256, v4
    v_mov_b32 v243, s17
    s_and_saveexec_b64 s[18:19], vcc
    s_cbranch_execz L_prep_nw
    v_add_co_u32 v242, vcc, s16, v4
    s_nop 1
    v_addc_co_u32 v243, vcc, 0, v243, vcc
    global_load_dword v240, v[242:243], off
L_prep_nw:
    s_mov_b64 exec, -1
    v_lshrrev_b32 v4, 6, v0
    v_and_b32 v1, 63, v0
    v_readfirstlane_b32 s3, v4
    v_and_b32 v2, 31, v0
    v_lshrrev_b32 v3, 5, v1
    v_lshlrev_b32 v9, 4, v1
    s_and_b32 s40, s2, 7
    s_lshr_b32 s41, s2, 3
    s_and_b32 s42, s41, 7
    s_lshl_b32 s43, s40, 2
    s_lshr_b32 s48, s41, 3
    s_add_u32 s43, s43, s48
    s_lshl_b32 s48, s48, 1
    s_add_u32 s51, s42, s48
    s_mov_b32 s23, 0x00020000
    s_cmp_lt_u32 s3, 4
    s_cbranch_scc1 L_prep_comp
L_prep_help:
    s_cmp_ge_u32 s3, 6
    s_cbranch_scc1 L_prep_h67
    v_lshrrev_b32 v4, 3, v1
    v_lshrrev_b32 v7, 4, v1
    v_xor_b32 v7, v7, v1
    v_and_b32 v7, 7, v7
    v_lshlrev_b32 v7, 4, v7
    v_lshl_add_u32 v12, v4, 10, v7
    v_xor_b32 v13, 64, v12
    v_add_u32 v13, 8192, v13
    s_movk_i32 s54, 128
    s_mov_b32 s52, 0
    s_cmp_eq_u32 s3, 5
    s_cbranch_scc1 L_prep_w
    v_lshl_add_u32 v12, v4, 16, v7
    v_xor_b32 v13, 64, v12
    v_add_u32 v13, 1024, v13
    s_bfe_u32 s40, s43, 0x20001
    s_lshl_b32 s40, s40, 19
    s_lshr_b32 s41, s43, 3
    s_lshl_b32 s41, s41, 14
    s_add_u32 s50, s40, s41
    s_and_b32 s41, s43, 1
    s_lshl_b32 s41, s41, 13
    s_add_u32 s50, s50, s41
    s_movk_i32 s55, 2048
    s_movk_i32 s59, 4096
    s_mov_b32 s22, 0x200000
    s_waitcnt lgkmcnt(0)
    s_mov_b64 s[20:21], s[72:73]
    s_branch L_prep_go
L_prep_w:
    s_movk_i32 s52, 8192
    s_cmp_lt_u32 s43, 24
    s_cbranch_scc1 L_prep_q
    s_sub_u32 s50, s43, 24
    s_lshl_b32 s50, s50, 16
    s_movk_i32 s55, 16384
    s_mov_b32 s59, 32768
    s_mov_b32 s22, 0x80000
    s_waitcnt lgkmcnt(0)
    s_mov_b64 s[20:21], s[14:15]
    s_branch L_prep_go
L_prep_q:
    s_movk_i32 s40, 3072
    v_mul_lo_u32 v12, v4, s40
    v_lshrrev_b32 v7, 2, v1
    v_and_b32 v7, 4, v7
    v_xor_b32 v7, v7, v1
    v_and_b32 v7, 7, v7
    v_lshl_add_u32 v12, v7, 4, v12
    v_add_u32 v13, 24576, v12
    s_lshl_b32 s50, s43, 7
    s_mov_b32 s54, 196608
    s_mov_b32 s55, 49152
    s_mov_b32 s59, 98304
    s_mov_b32 s22, 0x180000
    s_waitcnt lgkmcnt(0)
    s_mov_b64 s[20:21], s[12:13]
L_prep_go:
    s_setprio 3
    s_mov_b32 s56, 0
L_prep_ll:
    s_add_u32 s53, s51, s56
    s_and_b32 s53, s53, 7
    s_mul_i32 s53, s53, s54
    s_add_u32 s60, s53, s50
    s_add_u32 s61, s60, s55
    s_add_u32 s62, s60, s59
    s_add_u32 s63, s61, s59
    s_add_u32 m0, s52, 0
    s_nop 0
    buffer_load_dwordx4 v12, s[20:23], s60 offen lds
    s_add_u32 m0, s52, 1024
    s_nop 0
    buffer_load_dwordx4 v13, s[20:23], s60 offen lds
    s_add_u32 m0, s52, 2048
    s_nop 0
    buffer_load_dwordx4 v12, s[20:23], s61 offen lds
    s_add_u32 m0, s52, 3072
    s_nop 0
    buffer_load_dwordx4 v13, s[20:23], s61 offen lds
    s_add_u32 m0, s52, 4096
    s_nop 0
    buffer_load_dwordx4 v12, s[20:23], s62 offen lds
    s_add_u32 m0, s52, 5120
    s_nop 0
    buffer_load_dwordx4 v13, s[20:23], s62 offen lds
    s_add_u32 m0, s52, 6144
    s_nop 0
    buffer_load_dwordx4 v12, s[20:23], s63 offen lds
    s_add_u32 m0, s52, 7168
    s_nop 0
    buffer_load_dwordx4 v13, s[20:23], s63 offen lds
    s_add_u32 s52, s52, 16384
    s_add_u32 s56, s56, 1
    s_cmp_lt_u32 s56, 3
    s_cbranch_scc1 L_prep_ll
    s_waitcnt vmcnt(16)
    s_barrier
    s_cmp_lt_u32 s56, 8
    s_cbranch_scc1 L_prep_ll
    s_waitcnt vmcnt(8)
    s_barrier
    s_waitcnt vmcnt(0)
    s_barrier
    s_endpgm
L_prep_comp:
    s_lshr_b32 s57, s3, 1
    s_and_b32 s58, s3, 1
    s_lshl_b32 s44, s42, 1
    s_add_u32 s44, s44, s57
    s_lshl_b32 s46, s43, 1
    s_add_u32 s46, s46, s58
    s_lshl_b32 s50, s44, 15
    v_and_b32 v4, 0x13, v1
    v_and_b32 v5, 4, v1
    v_lshl_or_b32 v4, v5, 1, v4
    v_bfe_u32 v5, v1, 3, 1
    v_lshl_or_b32 v4, v5, 2, v4
    s_lshl_b32 s40, s44, 5
    v_add_u32 v4, s40, v4
    v_lshrrev_b32 v5, 1, v4
    v_and_b32 v6, 1, v4
    v_lshlrev_b32 v6, 7, v6
    v_mov_b32 v7, 256
    v_cmp_eq_u32 vcc, 0, v4
    s_nop 1
    v_cndmask_b32 v5, v5, v7, vcc
    v_mov_b32 v7, 64
    v_cmp_gt_u32 vcc, 2, v4
    s_nop 1
    v_cndmask_b32 v6, v6, v7, vcc
    v_lshlrev_b32 v7, 3, v3
    v_mad_u32_u24 v6, v5, v7, v6
    v_cvt_f32_u32 v7, v5
    v_mul_f32 v7, 0x3b000000, v7
    v_lshlrev_b32 v11, 31, v5
    v_ashrrev_i32 v11, 31, v11
    v_and_b32 v12, v5, v4
    v_lshrrev_b32 v13, 1, v5
    v_xor_b32 v12, v12, v13
    v_lshlrev_b32 v12, 31, v12
    v_ashrrev_i32 v12, 31, v12
    v_and_b32 v11, 0x80008000, v11
    v_and_b32 v12, 0x80008000, v12
    v_xor_b32 v13, v11, v12
    s_add_u32 s53, s51, 0
    s_lshl_b32 s53, s53, 6
    v_mad_u32_u24 v10, v5, s53, v6
    v_and_b32 v10, 511, v10
    v_cvt_f32_u32 v10, v10
    v_mul_f32 v48, 0x3b000000, v10
    v_fmamk_f32 v49, v7, 0x3f800000, v48
    v_fmamk_f32 v50, v7, 0x40000000, v48
    v_fmamk_f32 v51, v7, 0x40400000, v48
    v_fmamk_f32 v52, v7, 0x40800000, v48
    v_fmamk_f32 v53, v7, 0x40a00000, v48
    v_fmamk_f32 v54, v7, 0x40c00000, v48
    v_fmamk_f32 v55, v7, 0x40e00000, v48
    v_cos_f32 v48, v48
    v_cos_f32 v49, v49
    v_cos_f32 v50, v50
    v_cos_f32 v51, v51
    v_cos_f32 v52, v52
    v_cos_f32 v53, v53
    v_cos_f32 v54, v54
    v_cos_f32 v55, v55
    v_cvt_pk_bf16_f32 v112, v48, v49
    v_cvt_pk_bf16_f32 v113, v50, v51
    v_cvt_pk_bf16_f32 v114, v52, v53
    v_cvt_pk_bf16_f32 v115, v54, v55
    v_xor_b32 v176, v11, v112
    v_xor_b32 v177, v11, v113
    v_xor_b32 v178, v11, v114
    v_xor_b32 v179, v11, v115
    v_xor_b32_dpp v144, v112, v12 quad_perm:[0,1,3,2] row_mask:0xf bank_mask:0xf
    v_xor_b32_dpp v145, v113, v12 quad_perm:[0,1,3,2] row_mask:0xf bank_mask:0xf
    v_xor_b32_dpp v146, v114, v12 quad_perm:[0,1,3,2] row_mask:0xf bank_mask:0xf
    v_xor_b32_dpp v147, v115, v12 quad_perm:[0,1,3,2] row_mask:0xf bank_mask:0xf
    v_xor_b32_dpp v208, v112, v13 quad_perm:[0,1,3,2] row_mask:0xf bank_mask:0xf
    v_xor_b32_dpp v209, v113, v13 quad_perm:[0,1,3,2] row_mask:0xf bank_mask:0xf
    v_xor_b32_dpp v210, v114, v13 quad_perm:[0,1,3,2] row_mask:0xf bank_mask:0xf
    v_xor_b32_dpp v211, v115, v13 quad_perm:[0,1,3,2] row_mask:0xf bank_mask:0xf
    s_add_u32 s53, s53, 16
    v_mad_u32_u24 v10, v5, s53, v6
    v_and_b32 v10, 511, v10
    v_cvt_f32_u32 v10, v10
    v_mul_f32 v48, 0x3b000000, v10
    v_fmamk_f32 v49, v7, 0x3f800000, v48
    v_fmamk_f32 v50, v7, 0x40000000, v48
    v_fmamk_f32 v51, v7, 0x40400000, v48
    v_fmamk_f32 v52, v7, 0x40800000, v48
    v_fmamk_f32 v53, v7, 0x40a00000, v48
    v_fmamk_f32 v54, v7, 0x40c00000, v48
    v_fmamk_f32 v55, v7, 0x40e00000, v48
    v_cos_f32 v48, v48
    v_cos_f32 v49, v49
    v_cos_f32 v50, v50
    v_cos_f32 v51, v51
    v_cos_f32 v52, v52
    v_cos_f32 v53, v53
    v_cos_f32 v54, v54
    v_cos_f32 v55, v55
    v_cvt_pk_bf16_f32 v116, v48, v49
    v_cvt_pk_bf16_f32 v117, v50, v51
    v_cvt_pk_bf16_f32 v118, v52, v53
    v_cvt_pk_bf16_f32 v119, v54, v55
    v_xor_b32 v180, v11, v116
    v_xor_b32 v181, v11, v117
    v_xor_b32 v182, v11, v118
    v_xor_b32 v183, v11, v119
    v_xor_b32_dpp v148, v116, v12 quad_perm:[0,1,3,2] row_mask:0xf bank_mask:0xf
    v_xor_b32_dpp v149, v117, v12 quad_perm:[0,1,3,2] row_mask:0xf bank_mask:0xf
    v_xor_b32_dpp v150, v118, v12 quad_perm:[0,1,3,2] row_mask:0xf bank_mask:0xf
    v_xor_b32_dpp v151, v119, v12 quad_perm:[0,1,3,2] row_mask:0xf bank_mask:0xf
    v_xor_b32_dpp v212, v116, v13 quad_perm:[0,1,3,2] row_mask:0xf bank_mask:0xf
    v_xor_b32_dpp v213, v117, v13 quad_perm:[0,1,3,2] row_mask:0xf bank_mask:0xf
    v_xor_b32_dpp v214, v118, v13 quad_perm:[0,1,3,2] row_mask:0xf bank_mask:0xf
    v_xor_b32_dpp v215, v119, v13 quad_perm:[0,1,3,2] row_mask:0xf bank_mask:0xf
    s_add_u32 s53, s53, 16
    v_mad_u32_u24 v10, v5, s53, v6
    v_and_b32 v10, 511, v10
    v_cvt_f32_u32 v10, v10
    v_mul_f32 v48, 0x3b000000, v10
    v_fmamk_f32 v49, v7, 0x3f800000, v48
    v_fmamk_f32 v50, v7, 0x40000000, v48
    v_fmamk_f32 v51, v7, 0x40400000, v48
    v_fmamk_f32 v52, v7, 0x40800000, v48
    v_fmamk_f32 v53, v7, 0x40a00000, v48
    v_fmamk_f32 v54, v7, 0x40c00000, v48
    v_fmamk_f32 v55, v7, 0x40e00000, v48
    v_cos_f32 v48, v48
    v_cos_f32 v49, v49
    v_cos_f32 v50, v50
    v_cos_f32 v51, v51
    v_cos_f32 v52, v52
    v_cos_f32 v53, v53
    v_cos_f32 v54, v54
    v_cos_f32 v55, v55
    v_cvt_pk_bf16_f32 v120, v48, v49
    v_cvt_pk_bf16_f32 v121, v50, v51
    v_cvt_pk_bf16_f32 v122, v52, v53
    v_cvt_pk_bf16_f32 v123, v54, v55
    v_xor_b32 v184, v11, v120
    v_xor_b32 v185, v11, v121
    v_xor_b32 v186, v11, v122
    v_xor_b32 v187, v11, v123
    v_xor_b32_dpp v152, v120, v12 quad_perm:[0,1,3,2] row_mask:0xf bank_mask:0xf
    v_xor_b32_dpp v153, v121, v12 quad_perm:[0,1,3,2] row_mask:0xf bank_mask:0xf
    v_xor_b32_dpp v154, v122, v12 quad_perm:[0,1,3,2] row_mask:0xf bank_mask:0xf
    v_xor_b32_dpp v155, v123, v12 quad_perm:[0,1,3,2] row_mask:0xf bank_mask:0xf
    v_xor_b32_dpp v216, v120, v13 quad_perm:[0,1,3,2] row_mask:0xf bank_mask:0xf
    v_xor_b32_dpp v217, v121, v13 quad_perm:[0,1,3,2] row_mask:0xf bank_mask:0xf
    v_xor_b32_dpp v218, v122, v13 quad_perm:[0,1,3,2] row_mask:0xf bank_mask:0xf
    v_xor_b32_dpp v219, v123, v13 quad_perm:[0,1,3,2] row_mask:0xf bank_mask:0xf
    s_add_u32 s53, s53, 16
    v_mad_u32_u24 v10, v5, s53, v6
    v_and_b32 v10, 511, v10
    v_cvt_f32_u32 v10, v10
    v_mul_f32 v48, 0x3b000000, v10
    v_fmamk_f32 v49, v7, 0x3f800000, v48
    v_fmamk_f32 v50, v7, 0x40000000, v48
    v_fmamk_f32 v51, v7, 0x40400000, v48
    v_fmamk_f32 v52, v7, 0x40800000, v48
    v_fmamk_f32 v53, v7, 0x40a00000, v48
    v_fmamk_f32 v54, v7, 0x40c00000, v48
    v_fmamk_f32 v55, v7, 0x40e00000, v48
    v_cos_f32 v48, v48
    v_cos_f32 v49, v49
    v_cos_f32 v50, v50
    v_cos_f32 v51, v51
    v_cos_f32 v52, v52
    v_cos_f32 v53, v53
    v_cos_f32 v54, v54
    v_cos_f32 v55, v55
    v_cvt_pk_bf16_f32 v124, v48, v49
    v_cvt_pk_bf16_f32 v125, v50, v51
    v_cvt_pk_bf16_f32 v126, v52, v53
    v_cvt_pk_bf16_f32 v127, v54, v55
    v_xor_b32 v188, v11, v124
    v_xor_b32 v189, v11, v125
    v_xor_b32 v190, v11, v126
    v_xor_b32 v191, v11, v127
    v_xor_b32_dpp v156, v124, v12 quad_perm:[0,1,3,2] row_mask:0xf bank_mask:0xf
    v_xor_b32_dpp v157, v125, v12 quad_perm:[0,1,3,2] row_mask:0xf bank_mask:0xf
    v_xor_b32_dpp v158, v126, v12 quad_perm:[0,1,3,2] row_mask:0xf bank_mask:0xf
    v_xor_b32_dpp v159, v127, v12 quad_perm:[0,1,3,2] row_mask:0xf bank_mask:0xf
    v_xor_b32_dpp v220, v124, v13 quad_perm:[0,1,3,2] row_mask:0xf bank_mask:0xf
    v_xor_b32_dpp v221, v125, v13 quad_perm:[0,1,3,2] row_mask:0xf bank_mask:0xf
    v_xor_b32_dpp v222, v126, v13 quad_perm:[0,1,3,2] row_mask:0xf bank_mask:0xf
    v_xor_b32_dpp v223, v127, v13 quad_perm:[0,1,3,2] row_mask:0xf bank_mask:0xf
    s_add_u32 s53, s51, 1
    s_lshl_b32 s53, s53, 6
    v_mad_u32_u24 v10, v5, s53, v6
    v_and_b32 v10, 511, v10
    v_cvt_f32_u32 v10, v10
    v_mul_f32 v48, 0x3b000000, v10
    v_fmamk_f32 v49, v7, 0x3f800000, v48
    v_fmamk_f32 v50, v7, 0x40000000, v48
    v_fmamk_f32 v51, v7, 0x40400000, v48
    v_fmamk_f32 v52, v7, 0x40800000, v48
    v_fmamk_f32 v53, v7, 0x40a00000, v48
    v_fmamk_f32 v54, v7, 0x40c00000, v48
    v_fmamk_f32 v55, v7, 0x40e00000, v48
    v_cos_f32 v48, v48
    v_cos_f32 v49, v49
    v_cos_f32 v50, v50
    v_cos_f32 v51, v51
    v_cos_f32 v52, v52
    v_cos_f32 v53, v53
    v_cos_f32 v54, v54
    v_cos_f32 v55, v55
    v_cvt_pk_bf16_f32 v128, v48, v49
    v_cvt_pk_bf16_f32 v129, v50, v51
    v_cvt_pk_bf16_f32 v130, v52, v53
    v_cvt_pk_bf16_f32 v131, v54, v55
    v_xor_b32 v192, v11, v128
    v_xor_b32 v193, v11, v129
    v_xor_b32 v194, v11, v130
    v_xor_b32 v195, v11, v131
    v_xor_b32_dpp v160, v128, v12 quad_perm:[0,1,3,2] row_mask:0xf bank_mask:0xf
    v_xor_b32_dpp v161, v129, v12 quad_perm:[0,1,3,2] row_mask:0xf bank_mask:0xf
    v_xor_b32_dpp v162, v130, v12 quad_perm:[0,1,3,2] row_mask:0xf bank_mask:0xf
    v_xor_b32_dpp v163, v131, v12 quad_perm:[0,1,3,2] row_mask:0xf bank_mask:0xf
    v_xor_b32_dpp v224, v128, v13 quad_perm:[0,1,3,2] row_mask:0xf bank_mask:0xf
    v_xor_b32_dpp v225, v129, v13 quad_perm:[0,1,3,2] row_mask:0xf bank_mask:0xf
    v_xor_b32_dpp v226, v130, v13 quad_perm:[0,1,3,2] row_mask:0xf bank_mask:0xf
    v_xor_b32_dpp v227, v131, v13 quad_perm:[0,1,3,2] row_mask:0xf bank_mask:0xf
    s_add_u32 s53, s53, 16
    v_mad_u32_u24 v10, v5, s53, v6
    v_and_b32 v10, 511, v10
    v_cvt_f32_u32 v10, v10
    v_mul_f32 v48, 0x3b000000, v10
    v_fmamk_f32 v49, v7, 0x3f800000, v48
    v_fmamk_f32 v50, v7, 0x40000000, v48
    v_fmamk_f32 v51, v7, 0x40400000, v48
    v_fmamk_f32 v52, v7, 0x40800000, v48
    v_fmamk_f32 v53, v7, 0x40a00000, v48
    v_fmamk_f32 v54, v7, 0x40c00000, v48
    v_fmamk_f32 v55, v7, 0x40e00000, v48
    v_cos_f32 v48, v48
    v_cos_f32 v49, v49
    v_cos_f32 v50, v50
    v_cos_f32 v51, v51
    v_cos_f32 v52, v52
    v_cos_f32 v53, v53
    v_cos_f32 v54, v54
    v_cos_f32 v55, v55
    v_cvt_pk_bf16_f32 v132, v48, v49
    v_cvt_pk_bf16_f32 v133, v50, v51
    v_cvt_pk_bf16_f32 v134, v52, v53
    v_cvt_pk_bf16_f32 v135, v54, v55
    v_xor_b32 v196, v11, v132
    v_xor_b32 v197, v11, v133
    v_xor_b32 v198, v11, v134
    v_xor_b32 v199, v11, v135
    v_xor_b32_dpp v164, v132, v12 quad_perm:[0,1,3,2] row_mask:0xf bank_mask:0xf
    v_xor_b32_dpp v165, v133, v12 quad_perm:[0,1,3,2] row_mask:0xf bank_mask:0xf
    v_xor_b32_dpp v166, v134, v12 quad_perm:[0,1,3,2] row_mask:0xf bank_mask:0xf
    v_xor_b32_dpp v167, v135, v12 quad_perm:[0,1,3,2] row_mask:0xf bank_mask:0xf
    v_xor_b32_dpp v228, v132, v13 quad_perm:[0,1,3,2] row_mask:0xf bank_mask:0xf
    v_xor_b32_dpp v229, v133, v13 quad_perm:[0,1,3,2] row_mask:0xf bank_mask:0xf
    v_xor_b32_dpp v230, v134, v13 quad_perm:[0,1,3,2] row_mask:0xf bank_mask:0xf
    v_xor_b32_dpp v231, v135, v13 quad_perm:[0,1,3,2] row_mask:0xf bank_mask:0xf
    s_add_u32 s53, s53, 16
    v_mad_u32_u24 v10, v5, s53, v6
    v_and_b32 v10, 511, v10
    v_cvt_f32_u32 v10, v10
    v_mul_f32 v48, 0x3b000000, v10
    v_fmamk_f32 v49, v7, 0x3f800000, v48
    v_fmamk_f32 v50, v7, 0x40000000, v48
    v_fmamk_f32 v51, v7, 0x40400000, v48
    v_fmamk_f32 v52, v7, 0x40800000, v48
    v_fmamk_f32 v53, v7, 0x40a00000, v48
    v_fmamk_f32 v54, v7, 0x40c00000, v48
    v_fmamk_f32 v55, v7, 0x40e00000, v48
    v_cos_f32 v48, v48
    v_cos_f32 v49, v49
    v_cos_f32 v50, v50
    v_cos_f32 v51, v51
    v_cos_f32 v52, v52
    v_cos_f32 v53, v53
    v_cos_f32 v54, v54
    v_cos_f32 v55, v55
    v_cvt_pk_bf16_f32 v136, v48, v49
    v_cvt_pk_bf16_f32 v137, v50, v51
    v_cvt_pk_bf16_f32 v138, v52, v53
    v_cvt_pk_bf16_f32 v139, v54, v55
    v_xor_b32 v200, v11, v136
    v_xor_b32 v201, v11, v137
    v_xor_b32 v202, v11, v138
    v_xor_b32 v203, v11, v139
    v_xor_b32_dpp v168, v136, v12 quad_perm:[0,1,3,2] row_mask:0xf bank_mask:0xf
    v_xor_b32_dpp v169, v137, v12 quad_perm:[0,1,3,2] row_mask:0xf bank_mask:0xf
    v_xor_b32_dpp v170, v138, v12 quad_perm:[0,1,3,2] row_mask:0xf bank_mask:0xf
    v_xor_b32_dpp v171, v139, v12 quad_perm:[0,1,3,2] row_mask:0xf bank_mask:0xf
    v_xor_b32_dpp v232, v136, v13 quad_perm:[0,1,3,2] row_mask:0xf bank_mask:0xf
    v_xor_b32_dpp v233, v137, v13 quad_perm:[0,1,3,2] row_mask:0xf bank_mask:0xf
    v_xor_b32_dpp v234, v138, v13 quad_perm:[0,1,3,2] row_mask:0xf bank_mask:0xf
    v_xor_b32_dpp v235, v139, v13 quad_perm:[0,1,3,2] row_mask:0xf bank_mask:0xf
    s_add_u32 s53, s53, 16
    v_mad_u32_u24 v10, v5, s53, v6
    v_and_b32 v10, 511, v10
    v_cvt_f32_u32 v10, v10
    v_mul_f32 v48, 0x3b000000, v10
    v_fmamk_f32 v49, v7, 0x3f800000, v48
    v_fmamk_f32 v50, v7, 0x40000000, v48
    v_fmamk_f32 v51, v7, 0x40400000, v48
    v_fmamk_f32 v52, v7, 0x40800000, v48
    v_fmamk_f32 v53, v7, 0x40a00000, v48
    v_fmamk_f32 v54, v7, 0x40c00000, v48
    v_fmamk_f32 v55, v7, 0x40e00000, v48
    v_cos_f32 v48, v48
    v_cos_f32 v49, v49
    v_cos_f32 v50, v50
    v_cos_f32 v51, v51
    v_cos_f32 v52, v52
    v_cos_f32 v53, v53
    v_cos_f32 v54, v54
    v_cos_f32 v55, v55
    v_cvt_pk_bf16_f32 v140, v48, v49
    v_cvt_pk_bf16_f32 v141, v50, v51
    v_cvt_pk_bf16_f32 v142, v52, v53
    v_cvt_pk_bf16_f32 v143, v54, v55
    v_xor_b32 v204, v11, v140
    v_xor_b32 v205, v11, v141
    v_xor_b32 v206, v11, v142
    v_xor_b32 v207, v11, v143
    v_xor_b32_dpp v172, v140, v12 quad_perm:[0,1,3,2] row_mask:0xf bank_mask:0xf
    v_xor_b32_dpp v173, v141, v12 quad_perm:[0,1,3,2] row_mask:0xf bank_mask:0xf
    v_xor_b32_dpp v174, v142, v12 quad_perm:[0,1,3,2] row_mask:0xf bank_mask:0xf
    v_xor_b32_dpp v175, v143, v12 quad_perm:[0,1,3,2] row_mask:0xf bank_mask:0xf
    v_xor_b32_dpp v236, v140, v13 quad_perm:[0,1,3,2] row_mask:0xf bank_mask:0xf
    v_xor_b32_dpp v237, v141, v13 quad_perm:[0,1,3,2] row_mask:0xf bank_mask:0xf
    v_xor_b32_dpp v238, v142, v13 quad_perm:[0,1,3,2] row_mask:0xf bank_mask:0xf
    v_xor_b32_dpp v239, v143, v13 quad_perm:[0,1,3,2] row_mask:0xf bank_mask:0xf
    s_lshl_b32 s49, s58, 12
    v_bfe_u32 v5, v1, 1, 3
    v_xor_b32 v5, v5, v3
    v_lshlrev_b32 v7, 7, v2
    v_add_u32 v7, s49, v7
    v_lshl_add_u32 v10, v5, 4, v7
    v_xor_b32 v11, 32, v10
    v_xor_b32 v12, 64, v10
    v_xor_b32 v13, 96, v10
    v_bfe_u32 v4, v1, 2, 2
    v_lshl_add_u32 v4, v3, 3, v4
    v_lshlrev_b32 v4, 7, v4
    v_bfe_u32 v5, v1, 3, 1
    v_xor_b32 v5, s58, v5
    v_lshl_add_u32 v4, v5, 6, v4
    v_bfe_u32 v6, v1, 4, 1
    v_lshl_add_u32 v4, v6, 5, v4
    v_and_b32 v5, 3, v1
    v_lshl_add_u32 v14, v5, 3, v4
    s_waitcnt lgkmcnt(0)
    s_lshl_b32 s40, s44, 17
    s_lshl_b32 s41, s46, 7
    s_add_u32 s40, s40, s41
    s_add_u32 s64, s40, 0x0
    s_add_u32 s65, s64, 65536
    v_lshrrev_b32 v5, 3, v1
    v_lshlrev_b32 v5, 13, v5
    v_and_b32 v8, 7, v1
    v_lshl_add_u32 v5, v8, 4, v5
    s_lshl_b32 s40, s3, 11
    s_add_u32 s40, s40, 149504
    v_lshlrev_b32 v8, 9, v3
    v_lshl_add_u32 v8, v2, 2, v8
    v_add_u32 v8, s40, v8
    v_add_u32 v15, s40, v9
    s_cmp_ge_u32 s43, 24
    s_cbranch_scc1 L_prep_o
    s_waitcnt lgkmcnt(0)
    s_barrier
    ds_read_b128 v[48:51], v10 offset:0
    ds_read_b64_tr_b16 v[80:81], v14 offset:8192
    ds_read_b64_tr_b16 v[82:83], v14 offset:8704
    ds_read_b128 v[52:55], v11 offset:0
    ds_read_b64_tr_b16 v[84:85], v14 offset:10240
    ds_read_b64_tr_b16 v[86:87], v14 offset:10752
    ds_read_b128 v[56:59], v12 offset:0
    ds_read_b64_tr_b16 v[88:89], v14 offset:12288
    ds_read_b64_tr_b16 v[90:91], v14 offset:12800
    ds_read_b128 v[60:63], v13 offset:0
    ds_read_b64_tr_b16 v[92:93], v14 offset:14336
    ds_read_b64_tr_b16 v[94:95], v14 offset:14848
    s_waitcnt lgkmcnt(0)
    v_mfma_f32_32x32x16_bf16 v[16:31], v[112:115], v[48:51], 0
    v_mfma_f32_32x32x16_bf16 v[32:47], v[112:115], v[80:83], 0
    s_barrier
    ds_read_b128 v[64:67], v10 offset:16384
    ds_read_b64_tr_b16 v[96:97], v14 offset:24576
    ds_read_b64_tr_b16 v[98:99], v14 offset:25088
    v_mfma_f32_32x32x16_bf16 v[16:31], v[116:119], v[52:55], v[16:31]
    ds_read_b128 v[68:71], v11 offset:16384
    ds_read_b64_tr_b16 v[100:101], v14 offset:26624
    ds_read_b64_tr_b16 v[102:103], v14 offset:27136
    v_mfma_f32_32x32x16_bf16 v[32:47], v[116:119], v[84:87], v[32:47]
    ds_read_b128 v[72:75], v12 offset:16384
    ds_read_b64_tr_b16 v[104:105], v14 offset:28672
    ds_read_b64_tr_b16 v[106:107], v14 offset:29184
    v_mfma_f32_32x32x16_bf16 v[16:31], v[120:123], v[56:59], v[16:31]
    ds_read_b128 v[76:79], v13 offset:16384
    ds_read_b64_tr_b16 v[108:109], v14 offset:30720
    ds_read_b64_tr_b16 v[110:111], v14 offset:31232
    v_mfma_f32_32x32x16_bf16 v[32:47], v[120:123], v[88:91], v[32:47]
    v_mfma_f32_32x32x16_bf16 v[16:31], v[124:127], v[60:63], v[16:31]
    v_mfma_f32_32x32x16_bf16 v[32:47], v[124:127], v[92:95], v[32:47]
    s_waitcnt lgkmcnt(0)
    v_mfma_f32_32x32x16_bf16 v[16:31], v[128:131], v[64:67], v[16:31]
    v_mfma_f32_32x32x16_bf16 v[32:47], v[128:131], v[96:99], v[32:47]
    s_barrier
    ds_read_b128 v[48:51], v10 offset:32768
    ds_read_b64_tr_b16 v[80:81], v14 offset:40960
    ds_read_b64_tr_b16 v[82:83], v14 offset:41472
    v_mfma_f32_32x32x16_bf16 v[16:31], v[132:135], v[68:71], v[16:31]
    ds_read_b128 v[52:55], v11 offset:32768
    ds_read_b64_tr_b16 v[84:85], v14 offset:43008
    ds_read_b64_tr_b16 v[86:87], v14 offset:43520
    v_mfma_f32_32x32x16_bf16 v[32:47], v[132:135], v[100:103], v[32:47]
    ds_read_b128 v[56:59], v12 offset:32768
    ds_read_b64_tr_b16 v[88:89], v14 offset:45056
    ds_read_b64_tr_b16 v[90:91], v14 offset:45568
    v_mfma_f32_32x32x16_bf16 v[16:31], v[136:139], v[72:75], v[16:31]
    ds_read_b128 v[60:63], v13 offset:32768
    ds_read_b64_tr_b16 v[92:93], v14 offset:47104
    ds_read_b64_tr_b16 v[94:95], v14 offset:47616
    v_mfma_f32_32x32x16_bf16 v[32:47], v[136:139], v[104:107], v[32:47]
    v_mfma_f32_32x32x16_bf16 v[16:31], v[140:143], v[76:79], v[16:31]
    v_mfma_f32_32x32x16_bf16 v[32:47], v[140:143], v[108:111], v[32:47]
    s_waitcnt lgkmcnt(0)
    v_mfma_f32_32x32x16_bf16 v[16:31], v[144:147], v[48:51], v[16:31]
    v_mfma_f32_32x32x16_bf16 v[32:47], v[144:147], v[80:83], v[32:47]
    s_barrier
    ds_read_b128 v[64:67], v10 offset:49152
    ds_read_b64_tr_b16 v[96:97], v14 offset:57344
    ds_read_b64_tr_b16 v[98:99], v14 offset:57856
    v_mfma_f32_32x32x16_bf16 v[16:31], v[148:151], v[52:55], v[16:31]
    ds_read_b128 v[68:71], v11 offset:49152
    ds_read_b64_tr_b16 v[100:101], v14 offset:59392
    ds_read_b64_tr_b16 v[102:103], v14 offset:59904
    v_mfma_f32_32x32x16_bf16 v[32:47], v[148:151], v[84:87], v[32:47]
    ds_read_b128 v[72:75], v12 offset:49152
    ds_read_b64_tr_b16 v[104:105], v14 offset:61440
    ds_read_b64_tr_b16 v[106:107], v14 offset:61952
    v_mfma_f32_32x32x16_bf16 v[16:31], v[152:155], v[56:59], v[16:31]
    ds_read_b128 v[76:79], v13 offset:49152
    ds_read_b64_tr_b16 v[108:109], v14 offset:63488
    ds_read_b64_tr_b16 v[110:111], v14 offset:64000
    v_mfma_f32_32x32x16_bf16 v[32:47], v[152:155], v[88:91], v[32:47]
    v_mfma_f32_32x32x16_bf16 v[16:31], v[156:159], v[60:63], v[16:31]
    v_mfma_f32_32x32x16_bf16 v[32:47], v[156:159], v[92:95], v[32:47]
    v_add_u32 v10, 0x10000, v10
    v_add_u32 v11, 0x10000, v11
    v_add_u32 v12, 0x10000, v12
    v_add_u32 v13, 0x10000, v13
    v_add_u32 v14, 0x10000, v14
    s_waitcnt lgkmcnt(0)
    v_mfma_f32_32x32x16_bf16 v[16:31], v[160:163], v[64:67], v[16:31]
    v_mfma_f32_32x32x16_bf16 v[32:47], v[160:163], v[96:99], v[32:47]
    s_barrier
    ds_read_b128 v[48:51], v10 offset:0
    ds_read_b64_tr_b16 v[80:81], v14 offset:8192
    ds_read_b64_tr_b16 v[82:83], v14 offset:8704
    v_mfma_f32_32x32x16_bf16 v[16:31], v[164:167], v[68:71], v[16:31]
    ds_read_b128 v[52:55], v11 offset:0
    ds_read_b64_tr_b16 v[84:85], v14 offset:10240
    ds_read_b64_tr_b16 v[86:87], v14 offset:10752
    v_mfma_f32_32x32x16_bf16 v[32:47], v[164:167], v[100:103], v[32:47]
    ds_read_b128 v[56:59], v12 offset:0
    ds_read_b64_tr_b16 v[88:89], v14 offset:12288
    ds_read_b64_tr_b16 v[90:91], v14 offset:12800
    v_mfma_f32_32x32x16_bf16 v[16:31], v[168:171], v[72:75], v[16:31]
    ds_read_b128 v[60:63], v13 offset:0
    ds_read_b64_tr_b16 v[92:93], v14 offset:14336
    ds_read_b64_tr_b16 v[94:95], v14 offset:14848
    v_mfma_f32_32x32x16_bf16 v[32:47], v[168:171], v[104:107], v[32:47]
    v_mfma_f32_32x32x16_bf16 v[16:31], v[172:175], v[76:79], v[16:31]
    v_mfma_f32_32x32x16_bf16 v[32:47], v[172:175], v[108:111], v[32:47]
    s_waitcnt lgkmcnt(0)
    v_mfma_f32_32x32x16_bf16 v[16:31], v[176:179], v[48:51], v[16:31]
    v_mfma_f32_32x32x16_bf16 v[32:47], v[176:179], v[80:83], v[32:47]
    s_barrier
    ds_read_b128 v[64:67], v10 offset:16384
    ds_read_b64_tr_b16 v[96:97], v14 offset:24576
    ds_read_b64_tr_b16 v[98:99], v14 offset:25088
    v_mfma_f32_32x32x16_bf16 v[16:31], v[180:183], v[52:55], v[16:31]
    ds_read_b128 v[68:71], v11 offset:16384
    ds_read_b64_tr_b16 v[100:101], v14 offset:26624
    ds_read_b64_tr_b16 v[102:103], v14 offset:27136
    v_mfma_f32_32x32x16_bf16 v[32:47], v[180:183], v[84:87], v[32:47]
    ds_read_b128 v[72:75], v12 offset:16384
    ds_read_b64_tr_b16 v[104:105], v14 offset:28672
    ds_read_b64_tr_b16 v[106:107], v14 offset:29184
    v_mfma_f32_32x32x16_bf16 v[16:31], v[184:187], v[56:59], v[16:31]
    ds_read_b128 v[76:79], v13 offset:16384
    ds_read_b64_tr_b16 v[108:109], v14 offset:30720
    ds_read_b64_tr_b16 v[110:111], v14 offset:31232
    v_mfma_f32_32x32x16_bf16 v[32:47], v[184:187], v[88:91], v[32:47]
    v_mfma_f32_32x32x16_bf16 v[16:31], v[188:191], v[60:63], v[16:31]
    v_mfma_f32_32x32x16_bf16 v[32:47], v[188:191], v[92:95], v[32:47]
    s_waitcnt lgkmcnt(0)
    v_mfma_f32_32x32x16_bf16 v[16:31], v[192:195], v[64:67], v[16:31]
    v_mfma_f32_32x32x16_bf16 v[32:47], v[192:195], v[96:99], v[32:47]
    s_barrier
    ds_read_b128 v[48:51], v10 offset:32768
    ds_read_b64_tr_b16 v[80:81], v14 offset:40960
    ds_read_b64_tr_b16 v[82:83], v14 offset:41472
    v_mfma_f32_32x32x16_bf16 v[16:31], v[196:199], v[68:71], v[16:31]
    ds_read_b128 v[52:55], v11 offset:32768
    ds_read_b64_tr_b16 v[84:85], v14 offset:43008
    ds_read_b64_tr_b16 v[86:87], v14 offset:43520
    v_mfma_f32_32x32x16_bf16 v[32:47], v[196:199], v[100:103], v[32:47]
    ds_read_b128 v[56:59], v12 offset:32768
    ds_read_b64_tr_b16 v[88:89], v14 offset:45056
    ds_read_b64_tr_b16 v[90:91], v14 offset:45568
    v_mfma_f32_32x32x16_bf16 v[16:31], v[200:203], v[72:75], v[16:31]
    ds_read_b128 v[60:63], v13 offset:32768
    ds_read_b64_tr_b16 v[92:93], v14 offset:47104
    ds_read_b64_tr_b16 v[94:95], v14 offset:47616
    v_mfma_f32_32x32x16_bf16 v[32:47], v[200:203], v[104:107], v[32:47]
    v_mfma_f32_32x32x16_bf16 v[16:31], v[204:207], v[76:79], v[16:31]
    v_mfma_f32_32x32x16_bf16 v[32:47], v[204:207], v[108:111], v[32:47]
    s_waitcnt lgkmcnt(0)
    v_mfma_f32_32x32x16_bf16 v[16:31], v[208:211], v[48:51], v[16:31]
    v_mfma_f32_32x32x16_bf16 v[32:47], v[208:211], v[80:83], v[32:47]
    s_barrier
    ds_read_b128 v[64:67], v10 offset:49152
    ds_read_b64_tr_b16 v[96:97], v14 offset:57344
    ds_read_b64_tr_b16 v[98:99], v14 offset:57856
    v_mfma_f32_32x32x16_bf16 v[16:31], v[212:215], v[52:55], v[16:31]
    ds_read_b128 v[68:71], v11 offset:49152
    ds_read_b64_tr_b16 v[100:101], v14 offset:59392
    ds_read_b64_tr_b16 v[102:103], v14 offset:59904
    v_mfma_f32_32x32x16_bf16 v[32:47], v[212:215], v[84:87], v[32:47]
    ds_read_b128 v[72:75], v12 offset:49152
    ds_read_b64_tr_b16 v[104:105], v14 offset:61440
    ds_read_b64_tr_b16 v[106:107], v14 offset:61952
    v_mfma_f32_32x32x16_bf16 v[16:31], v[216:219], v[56:59], v[16:31]
    ds_read_b128 v[76:79], v13 offset:49152
    ds_read_b64_tr_b16 v[108:109], v14 offset:63488
    ds_read_b64_tr_b16 v[110:111], v14 offset:64000
    v_mfma_f32_32x32x16_bf16 v[32:47], v[216:219], v[88:91], v[32:47]
    v_mfma_f32_32x32x16_bf16 v[16:31], v[220:223], v[60:63], v[16:31]
    v_mfma_f32_32x32x16_bf16 v[32:47], v[220:223], v[92:95], v[32:47]
    s_waitcnt lgkmcnt(9)
    v_mfma_f32_32x32x16_bf16 v[16:31], v[224:227], v[64:67], v[16:31]
    v_mfma_f32_32x32x16_bf16 v[32:47], v[224:227], v[96:99], v[32:47]
    s_waitcnt lgkmcnt(6)
    v_mfma_f32_32x32x16_bf16 v[16:31], v[228:231], v[68:71], v[16:31]
    v_mfma_f32_32x32x16_bf16 v[32:47], v[228:231], v[100:103], v[32:47]
    s_waitcnt lgkmcnt(3)
    v_mfma_f32_32x32x16_bf16 v[16:31], v[232:235], v[72:75], v[16:31]
    v_mfma_f32_32x32x16_bf16 v[32:47], v[232:235], v[104:107], v[32:47]
    s_waitcnt lgkmcnt(0)
    v_mfma_f32_32x32x16_bf16 v[16:31], v[236:239], v[76:79], v[16:31]
    v_mfma_f32_32x32x16_bf16 v[32:47], v[236:239], v[108:111], v[32:47]
    s_lshr_b32 s47, s46, 4
    s_and_b32 s41, s46, 15
    s_mul_i32 s41, s41, 98304
    s_add_u32 s41, s41, 0x600000
    s_cmp_eq_u32 s47, 0
    s_mov_b32 s50, 0x3d800000
    s_cselect_b32 s50, 0x3cb8aa3b, s50
    s_lshl_b32 s40, s44, 11
    s_lshl_b32 s48, s47, 8
    s_add_u32 s40, s40, s48
    s_lshl_b32 s48, s44, 10
    s_add_u32 s48, s48, 32768
    s_cmp_eq_u32 s47, 2
    s_cselect_b32 s40, s48, s40
    s_cselect_b32 s48, 8, 10
    s_mov_b32 s47, 9
    s_add_u32 s40, s40, s41
    s_lshl_b32 s48, 1, s48
    s_add_u32 s41, s40, s48
    v_and_b32 v7, 15, v1
    v_lshlrev_b32 v9, 4, v7
    v_lshlrev_b32 v7, s47, v3
    v_add_u32 v9, v9, v7
    s_mov_b32 s48, 49152
    v_mad_u32_u24 v9, v6, s48, v9
    v_add_u32 v4, s44, v3
    v_cmp_eq_u32 vcc, 0, v4
    s_nop 1
    v_cndmask_b32 v33, v33, v4, vcc
L_prep_out:
    v_mul_f32 v16, 0x3d800000, v16
    v_mul_f32 v17, 0x3d800000, v17
    v_mul_f32 v18, 0x3d800000, v18
    v_mul_f32 v19, 0x3d800000, v19
    v_mul_f32 v20, 0x3d800000, v20
    v_mul_f32 v21, 0x3d800000, v21
    v_mul_f32 v22, 0x3d800000, v22
    v_mul_f32 v23, 0x3d800000, v23
    v_mul_f32 v24, 0x3d800000, v24
    v_mul_f32 v25, 0x3d800000, v25
    v_mul_f32 v26, 0x3d800000, v26
    v_mul_f32 v27, 0x3d800000, v27
    v_mul_f32 v28, 0x3d800000, v28
    v_mul_f32 v29, 0x3d800000, v29
    v_mul_f32 v30, 0x3d800000, v30
    v_mul_f32 v31, 0x3d800000, v31
    v_cvt_pk_bf16_f32 v48, v16, v17
    v_cvt_pk_bf16_f32 v49, v18, v19
    v_cvt_pk_bf16_f32 v50, v20, v21
    v_cvt_pk_bf16_f32 v51, v22, v23
    v_cvt_pk_bf16_f32 v52, v24, v25
    v_cvt_pk_bf16_f32 v53, v26, v27
    v_cvt_pk_bf16_f32 v54, v28, v29
    v_cvt_pk_bf16_f32 v55, v30, v31
    ds_write_b32 v8, v48 offset:0
    ds_write_b32 v8, v49 offset:128
    ds_write_b32 v8, v50 offset:256
    ds_write_b32 v8, v51 offset:384
    ds_write_b32 v8, v52 offset:1024
    ds_write_b32 v8, v53 offset:1152
    ds_write_b32 v8, v54 offset:1280
    ds_write_b32 v8, v55 offset:1408
    ds_read_b128 v[64:67], v15
    ds_read_b128 v[68:71], v15 offset:1024
    v_mul_f32 v32, s50, v32
    v_mul_f32 v33, s50, v33
    v_mul_f32 v34, s50, v34
    v_mul_f32 v35, s50, v35
    v_mul_f32 v36, s50, v36
    v_mul_f32 v37, s50, v37
    v_mul_f32 v38, s50, v38
    v_mul_f32 v39, s50, v39
    v_mul_f32 v40, s50, v40
    v_mul_f32 v41, s50, v41
    v_mul_f32 v42, s50, v42
    v_mul_f32 v43, s50, v43
    v_mul_f32 v44, s50, v44
    v_mul_f32 v45, s50, v45
    v_mul_f32 v46, s50, v46
    v_mul_f32 v47, s50, v47
    v_cvt_pk_bf16_f32 v56, v32, v33
    v_cvt_pk_bf16_f32 v57, v34, v35
    v_cvt_pk_bf16_f32 v58, v36, v37
    v_cvt_pk_bf16_f32 v59, v38, v39
    v_cvt_pk_bf16_f32 v60, v40, v41
    v_cvt_pk_bf16_f32 v61, v42, v43
    v_cvt_pk_bf16_f32 v62, v44, v45
    v_cvt_pk_bf16_f32 v63, v46, v47
    s_waitcnt lgkmcnt(0)
    buffer_store_dwordx4 v[64:67], v5, s[8:11], s64 offen sc1
    buffer_store_dwordx4 v[68:71], v5, s[8:11], s65 offen sc1
    buffer_store_dwordx4 v[56:59], v9, s[8:11], s40 offen sc1
    buffer_store_dwordx4 v[60:63], v9, s[8:11], s41 offen sc1
    s_endpgm
L_prep_o:
    s_waitcnt lgkmcnt(0)
    s_barrier
    ds_read_b128 v[48:51], v10 offset:0
    ds_read_b128 v[80:83], v10 offset:8192
    ds_read_b128 v[52:55], v11 offset:0
    ds_read_b128 v[84:87], v11 offset:8192
    ds_read_b128 v[56:59], v12 offset:0
    ds_read_b128 v[88:91], v12 offset:8192
    ds_read_b128 v[60:63], v13 offset:0
    ds_read_b128 v[92:95], v13 offset:8192
    s_waitcnt lgkmcnt(0)
    v_mfma_f32_32x32x16_bf16 v[16:31], v[112:115], v[48:51], 0
    v_mfma_f32_32x32x16_bf16 v[32:47], v[80:83], v[112:115], 0
    s_barrier
    ds_read_b128 v[64:67], v10 offset:16384
    ds_read_b128 v[96:99], v10 offset:24576
    v_mfma_f32_32x32x16_bf16 v[16:31], v[116:119], v[52:55], v[16:31]
    ds_read_b128 v[68:71], v11 offset:16384
    ds_read_b128 v[100:103], v11 offset:24576
    v_mfma_f32_32x32x16_bf16 v[32:47], v[84:87], v[116:119], v[32:47]
    ds_read_b128 v[72:75], v12 offset:16384
    ds_read_b128 v[104:107], v12 offset:24576
    v_mfma_f32_32x32x16_bf16 v[16:31], v[120:123], v[56:59], v[16:31]
    ds_read_b128 v[76:79], v13 offset:16384
    ds_read_b128 v[108:111], v13 offset:24576
    v_mfma_f32_32x32x16_bf16 v[32:47], v[88:91], v[120:123], v[32:47]
    v_mfma_f32_32x32x16_bf16 v[16:31], v[124:127], v[60:63], v[16:31]
    v_mfma_f32_32x32x16_bf16 v[32:47], v[92:95], v[124:127], v[32:47]
    s_waitcnt lgkmcnt(0)
    v_mfma_f32_32x32x16_bf16 v[16:31], v[128:131], v[64:67], v[16:31]
    v_mfma_f32_32x32x16_bf16 v[32:47], v[96:99], v[128:131], v[32:47]
    s_barrier
    ds_read_b128 v[48:51], v10 offset:32768
    ds_read_b128 v[80:83], v10 offset:40960
    v_mfma_f32_32x32x16_bf16 v[16:31], v[132:135], v[68:71], v[16:31]
    ds_read_b128 v[52:55], v11 offset:32768
    ds_read_b128 v[84:87], v11 offset:40960
    v_mfma_f32_32x32x16_bf16 v[32:47], v[100:103], v[132:135], v[32:47]
    ds_read_b128 v[56:59], v12 offset:32768
    ds_read_b128 v[88:91], v12 offset:40960
    v_mfma_f32_32x32x16_bf16 v[16:31], v[136:139], v[72:75], v[16:31]
    ds_read_b128 v[60:63], v13 offset:32768
    ds_read_b128 v[92:95], v13 offset:40960
    v_mfma_f32_32x32x16_bf16 v[32:47], v[104:107], v[136:139], v[32:47]
    v_mfma_f32_32x32x16_bf16 v[16:31], v[140:143], v[76:79], v[16:31]
    v_mfma_f32_32x32x16_bf16 v[32:47], v[108:111], v[140:143], v[32:47]
    s_waitcnt lgkmcnt(0)
    v_mfma_f32_32x32x16_bf16 v[16:31], v[144:147], v[48:51], v[16:31]
    v_mfma_f32_32x32x16_bf16 v[32:47], v[80:83], v[144:147], v[32:47]
    s_barrier
    ds_read_b128 v[64:67], v10 offset:49152
    ds_read_b128 v[96:99], v10 offset:57344
    v_mfma_f32_32x32x16_bf16 v[16:31], v[148:151], v[52:55], v[16:31]
    ds_read_b128 v[68:71], v11 offset:49152
    ds_read_b128 v[100:103], v11 offset:57344
    v_mfma_f32_32x32x16_bf16 v[32:47], v[84:87], v[148:151], v[32:47]
    ds_read_b128 v[72:75], v12 offset:49152
    ds_read_b128 v[104:107], v12 offset:57344
    v_mfma_f32_32x32x16_bf16 v[16:31], v[152:155], v[56:59], v[16:31]
    ds_read_b128 v[76:79], v13 offset:49152
    ds_read_b128 v[108:111], v13 offset:57344
    v_mfma_f32_32x32x16_bf16 v[32:47], v[88:91], v[152:155], v[32:47]
    v_mfma_f32_32x32x16_bf16 v[16:31], v[156:159], v[60:63], v[16:31]
    v_mfma_f32_32x32x16_bf16 v[32:47], v[92:95], v[156:159], v[32:47]
    v_add_u32 v10, 0x10000, v10
    v_add_u32 v11, 0x10000, v11
    v_add_u32 v12, 0x10000, v12
    v_add_u32 v13, 0x10000, v13
    v_add_u32 v14, 0x10000, v14
    s_waitcnt lgkmcnt(0)
    v_mfma_f32_32x32x16_bf16 v[16:31], v[160:163], v[64:67], v[16:31]
    v_mfma_f32_32x32x16_bf16 v[32:47], v[96:99], v[160:163], v[32:47]
    s_barrier
    ds_read_b128 v[48:51], v10 offset:0
    ds_read_b128 v[80:83], v10 offset:8192
    v_mfma_f32_32x32x16_bf16 v[16:31], v[164:167], v[68:71], v[16:31]
    ds_read_b128 v[52:55], v11 offset:0
    ds_read_b128 v[84:87], v11 offset:8192
    v_mfma_f32_32x32x16_bf16 v[32:47], v[100:103], v[164:167], v[32:47]
    ds_read_b128 v[56:59], v12 offset:0
    ds_read_b128 v[88:91], v12 offset:8192
    v_mfma_f32_32x32x16_bf16 v[16:31], v[168:171], v[72:75], v[16:31]
    ds_read_b128 v[60:63], v13 offset:0
    ds_read_b128 v[92:95], v13 offset:8192
    v_mfma_f32_32x32x16_bf16 v[32:47], v[104:107], v[168:171], v[32:47]
    v_mfma_f32_32x32x16_bf16 v[16:31], v[172:175], v[76:79], v[16:31]
    v_mfma_f32_32x32x16_bf16 v[32:47], v[108:111], v[172:175], v[32:47]
    s_waitcnt lgkmcnt(0)
    v_mfma_f32_32x32x16_bf16 v[16:31], v[176:179], v[48:51], v[16:31]
    v_mfma_f32_32x32x16_bf16 v[32:47], v[80:83], v[176:179], v[32:47]
    s_barrier
    ds_read_b128 v[64:67], v10 offset:16384
    ds_read_b128 v[96:99], v10 offset:24576
    v_mfma_f32_32x32x16_bf16 v[16:31], v[180:183], v[52:55], v[16:31]
    ds_read_b128 v[68:71], v11 offset:16384
    ds_read_b128 v[100:103], v11 offset:24576
    v_mfma_f32_32x32x16_bf16 v[32:47], v[84:87], v[180:183], v[32:47]
    ds_read_b128 v[72:75], v12 offset:16384
    ds_read_b128 v[104:107], v12 offset:24576
    v_mfma_f32_32x32x16_bf16 v[16:31], v[184:187], v[56:59], v[16:31]
    ds_read_b128 v[76:79], v13 offset:16384
    ds_read_b128 v[108:111], v13 offset:24576
    v_mfma_f32_32x32x16_bf16 v[32:47], v[88:91], v[184:187], v[32:47]
    v_mfma_f32_32x32x16_bf16 v[16:31], v[188:191], v[60:63], v[16:31]
    v_mfma_f32_32x32x16_bf16 v[32:47], v[92:95], v[188:191], v[32:47]
    s_waitcnt lgkmcnt(0)
    v_mfma_f32_32x32x16_bf16 v[16:31], v[192:195], v[64:67], v[16:31]
    v_mfma_f32_32x32x16_bf16 v[32:47], v[96:99], v[192:195], v[32:47]
    s_barrier
    ds_read_b128 v[48:51], v10 offset:32768
    ds_read_b128 v[80:83], v10 offset:40960
    v_mfma_f32_32x32x16_bf16 v[16:31], v[196:199], v[68:71], v[16:31]
    ds_read_b128 v[52:55], v11 offset:32768
    ds_read_b128 v[84:87], v11 offset:40960
    v_mfma_f32_32x32x16_bf16 v[32:47], v[100:103], v[196:199], v[32:47]
    ds_read_b128 v[56:59], v12 offset:32768
    ds_read_b128 v[88:91], v12 offset:40960
    v_mfma_f32_32x32x16_bf16 v[16:31], v[200:203], v[72:75], v[16:31]
    ds_read_b128 v[60:63], v13 offset:32768
    ds_read_b128 v[92:95], v13 offset:40960
    v_mfma_f32_32x32x16_bf16 v[32:47], v[104:107], v[200:203], v[32:47]
    v_mfma_f32_32x32x16_bf16 v[16:31], v[204:207], v[76:79], v[16:31]
    v_mfma_f32_32x32x16_bf16 v[32:47], v[108:111], v[204:207], v[32:47]
    s_waitcnt lgkmcnt(0)
    v_mfma_f32_32x32x16_bf16 v[16:31], v[208:211], v[48:51], v[16:31]
    v_mfma_f32_32x32x16_bf16 v[32:47], v[80:83], v[208:211], v[32:47]
    s_barrier
    ds_read_b128 v[64:67], v10 offset:49152
    ds_read_b128 v[96:99], v10 offset:57344
    v_mfma_f32_32x32x16_bf16 v[16:31], v[212:215], v[52:55], v[16:31]
    ds_read_b128 v[68:71], v11 offset:49152
    ds_read_b128 v[100:103], v11 offset:57344
    v_mfma_f32_32x32x16_bf16 v[32:47], v[84:87], v[212:215], v[32:47]
    ds_read_b128 v[72:75], v12 offset:49152
    ds_read_b128 v[104:107], v12 offset:57344
    v_mfma_f32_32x32x16_bf16 v[16:31], v[216:219], v[56:59], v[16:31]
    ds_read_b128 v[76:79], v13 offset:49152
    ds_read_b128 v[108:111], v13 offset:57344
    v_mfma_f32_32x32x16_bf16 v[32:47], v[88:91], v[216:219], v[32:47]
    v_mfma_f32_32x32x16_bf16 v[16:31], v[220:223], v[60:63], v[16:31]
    v_mfma_f32_32x32x16_bf16 v[32:47], v[92:95], v[220:223], v[32:47]
    s_waitcnt lgkmcnt(6)
    v_mfma_f32_32x32x16_bf16 v[16:31], v[224:227], v[64:67], v[16:31]
    v_mfma_f32_32x32x16_bf16 v[32:47], v[96:99], v[224:227], v[32:47]
    s_waitcnt lgkmcnt(4)
    v_mfma_f32_32x32x16_bf16 v[16:31], v[228:231], v[68:71], v[16:31]
    v_mfma_f32_32x32x16_bf16 v[32:47], v[100:103], v[228:231], v[32:47]
    s_waitcnt lgkmcnt(2)
    v_mfma_f32_32x32x16_bf16 v[16:31], v[232:235], v[72:75], v[16:31]
    v_mfma_f32_32x32x16_bf16 v[32:47], v[104:107], v[232:235], v[32:47]
    s_waitcnt lgkmcnt(0)
    v_mfma_f32_32x32x16_bf16 v[16:31], v[236:239], v[76:79], v[16:31]
    v_mfma_f32_32x32x16_bf16 v[32:47], v[108:111], v[236:239], v[32:47]
    s_sub_u32 s46, s46, 48
    s_lshl_b32 s40, s44, 15
    s_lshl_b32 s41, s46, 11
    s_add_u32 s40, s40, s41
    s_add_u32 s40, s40, 0x800000
    s_add_u32 s41, s40, 1024
    s_mov_b32 s50, 0x3d800000
    s_nop 7
    s_branch L_prep_out
L_prep_h67:
    s_cmp_eq_u32 s3, 7
    s_cbranch_scc1 L_prep_stat
    s_lshl_b32 s44, s40, 5
    s_add_u32 s44, s44, s41
    s_and_b32 s47, s44, 1
    s_lshr_b32 s44, s44, 1
    s_mul_i32 s45, s44, 8224
    s_add_u32 s46, s45, 4096
    s_add_u32 s48, s45, 8192
    s_mov_b32 s18, 0x101000
    s_mov_b32 s19, 0x00020000
    s_mov_b32 s22, 0x101000
    s_waitcnt lgkmcnt(0)
    s_mov_b64 s[16:17], s[74:75]
    s_mov_b64 s[20:21], s[76:77]
    s_mov_b32 m0, 131072
    s_nop 0
    buffer_load_dwordx4 v9, s[16:19], s45 offen offset:0 lds
    buffer_load_dwordx4 v9, s[16:19], s45 offen offset:1024 lds
    buffer_load_dwordx4 v9, s[16:19], s45 offen offset:2048 lds
    buffer_load_dwordx4 v9, s[16:19], s45 offen offset:3072 lds
    s_mov_b32 m0, 135168
    s_nop 0
    buffer_load_dwordx4 v9, s[16:19], s46 offen offset:0 lds
    buffer_load_dwordx4 v9, s[16:19], s46 offen offset:1024 lds
    buffer_load_dwordx4 v9, s[16:19], s46 offen offset:2048 lds
    buffer_load_dwordx4 v9, s[16:19], s46 offen offset:3072 lds
    s_mov_b32 m0, 139264
    s_mov_b64 exec, 3
    buffer_load_dwordx4 v9, s[16:19], s48 offen lds
    s_mov_b64 exec, -1
    s_mov_b32 m0, 140288
    s_nop 0
    buffer_load_dwordx4 v9, s[20:23], s45 offen offset:0 lds
    buffer_load_dwordx4 v9, s[20:23], s45 offen offset:1024 lds
    buffer_load_dwordx4 v9, s[20:23], s45 offen offset:2048 lds
    buffer_load_dwordx4 v9, s[20:23], s45 offen offset:3072 lds
    s_mov_b32 m0, 144384
    s_nop 0
    buffer_load_dwordx4 v9, s[20:23], s46 offen offset:0 lds
    buffer_load_dwordx4 v9, s[20:23], s46 offen offset:1024 lds
    buffer_load_dwordx4 v9, s[20:23], s46 offen offset:2048 lds
    buffer_load_dwordx4 v9, s[20:23], s46 offen offset:3072 lds
    s_mov_b32 m0, 148480
    s_mov_b64 exec, 3
    buffer_load_dwordx4 v9, s[20:23], s48 offen lds
    s_mov_b64 exec, -1
    s_mov_b32 s49, 131072
    v_lshrrev_b32 v4, 2, v1
    s_lshl_b32 s47, s47, 7
    v_add_u32 v4, s47, v4
    v_and_b32 v8, 3, v1
    s_movk_i32 s48, 2056
    v_mul_lo_u32 v10, v8, s48
    v_lshlrev_b32 v5, 1, v4
    v_mov_b32 v6, 512
    v_cmp_eq_u32 vcc, 0, v4
    s_nop 1
    v_cndmask_b32 v6, v5, v6, vcc
    v_add3_u32 v5, v5, v10, s49
    v_add3_u32 v6, v6, v10, s49
    v_lshlrev_b32 v7, 13, v4
    v_lshl_add_u32 v7, v8, 4, v7
    s_lshl_b32 s44, s44, 6
    s_add_u32 s44, s44, 0x400000
    s_setprio 3
    s_barrier
    s_barrier
    s_barrier
    s_barrier
    s_barrier
    s_waitcnt vmcnt(0)
    ds_read_u16 v64, v6 offset:0
    ds_read_u16 v72, v6 offset:9216
    ds_read_u16 v65, v6 offset:514
    ds_read_u16 v73, v6 offset:9730
    ds_read_u16 v66, v6 offset:1028
    ds_read_u16 v74, v6 offset:10244
    ds_read_u16 v67, v6 offset:1542
    ds_read_u16 v75, v6 offset:10758
    s_waitcnt lgkmcnt(0)
    v_lshl_or_b32 v80, v72, 16, v64
    v_lshl_or_b32 v81, v73, 16, v65
    v_lshl_or_b32 v82, v74, 16, v66
    v_lshl_or_b32 v83, v75, 16, v67
    buffer_store_dwordx4 v[80:83], v7, s[8:11], s44 offen sc1
    s_add_u32 s44, s44, 0x20000
    ds_read_u16 v64, v5 offset:32
    ds_read_u16 v72, v5 offset:9248
    ds_read_u16 v65, v5 offset:546
    ds_read_u16 v73, v5 offset:9762
    ds_read_u16 v66, v5 offset:1060
    ds_read_u16 v74, v5 offset:10276
    ds_read_u16 v67, v5 offset:1574
    ds_read_u16 v75, v5 offset:10790
    s_waitcnt lgkmcnt(0)
    v_lshl_or_b32 v84, v72, 16, v64
    v_lshl_or_b32 v85, v73, 16, v65
    v_lshl_or_b32 v86, v74, 16, v66
    v_lshl_or_b32 v87, v75, 16, v67
    buffer_store_dwordx4 v[84:87], v7, s[8:11], s44 offen sc1
    s_add_u32 s44, s44, 0x20000
    s_barrier
    ds_read_u16 v64, v5 offset:64
    ds_read_u16 v72, v5 offset:9280
    ds_read_u16 v65, v5 offset:578
    ds_read_u16 v73, v5 offset:9794
    ds_read_u16 v66, v5 offset:1092
    ds_read_u16 v74, v5 offset:10308
    ds_read_u16 v67, v5 offset:1606
    ds_read_u16 v75, v5 offset:10822
    s_waitcnt lgkmcnt(0)
    v_lshl_or_b32 v88, v72, 16, v64
    v_lshl_or_b32 v89, v73, 16, v65
    v_lshl_or_b32 v90, v74, 16, v66
    v_lshl_or_b32 v91, v75, 16, v67
    buffer_store_dwordx4 v[88:91], v7, s[8:11], s44 offen sc1
    s_add_u32 s44, s44, 0x20000
    ds_read_u16 v64, v5 offset:96
    ds_read_u16 v72, v5 offset:9312
    ds_read_u16 v65, v5 offset:610
    ds_read_u16 v73, v5 offset:9826
    ds_read_u16 v66, v5 offset:1124
    ds_read_u16 v74, v5 offset:10340
    ds_read_u16 v67, v5 offset:1638
    ds_read_u16 v75, v5 offset:10854
    s_waitcnt lgkmcnt(0)
    v_lshl_or_b32 v92, v72, 16, v64
    v_lshl_or_b32 v93, v73, 16, v65
    v_lshl_or_b32 v94, v74, 16, v66
    v_lshl_or_b32 v95, v75, 16, v67
    buffer_store_dwordx4 v[92:95], v7, s[8:11], s44 offen sc1
    s_add_u32 s44, s44, 0x20000
    s_barrier
    ds_read_u16 v64, v5 offset:128
    ds_read_u16 v72, v5 offset:9344
    ds_read_u16 v65, v5 offset:642
    ds_read_u16 v73, v5 offset:9858
    ds_read_u16 v66, v5 offset:1156
    ds_read_u16 v74, v5 offset:10372
    ds_read_u16 v67, v5 offset:1670
    ds_read_u16 v75, v5 offset:10886
    s_waitcnt lgkmcnt(0)
    v_lshl_or_b32 v80, v72, 16, v64
    v_lshl_or_b32 v81, v73, 16, v65
    v_lshl_or_b32 v82, v74, 16, v66
    v_lshl_or_b32 v83, v75, 16, v67
    buffer_store_dwordx4 v[80:83], v7, s[8:11], s44 offen sc1
    s_add_u32 s44, s44, 0x20000
    ds_read_u16 v64, v5 offset:160
    ds_read_u16 v72, v5 offset:9376
    ds_read_u16 v65, v5 offset:674
    ds_read_u16 v73, v5 offset:9890
    ds_read_u16 v66, v5 offset:1188
    ds_read_u16 v74, v5 offset:10404
    ds_read_u16 v67, v5 offset:1702
    ds_read_u16 v75, v5 offset:10918
    s_waitcnt lgkmcnt(0)
    v_lshl_or_b32 v84, v72, 16, v64
    v_lshl_or_b32 v85, v73, 16, v65
    v_lshl_or_b32 v86, v74, 16, v66
    v_lshl_or_b32 v87, v75, 16, v67
    buffer_store_dwordx4 v[84:87], v7, s[8:11], s44 offen sc1
    s_add_u32 s44, s44, 0x20000
    s_barrier
    ds_read_u16 v64, v5 offset:192
    ds_read_u16 v72, v5 offset:9408
    ds_read_u16 v65, v5 offset:706
    ds_read_u16 v73, v5 offset:9922
    ds_read_u16 v66, v5 offset:1220
    ds_read_u16 v74, v5 offset:10436
    ds_read_u16 v67, v5 offset:1734
    ds_read_u16 v75, v5 offset:10950
    s_waitcnt lgkmcnt(0)
    v_lshl_or_b32 v88, v72, 16, v64
    v_lshl_or_b32 v89, v73, 16, v65
    v_lshl_or_b32 v90, v74, 16, v66
    v_lshl_or_b32 v91, v75, 16, v67
    buffer_store_dwordx4 v[88:91], v7, s[8:11], s44 offen sc1
    s_add_u32 s44, s44, 0x20000
    ds_read_u16 v64, v5 offset:224
    ds_read_u16 v72, v5 offset:9440
    ds_read_u16 v65, v5 offset:738
    ds_read_u16 v73, v5 offset:9954
    ds_read_u16 v66, v5 offset:1252
    ds_read_u16 v74, v5 offset:10468
    ds_read_u16 v67, v5 offset:1766
    ds_read_u16 v75, v5 offset:10982
    s_waitcnt lgkmcnt(0)
    v_lshl_or_b32 v92, v72, 16, v64
    v_lshl_or_b32 v93, v73, 16, v65
    v_lshl_or_b32 v94, v74, 16, v66
    v_lshl_or_b32 v95, v75, 16, v67
    buffer_store_dwordx4 v[92:95], v7, s[8:11], s44 offen sc1
    s_cmp_lt_u32 s43, 24
    s_cbranch_scc1 L_prep_w6e
    v_bfe_u32 v4, v1, 2, 2
    v_lshl_add_u32 v5, v3, 2, v4
    v_lshlrev_b32 v5, 7, v5
    v_lshrrev_b32 v4, 1, v4
    v_lshl_add_u32 v4, v3, 1, v4
    v_and_b32 v6, 1, v1
    v_bfe_u32 v7, v1, 4, 1
    v_lshl_add_u32 v6, v6, 1, v7
    v_xor_b32 v4, v4, v6
    v_lshl_add_u32 v5, v4, 4, v5
    v_bfe_u32 v4, v1, 1, 1
    v_lshl_add_u32 v5, v4, 3, v5
    s_and_b32 s44, s51, 7
    s_lshl_b32 s44, s44, 16
    s_sub_u32 s45, s43, 24
    s_lshl_b32 s45, s45, 12
    s_add_u32 s44, s44, s45
    s_add_u32 s44, s44, 0x880000
    s_add_u32 s45, s44, 32768
    ds_read_b64_tr_b16 v[96:97], v5 offset:8192
    ds_read_b64_tr_b16 v[98:99], v5 offset:9280
    ds_read_b64_tr_b16 v[100:101], v5 offset:10240
    ds_read_b64_tr_b16 v[102:103], v5 offset:11328
    ds_read_b64_tr_b16 v[104:105], v5 offset:12288
    ds_read_b64_tr_b16 v[106:107], v5 offset:13376
    ds_read_b64_tr_b16 v[108:109], v5 offset:14336
    ds_read_b64_tr_b16 v[110:111], v5 offset:15424
    s_waitcnt lgkmcnt(0)
    buffer_store_dwordx4 v[96:99], v9, s[8:11], s44 offen offset:0 sc1
    buffer_store_dwordx4 v[100:103], v9, s[8:11], s44 offen offset:1024 sc1
    buffer_store_dwordx4 v[104:107], v9, s[8:11], s44 offen offset:2048 sc1
    buffer_store_dwordx4 v[108:111], v9, s[8:11], s44 offen offset:3072 sc1
    ds_read_b64_tr_b16 v[112:113], v5 offset:8256
    ds_read_b64_tr_b16 v[114:115], v5 offset:9216
    ds_read_b64_tr_b16 v[116:117], v5 offset:10304
    ds_read_b64_tr_b16 v[118:119], v5 offset:11264
    ds_read_b64_tr_b16 v[120:121], v5 offset:12352
    ds_read_b64_tr_b16 v[122:123], v5 offset:13312
    ds_read_b64_tr_b16 v[124:125], v5 offset:14400
    ds_read_b64_tr_b16 v[126:127], v5 offset:15360
    s_waitcnt lgkmcnt(0)
    buffer_store_dwordx4 v[112:115], v9, s[8:11], s45 offen offset:0 sc1
    buffer_store_dwordx4 v[116:119], v9, s[8:11], s45 offen offset:1024 sc1
    buffer_store_dwordx4 v[120:123], v9, s[8:11], s45 offen offset:2048 sc1
    buffer_store_dwordx4 v[124:127], v9, s[8:11], s45 offen offset:3072 sc1
    s_endpgm
L_prep_w6e:
    s_endpgm
L_prep_stat:
    s_getpc_b64 s[16:17]
    s_add_u32 s16, s16, code_begin@rel32@lo+4
    s_addc_u32 s17, s17, code_begin@rel32@hi+12
    v_lshlrev_b32 v25, 5, v1
    s_lshl_b32 s46, s41, 11
    v_add_u32 v25, s46, v25
    v_cmp_gt_u32 vcc, code_end-code_begin-4, v25
    v_mov_b32 v243, s17
    s_and_saveexec_b64 s[18:19], vcc
    s_cbranch_execz L_prep_nw2
    v_add_co_u32 v242, vcc, s16, v25
    s_nop 1
    v_addc_co_u32 v243, vcc, 0, v243, vcc
    global_load_dword v241, v[242:243], off
L_prep_nw2:
    s_mov_b64 exec, -1
    s_getpc_b64 s[16:17]
    s_add_u32 s16, s16, tables@rel32@lo+4
    s_addc_u32 s17, s17, tables@rel32@hi+12
    s_mul_i32 s46, s41, 1280
    v_lshlrev_b32 v25, 6, v1
    v_add_u32 v25, s46, v25
    v_mov_b32 v245, s17
    v_add_co_u32 v244, vcc, s16, v25
    s_nop 1
    v_addc_co_u32 v245, vcc, 0, v245, vcc
    s_mov_b64 exec, 0xfffff
    global_load_dword v246, v[244:245], off
    s_mov_b64 exec, -1
    s_waitcnt lgkmcnt(0)
    v_mov_b32 v42, 0
    v_mov_b32 v43, 0x3e800000
    v_bfe_u32 v44, v1, 2, 1
    v_lshlrev_b32 v44, 4, v44
    v_bfe_u32 v45, v1, 3, 2
    v_lshl_add_u32 v44, v45, 2, v44
    v_and_b32 v45, 3, v1
    s_lshr_b32 s46, s2, 4
    s_lshl_b32 s46, s46, 5
    v_add3_u32 v44, v44, v45, s46
    s_and_b32 s46, s2, 15
    s_lshl_b32 s46, s46, 4
    v_lshl_add_u32 v45, v3, 2, s46
    s_lshl_b32 s52, s2, 11
    s_add_u32 s52, s52, 0x1b00000
    s_add_u32 s53, s52, 1024
    v_and_b32 v46, 1, v44
    v_cvt_f32_u32 v46, v46
    v_mov_b32 v47, 0x3e000000
    v_fmac_f32 v47, 0.5, v46
    v_mov_b32 v46, 0x3e000000
    v_cmp_eq_u32 vcc, 0, v45
    v_mul_u32_u24 v40, v44, v45
    v_and_b32 v40, 511, v40
    v_cvt_f32_u32 v40, v40
    v_mul_f32 v40, 0x3b000000, v40
    v_cvt_f32_u32 v41, v44
    v_mul_f32 v41, 0x3b000000, v41
    v_add_f32 v48, v40, v42
    v_add_f32 v49, v40, v43
    v_fmamk_f32 v50, v41, 0x3f800000, v48
    v_fmamk_f32 v51, v41, 0x3f800000, v49
    v_fmamk_f32 v52, v41, 0x40000000, v48
    v_fmamk_f32 v53, v41, 0x40000000, v49
    v_fmamk_f32 v54, v41, 0x40400000, v48
    v_fmamk_f32 v55, v41, 0x40400000, v49
    v_cndmask_b32 v48, v48, v47, vcc
    v_cndmask_b32 v49, v49, v46, vcc
    v_cos_f32 v48, v48
    v_cos_f32 v49, v49
    v_cos_f32 v50, v50
    v_cos_f32 v51, v51
    v_cos_f32 v52, v52
    v_cos_f32 v53, v53
    v_cos_f32 v54, v54
    v_cos_f32 v55, v55
    v_mul_f32 v48, 0x3d800000, v48
    v_mul_f32 v49, 0x3d800000, v49
    v_mul_f32 v50, 0x3d800000, v50
    v_mul_f32 v51, 0x3d800000, v51
    v_mul_f32 v52, 0x3d800000, v52
    v_mul_f32 v53, 0x3d800000, v53
    v_mul_f32 v54, 0x3d800000, v54
    v_mul_f32 v55, 0x3d800000, v55
    v_cvt_pk_bf16_f32 v96, v48, v49
    v_cvt_pk_bf16_f32 v97, v50, v51
    v_cvt_pk_bf16_f32 v98, v52, v53
    v_cvt_pk_bf16_f32 v99, v54, v55
    buffer_store_dwordx4 v[96:99], v9, s[8:11], s52 offen
    v_add_u32 v45, 8, v45
    v_mul_u32_u24 v40, v44, v45
    v_and_b32 v40, 511, v40
    v_cvt_f32_u32 v40, v40
    v_mul_f32 v40, 0x3b000000, v40
    v_cvt_f32_u32 v41, v44
    v_mul_f32 v41, 0x3b000000, v41
    v_add_f32 v48, v40, v42
    v_add_f32 v49, v40, v43
    v_fmamk_f32 v50, v41, 0x3f800000, v48
    v_fmamk_f32 v51, v41, 0x3f800000, v49
    v_fmamk_f32 v52, v41, 0x40000000, v48
    v_fmamk_f32 v53, v41, 0x40000000, v49
    v_fmamk_f32 v54, v41, 0x40400000, v48
    v_fmamk_f32 v55, v41, 0x40400000, v49
    v_cos_f32 v48, v48
    v_cos_f32 v49, v49
    v_cos_f32 v50, v50
    v_cos_f32 v51, v51
    v_cos_f32 v52, v52
    v_cos_f32 v53, v53
    v_cos_f32 v54, v54
    v_cos_f32 v55, v55
    v_mul_f32 v48, 0x3d800000, v48
    v_mul_f32 v49, 0x3d800000, v49
    v_mul_f32 v50, 0x3d800000, v50
    v_mul_f32 v51, 0x3d800000, v51
    v_mul_f32 v52, 0x3d800000, v52
    v_mul_f32 v53, 0x3d800000, v53
    v_mul_f32 v54, 0x3d800000, v54
    v_mul_f32 v55, 0x3d800000, v55
    v_cvt_pk_bf16_f32 v100, v48, v49
    v_cvt_pk_bf16_f32 v101, v50, v51
    v_cvt_pk_bf16_f32 v102, v52, v53
    v_cvt_pk_bf16_f32 v103, v54, v55
    buffer_store_dwordx4 v[100:103], v9, s[8:11], s53 offen
    s_lshl_b32 s40, s42, 10
    v_add_u32 v7, s40, v9
    v_mov_b32 v20, 0
    v_lshlrev_b32 v21, 2, v1
    v_lshrrev_b32 v6, 3, v1
    v_lshlrev_b32 v6, 2, v6
    s_lshl_b32 s44, s43, 8
    s_lshl_b32 s45, s42, 5
    s_add_u32 s44, s44, s45
    s_add_u32 s43, s44, 0x1600000
    s_add_u32 s44, s44, 0x1602000
    s_lshl_b32 s45, s2, 7
    s_add_u32 s45, s45, 0x1604000
    s_lshl_b32 s47, s2, 9
    s_add_u32 s47, s47, 0x1610000
    v_mov_b32 v22, -1
    v_mov_b32 v23, -1
    v_lshlrev_b32 v24, 3, v1
    v_mov_b32 v10, 0
    v_mov_b32 v11, 0
    s_waitcnt lgkmcnt(0)
    buffer_store_dword v20, v6, s[8:11], s44 offen
    s_mov_b32 exec_hi, 0
    buffer_store_dword v20, v21, s[8:11], s45 offen
    s_mov_b32 exec_hi, -1
    buffer_store_dwordx2 v[22:23], v24, s[8:11], s47 offen
    v_mov_b32 v28, -1
    v_mov_b32 v29, -1
    v_mov_b32 v30, -1
    v_mov_b32 v31, -1
    s_lshl_b32 s47, s2, 13
    s_add_u32 s47, s47, 0xe00000
    s_add_u32 s48, s47, 4096
    s_mov_b32 s46, 0
    s_setprio 2
    s_add_u32 s49, s47, 0x900000
    s_add_u32 s50, s49, 4096
    v_mov_b32 v8, 0x3f803f80
    v_add_u32 v12, 0x10000, v7
    s_barrier
    ds_read_b128 v[64:67], v7 offset:0
    buffer_store_dwordx4 v[28:31], v9, s[8:11], s49 offen offset:0 sc1
    s_barrier
    ds_read_b128 v[68:71], v7 offset:16384
    buffer_store_dwordx4 v[28:31], v9, s[8:11], s49 offen offset:1024 sc1
    s_barrier
    ds_read_b128 v[72:75], v7 offset:32768
    buffer_store_dwordx4 v[28:31], v9, s[8:11], s49 offen offset:2048 sc1
    s_barrier
    ds_read_b128 v[76:79], v7 offset:49152
    buffer_store_dwordx4 v[28:31], v9, s[8:11], s49 offen offset:3072 sc1
    s_barrier
    ds_read_b128 v[80:83], v12 offset:0
    buffer_store_dwordx4 v[28:31], v9, s[8:11], s50 offen offset:0 sc1
    s_barrier
    ds_read_b128 v[84:87], v12 offset:16384
    buffer_store_dwordx4 v[28:31], v9, s[8:11], s50 offen offset:1024 sc1
    s_barrier
    ds_read_b128 v[88:91], v12 offset:32768
    buffer_store_dwordx4 v[28:31], v9, s[8:11], s50 offen offset:2048 sc1
    s_barrier
    ds_read_b128 v[92:95], v12 offset:49152
    buffer_store_dwordx4 v[28:31], v9, s[8:11], s50 offen offset:3072 sc1
    s_waitcnt lgkmcnt(0)
    v_dot2c_f32_bf16 v10, v64, v64
    v_dot2c_f32_bf16 v11, v64, v8
    v_dot2c_f32_bf16 v10, v65, v65
    v_dot2c_f32_bf16 v11, v65, v8
    v_dot2c_f32_bf16 v10, v66, v66
    v_dot2c_f32_bf16 v11, v66, v8
    v_dot2c_f32_bf16 v10, v67, v67
    v_dot2c_f32_bf16 v11, v67, v8
    v_dot2c_f32_bf16 v10, v68, v68
    v_dot2c_f32_bf16 v11, v68, v8
    v_dot2c_f32_bf16 v10, v69, v69
    v_dot2c_f32_bf16 v11, v69, v8
    v_dot2c_f32_bf16 v10, v70, v70
    v_dot2c_f32_bf16 v11, v70, v8
    v_dot2c_f32_bf16 v10, v71, v71
    v_dot2c_f32_bf16 v11, v71, v8
    v_dot2c_f32_bf16 v10, v72, v72
    v_dot2c_f32_bf16 v11, v72, v8
    v_dot2c_f32_bf16 v10, v73, v73
    v_dot2c_f32_bf16 v11, v73, v8
    v_dot2c_f32_bf16 v10, v74, v74
    v_dot2c_f32_bf16 v11, v74, v8
    v_dot2c_f32_bf16 v10, v75, v75
    v_dot2c_f32_bf16 v11, v75, v8
    v_dot2c_f32_bf16 v10, v76, v76
    v_dot2c_f32_bf16 v11, v76, v8
    v_dot2c_f32_bf16 v10, v77, v77
    v_dot2c_f32_bf16 v11, v77, v8
    v_dot2c_f32_bf16 v10, v78, v78
    v_dot2c_f32_bf16 v11, v78, v8
    v_dot2c_f32_bf16 v10, v79, v79
    v_dot2c_f32_bf16 v11, v79, v8
    v_dot2c_f32_bf16 v10, v80, v80
    v_dot2c_f32_bf16 v11, v80, v8
    v_dot2c_f32_bf16 v10, v81, v81
    v_dot2c_f32_bf16 v11, v81, v8
    v_dot2c_f32_bf16 v10, v82, v82
    v_dot2c_f32_bf16 v11, v82, v8
    v_dot2c_f32_bf16 v10, v83, v83
    v_dot2c_f32_bf16 v11, v83, v8
    v_dot2c_f32_bf16 v10, v84, v84
    v_dot2c_f32_bf16 v11, v84, v8
    v_dot2c_f32_bf16 v10, v85, v85
    v_dot2c_f32_bf16 v11, v85, v8
    v_dot2c_f32_bf16 v10, v86, v86
    v_dot2c_f32_bf16 v11, v86, v8
    v_dot2c_f32_bf16 v10, v87, v87
    v_dot2c_f32_bf16 v11, v87, v8
    v_dot2c_f32_bf16 v10, v88, v88
    v_dot2c_f32_bf16 v11, v88, v8
    v_dot2c_f32_bf16 v10, v89, v89
    v_dot2c_f32_bf16 v11, v89, v8
    v_dot2c_f32_bf16 v10, v90, v90
    v_dot2c_f32_bf16 v11, v90, v8
    v_dot2c_f32_bf16 v10, v91, v91
    v_dot2c_f32_bf16 v11, v91, v8
    v_dot2c_f32_bf16 v10, v92, v92
    v_dot2c_f32_bf16 v11, v92, v8
    v_dot2c_f32_bf16 v10, v93, v93
    v_dot2c_f32_bf16 v11, v93, v8
    v_dot2c_f32_bf16 v10, v94, v94
    v_dot2c_f32_bf16 v11, v94, v8
    v_dot2c_f32_bf16 v10, v95, v95
    v_dot2c_f32_bf16 v11, v95, v8
    s_nop 2
    v_add_f32_dpp v10, v10, v10 quad_perm:[1,0,3,2] row_mask:0xf bank_mask:0xf
    v_add_f32_dpp v11, v11, v11 quad_perm:[1,0,3,2] row_mask:0xf bank_mask:0xf
    s_nop 0
    v_add_f32_dpp v10, v10, v10 quad_perm:[2,3,0,1] row_mask:0xf bank_mask:0xf
    v_add_f32_dpp v11, v11, v11 quad_perm:[2,3,0,1] row_mask:0xf bank_mask:0xf
    s_nop 0
    v_add_f32_dpp v10, v10, v10 row_half_mirror row_mask:0xf bank_mask:0xf
    v_add_f32_dpp v11, v11, v11 row_half_mirror row_mask:0xf bank_mask:0xf
    v_mul_f32 v12, 0xbb000000, v11
    v_fma_f32 v13, v12, v11, v10
    buffer_store_dword v13, v6, s[8:11], s43 offen
L_prep_end:
    s_endpgm
.text
.p2align 8
code_begin:
.text
.globl mha2_kernel
.p2align 8
.type mha2_kernel,@function
mha2_kernel:
    s_mov_b32 s65, 0x600000
    s_mov_b32 s66, 1
    s_mov_b32 s47, 0x1602000
    s_branch L_mha
.text
.globl mha1_kernel
.p2align 8
.type mha1_kernel,@function
mha1_kernel:
    s_mov_b32 s65, 0
    s_mov_b32 s66, 0
    s_mov_b32 s47, 0x1600000
L_mha:
    s_cmp_ge_u32 s2, 256
    s_cbranch_scc1 L_mha_end
    s_load_dwordx2 s[8:9], s[0:1], 64
    s_mov_b32 s10, 0x1c00000
    s_mov_b32 s11, 0x00020000
    s_load_dwordx2 s[12:13], s[0:1], 48
    s_mov_b32 s14, 0x200000
    s_mov_b32 s15, 0x00020000
    v_lshrrev_b32 v4, 6, v0
    v_and_b32 v1, 63, v0
    v_readfirstlane_b32 s3, v4
    v_and_b32 v2, 31, v0
    v_lshrrev_b32 v3, 5, v1
    v_lshlrev_b32 v9, 4, v1
    s_cmp_ge_u32 s3, 4
    s_cbranch_scc1 L_mha_ids
    s_setprio 3
    s_getpc_b64 s[48:49]
    s_add_u32 s48, s48, tables@rel32@lo+4100
    s_addc_u32 s49, s49, tables@rel32@hi+4108
    v_mov_b32 v177, s49
    v_add_co_u32 v176, vcc, s48, v9
    s_nop 1
    v_addc_co_u32 v177, vcc, 0, v177, vcc
    global_load_dwordx4 v[48:51], v[176:177], off offset:-4096
    global_load_dwordx4 v[52:55], v[176:177], off offset:-3072
    global_load_dwordx4 v[56:59], v[176:177], off offset:-2048
    global_load_dwordx4 v[60:63], v[176:177], off offset:-1024
    global_load_dwordx4 v[64:67], v[176:177], off offset:0
    global_load_dwordx4 v[68:71], v[176:177], off offset:1024
    global_load_dwordx4 v[72:75], v[176:177], off offset:2048
    global_load_dwordx4 v[76:79], v[176:177], off offset:3072
    s_lshl_b32 s50, s3, 13
    s_add_u32 s50, s50, 8192
    v_add_co_u32 v178, vcc, s50, v176
    s_nop 1
    v_addc_co_u32 v179, vcc, 0, v177, vcc
    global_load_dwordx4 v[80:83], v[178:179], off offset:-4096
    global_load_dwordx4 v[84:87], v[178:179], off offset:-3072
    global_load_dwordx4 v[88:91], v[178:179], off offset:-2048
    global_load_dwordx4 v[92:95], v[178:179], off offset:-1024
    s_and_b32 s42, s2, 7
    s_lshr_b32 s43, s2, 3
    s_lshl_b32 s42, s42, 5
    s_add_u32 s42, s42, s43
    v_and_b32 v5, 15, v1
    v_lshrrev_b32 v6, 4, v1
    v_lshlrev_b32 v7, 5, v1
    s_lshl_b32 s44, s3, 11
    s_lshl_b32 s45, s42, 13
    s_add_u32 s45, s45, s44
    s_add_u32 s54, s45, 0x400000
    s_add_u32 s45, s45, 0x0
    s_add_u32 s47, s47, s44
    v_lshlrev_b32 v15, 8, v3
    v_lshl_add_u32 v15, v2, 2, v15
    s_lshl_b32 s56, s3, 4
    v_add_u32 v10, s56, v5
    v_cvt_f32_u32 v10, v10
    v_mul_f32 v10, 0x3a000000, v10
    v_lshlrev_b32 v11, 3, v6
    v_cvt_f32_u32 v11, v11
    v_mul_f32 v11, v10, v11
    s_waitcnt lgkmcnt(0)
    buffer_load_dwordx4 v[24:27], v7, s[8:11], s47 offen offset:0
    buffer_load_dwordx4 v[28:31], v7, s[8:11], s47 offen offset:16
    buffer_load_dwordx4 v[16:19], v7, s[8:11], s45 offen offset:0
    buffer_load_dwordx4 v[20:23], v7, s[8:11], s45 offen offset:16
    v_fmamk_f32 v12, v10, 0x0, v11
    v_cos_f32 v112, v12
    v_sin_f32 v113, v12
    v_fmamk_f32 v12, v10, 0x3f800000, v11
    v_cos_f32 v114, v12
    v_sin_f32 v115, v12
    v_fmamk_f32 v12, v10, 0x40000000, v11
    v_cos_f32 v116, v12
    v_sin_f32 v117, v12
    v_fmamk_f32 v12, v10, 0x40400000, v11
    v_cos_f32 v118, v12
    v_sin_f32 v119, v12
    v_fmamk_f32 v12, v10, 0x40800000, v11
    v_cos_f32 v120, v12
    v_sin_f32 v121, v12
    v_fmamk_f32 v12, v10, 0x40a00000, v11
    v_cos_f32 v122, v12
    v_sin_f32 v123, v12
    v_fmamk_f32 v12, v10, 0x40c00000, v11
    v_cos_f32 v124, v12
    v_sin_f32 v125, v12
    v_fmamk_f32 v12, v10, 0x40e00000, v11
    v_cos_f32 v126, v12
    v_sin_f32 v127, v12
    v_cvt_f32_u32 v10, v2
    v_mul_f32 v10, 0x3a000000, v10
    v_lshlrev_b32 v11, 1, v3
    v_add_u32 v11, s56, v11
    v_cvt_f32_u32 v11, v11
    v_mul_f32 v11, v10, v11
    s_mov_b32 s58, 0x3a000000
    s_mov_b32 s59, 0x3a000000
    v_fmamk_f32 v12, v10, 0x0, v11
    v_cos_f32 v128, v12
    v_sin_f32 v129, v12
    v_fmamk_f32 v12, v10, 0x3f800000, v11
    v_cos_f32 v130, v12
    v_sin_f32 v131, v12
    v_fmamk_f32 v12, v10, 0x40800000, v11
    v_cos_f32 v132, v12
    v_sin_f32 v133, v12
    v_fmamk_f32 v12, v10, 0x40a00000, v11
    v_cos_f32 v134, v12
    v_sin_f32 v135, v12
    v_fmamk_f32 v12, v10, 0x41000000, v11
    v_cos_f32 v136, v12
    v_sin_f32 v137, v12
    v_fmamk_f32 v12, v10, 0x41100000, v11
    v_cos_f32 v138, v12
    v_sin_f32 v139, v12
    v_fmamk_f32 v12, v10, 0x41400000, v11
    v_cos_f32 v140, v12
    v_sin_f32 v141, v12
    v_fmamk_f32 v12, v10, 0x41500000, v11
    v_cos_f32 v142, v12
    v_sin_f32 v143, v12
    v_pk_mul_f32 v[128:129], v[128:129], s[58:59]
    v_pk_mul_f32 v[130:131], v[130:131], s[58:59]
    v_pk_mul_f32 v[132:133], v[132:133], s[58:59]
    v_pk_mul_f32 v[134:135], v[134:135], s[58:59]
    v_pk_mul_f32 v[136:137], v[136:137], s[58:59]
    v_pk_mul_f32 v[138:139], v[138:139], s[58:59]
    v_pk_mul_f32 v[140:141], v[140:141], s[58:59]
    v_pk_mul_f32 v[142:143], v[142:143], s[58:59]
    s_movk_i32 s57, 2176
    v_mul_lo_u32 v10, v6, s57
    v_lshl_add_u32 v10, v5, 2, v10
    s_lshl_b32 s58, s3, 6
    s_add_u32 s58, s58, 0x12000
    v_add_u32 v10, s58, v10
    s_movk_i32 s57, 272
    v_mul_lo_u32 v11, v2, s57
    v_lshl_add_u32 v12, v3, 3, v11
    v_add_u32 v12, s58, v12
    v_lshl_add_u32 v11, v3, 4, v11
    v_add_u32 v11, 0x12000, v11
    s_mul_i32 s58, s3, 2304
    s_add_u32 s58, s58, 0x12000
    s_movk_i32 s57, 288
    v_mul_lo_u32 v13, v3, s57
    v_lshl_add_u32 v13, v2, 2, v13
    v_add_u32 v13, s58, v13
    s_movk_i32 s57, 144
    v_mul_lo_u32 v14, v5, s57
    v_add_u32 v14, s58, v14
    v_lshl_add_u32 v14, v6, 5, v14
    s_lshl_b32 s40, s42, 7
    s_lshl_b32 s41, s3, 19
    s_add_u32 s40, s40, s41
    s_lshl_b32 s41, s66, 21
    s_add_u32 s40, s40, s41
    s_add_u32 s40, s40, 0x1700000
    v_lshrrev_b32 v8, 2, v1
    v_lshlrev_b32 v8, 15, v8
    v_and_b32 v4, 3, v1
    v_lshl_add_u32 v8, v4, 4, v8
    s_mov_b32 s60, 0x3b000000
    v_mov_b32 v4, 0x3727c5ac
    global_load_dwordx4 v[96:99], v[178:179], off offset:0
    global_load_dwordx4 v[100:103], v[178:179], off offset:1024
    global_load_dwordx4 v[104:107], v[178:179], off offset:2048
    global_load_dwordx4 v[108:111], v[178:179], off offset:3072
    buffer_load_dword v184, v15, s[8:11], s54 offen offset:0
    buffer_load_dword v185, v15, s[8:11], s54 offen offset:128
    buffer_load_dword v186, v15, s[8:11], s54 offen offset:512
    buffer_load_dword v187, v15, s[8:11], s54 offen offset:640
    buffer_load_dword v188, v15, s[8:11], s54 offen offset:1024
    buffer_load_dword v189, v15, s[8:11], s54 offen offset:1152
    buffer_load_dword v190, v15, s[8:11], s54 offen offset:1536
    buffer_load_dword v191, v15, s[8:11], s54 offen offset:1664
    s_waitcnt vmcnt(14)
    v_fma_f32 v24, v24, s60, v4
    v_fma_f32 v25, v25, s60, v4
    v_fma_f32 v26, v26, s60, v4
    v_fma_f32 v27, v27, s60, v4
    v_fma_f32 v28, v28, s60, v4
    v_fma_f32 v29, v29, s60, v4
    v_fma_f32 v30, v30, s60, v4
    v_fma_f32 v31, v31, s60, v4
    v_rsq_f32 v24, v24
    v_rsq_f32 v25, v25
    v_rsq_f32 v26, v26
    v_rsq_f32 v27, v27
    v_rsq_f32 v28, v28
    v_rsq_f32 v29, v29
    v_rsq_f32 v30, v30
    v_rsq_f32 v31, v31
    s_waitcnt vmcnt(12)
    v_and_b32 v32, 0xffff0000, v16
    v_lshlrev_b32 v33, 16, v16
    v_pk_mul_f32 v[144:145], v[32:33], v[24:25] op_sel:[0,0] op_sel_hi:[1,0]
    v_and_b32 v34, 0xffff0000, v17
    v_lshlrev_b32 v35, 16, v17
    v_pk_mul_f32 v[146:147], v[34:35], v[24:25] op_sel:[0,1] op_sel_hi:[1,1]
    v_and_b32 v36, 0xffff0000, v18
    v_lshlrev_b32 v37, 16, v18
    v_pk_mul_f32 v[148:149], v[36:37], v[26:27] op_sel:[0,0] op_sel_hi:[1,0]
    v_and_b32 v38, 0xffff0000, v19
    v_lshlrev_b32 v39, 16, v19
    v_pk_mul_f32 v[150:151], v[38:39], v[26:27] op_sel:[0,1] op_sel_hi:[1,1]
    v_and_b32 v40, 0xffff0000, v20
    v_lshlrev_b32 v41, 16, v20
    v_pk_mul_f32 v[152:153], v[40:41], v[28:29] op_sel:[0,0] op_sel_hi:[1,0]
    v_and_b32 v42, 0xffff0000, v21
    v_lshlrev_b32 v43, 16, v21
    v_pk_mul_f32 v[154:155], v[42:43], v[28:29] op_sel:[0,1] op_sel_hi:[1,1]
    v_and_b32 v44, 0xffff0000, v22
    v_lshlrev_b32 v45, 16, v22
    v_pk_mul_f32 v[156:157], v[44:45], v[30:31] op_sel:[0,0] op_sel_hi:[1,0]
    v_and_b32 v46, 0xffff0000, v23
    v_lshlrev_b32 v47, 16, v23
    v_pk_mul_f32 v[158:159], v[46:47], v[30:31] op_sel:[0,1] op_sel_hi:[1,1]
    s_cmp_eq_u32 s42, 0
    s_cbranch_scc1 L_col_z0
L_col_n0:
    v_cvt_pk_bf16_f32 v24, v145, v144
    v_cvt_pk_bf16_f32 v25, v147, v146
    v_cvt_pk_bf16_f32 v26, v149, v148
    v_cvt_pk_bf16_f32 v27, v151, v150
    v_cvt_pk_bf16_f32 v28, v153, v152
    v_cvt_pk_bf16_f32 v29, v155, v154
    v_cvt_pk_bf16_f32 v30, v157, v156
    v_cvt_pk_bf16_f32 v31, v159, v158
    v_mfma_f32_16x16x32_bf16 v[144:147], v[48:51], v[24:27], 0
    v_mfma_f32_16x16x32_bf16 v[148:151], v[56:59], v[24:27], 0
    v_mfma_f32_16x16x32_bf16 v[152:155], v[64:67], v[24:27], 0
    v_mfma_f32_16x16x32_bf16 v[156:159], v[72:75], v[24:27], 0
    v_mfma_f32_16x16x32_bf16 v[144:147], v[52:55], v[28:31], v[144:147]
    v_mfma_f32_16x16x32_bf16 v[148:151], v[60:63], v[28:31], v[148:151]
    v_mfma_f32_16x16x32_bf16 v[152:155], v[68:71], v[28:31], v[152:155]
    v_mfma_f32_16x16x32_bf16 v[156:159], v[76:79], v[28:31], v[156:159]
    s_nop 4
    v_pk_mul_f32 v[160:161], v[144:145], v[112:113] op_sel:[0,0] op_sel_hi:[1,0]
    v_pk_fma_f32 v[160:161], v[144:145], v[112:113], v[160:161] op_sel:[1,1,0] op_sel_hi:[0,1,1] neg_hi:[1,0,0]
    v_cvt_pk_bf16_f32 v24, v160, v161
    ds_write_b32 v10, v24 offset:0
    v_pk_mul_f32 v[162:163], v[146:147], v[114:115] op_sel:[0,0] op_sel_hi:[1,0]
    v_pk_fma_f32 v[162:163], v[146:147], v[114:115], v[162:163] op_sel:[1,1,0] op_sel_hi:[0,1,1] neg_hi:[1,0,0]
    v_cvt_pk_bf16_f32 v25, v162, v163
    ds_write_b32 v10, v25 offset:272
    v_pk_mul_f32 v[164:165], v[148:149], v[116:117] op_sel:[0,0] op_sel_hi:[1,0]
    v_pk_fma_f32 v[164:165], v[148:149], v[116:117], v[164:165] op_sel:[1,1,0] op_sel_hi:[0,1,1] neg_hi:[1,0,0]
    v_cvt_pk_bf16_f32 v26, v164, v165
    ds_write_b32 v10, v26 offset:544
    v_pk_mul_f32 v[166:167], v[150:151], v[118:119] op_sel:[0,0] op_sel_hi:[1,0]
    v_pk_fma_f32 v[166:167], v[150:151], v[118:119], v[166:167] op_sel:[1,1,0] op_sel_hi:[0,1,1] neg_hi:[1,0,0]
    v_cvt_pk_bf16_f32 v27, v166, v167
    ds_write_b32 v10, v27 offset:816
    v_pk_mul_f32 v[168:169], v[152:153], v[120:121] op_sel:[0,0] op_sel_hi:[1,0]
    v_pk_fma_f32 v[168:169], v[152:153], v[120:121], v[168:169] op_sel:[1,1,0] op_sel_hi:[0,1,1] neg_hi:[1,0,0]
    v_cvt_pk_bf16_f32 v28, v168, v169
    ds_write_b32 v10, v28 offset:1088
    v_pk_mul_f32 v[170:171], v[154:155], v[122:123] op_sel:[0,0] op_sel_hi:[1,0]
    v_pk_fma_f32 v[170:171], v[154:155], v[122:123], v[170:171] op_sel:[1,1,0] op_sel_hi:[0,1,1] neg_hi:[1,0,0]
    v_cvt_pk_bf16_f32 v29, v170, v171
    ds_write_b32 v10, v29 offset:1360
    v_pk_mul_f32 v[172:173], v[156:157], v[124:125] op_sel:[0,0] op_sel_hi:[1,0]
    v_pk_fma_f32 v[172:173], v[156:157], v[124:125], v[172:173] op_sel:[1,1,0] op_sel_hi:[0,1,1] neg_hi:[1,0,0]
    v_cvt_pk_bf16_f32 v30, v172, v173
    ds_write_b32 v10, v30 offset:1632
    v_pk_mul_f32 v[174:175], v[158:159], v[126:127] op_sel:[0,0] op_sel_hi:[1,0]
    v_pk_fma_f32 v[174:175], v[158:159], v[126:127], v[174:175] op_sel:[1,1,0] op_sel_hi:[0,1,1] neg_hi:[1,0,0]
    v_cvt_pk_bf16_f32 v31, v174, v175
    ds_write_b32 v10, v31 offset:1904
    s_waitcnt lgkmcnt(0)
    s_barrier
    ds_read_b128 v[144:147], v11 offset:0
    ds_read_b128 v[148:151], v11 offset:32
    ds_read_b128 v[152:155], v11 offset:64
    ds_read_b128 v[156:159], v11 offset:96
    ds_read_b128 v[160:163], v11 offset:128
    ds_read_b128 v[164:167], v11 offset:160
    ds_read_b128 v[168:171], v11 offset:192
    ds_read_b128 v[172:175], v11 offset:224
    s_waitcnt vmcnt(0)
    s_waitcnt lgkmcnt(7)
    v_mfma_f32_32x32x16_bf16 v[112:127], v[80:83], v[144:147], 0
    v_lshlrev_b32 v192, 16, v184
    v_and_b32 v193, 0xffff0000, v184
    s_waitcnt lgkmcnt(6)
    v_mfma_f32_32x32x16_bf16 v[112:127], v[84:87], v[148:151], v[112:127]
    v_lshlrev_b32 v194, 16, v185
    v_and_b32 v195, 0xffff0000, v185
    s_waitcnt lgkmcnt(5)
    v_mfma_f32_32x32x16_bf16 v[112:127], v[88:91], v[152:155], v[112:127]
    v_lshlrev_b32 v196, 16, v186
    v_and_b32 v197, 0xffff0000, v186
    s_waitcnt lgkmcnt(4)
    v_mfma_f32_32x32x16_bf16 v[112:127], v[92:95], v[156:159], v[112:127]
    v_lshlrev_b32 v198, 16, v187
    v_and_b32 v199, 0xffff0000, v187
    s_waitcnt lgkmcnt(3)
    v_mfma_f32_32x32x16_bf16 v[112:127], v[96:99], v[160:163], v[112:127]
    v_lshlrev_b32 v200, 16, v188
    v_and_b32 v201, 0xffff0000, v188
    s_waitcnt lgkmcnt(2)
    v_mfma_f32_32x32x16_bf16 v[112:127], v[100:103], v[164:167], v[112:127]
    v_lshlrev_b32 v202, 16, v189
    v_and_b32 v203, 0xffff0000, v189
    s_waitcnt lgkmcnt(1)
    v_mfma_f32_32x32x16_bf16 v[112:127], v[104:107], v[168:171], v[112:127]
    v_lshlrev_b32 v204, 16, v190
    v_and_b32 v205, 0xffff0000, v190
    s_waitcnt lgkmcnt(0)
    v_mfma_f32_32x32x16_bf16 v[112:127], v[108:111], v[172:175], v[112:127]
    v_lshlrev_b32 v206, 16, v191
    v_and_b32 v207, 0xffff0000, v191
    s_nop 9
    v_pk_mul_f32 v[160:161], v[112:113], v[192:193] op_sel:[0,0] op_sel_hi:[1,0] neg_hi:[1,0]
    v_pk_fma_f32 v[160:161], v[112:113], v[192:193], v[160:161] op_sel:[1,1,0] op_sel_hi:[0,1,1] neg_lo:[1,0,0] neg_hi:[1,0,0]
    v_cvt_pk_bf16_f32 v24, v160, v161
    v_pk_mul_f32 v[162:163], v[114:115], v[194:195] op_sel:[0,0] op_sel_hi:[1,0] neg_hi:[1,0]
    v_pk_fma_f32 v[162:163], v[114:115], v[194:195], v[162:163] op_sel:[1,1,0] op_sel_hi:[0,1,1] neg_lo:[1,0,0] neg_hi:[1,0,0]
    v_cvt_pk_bf16_f32 v25, v162, v163
    ds_write_b64 v12, v[24:25] offset:8704
    v_pk_mul_f32 v[164:165], v[116:117], v[196:197] op_sel:[0,0] op_sel_hi:[1,0] neg_hi:[1,0]
    v_pk_fma_f32 v[164:165], v[116:117], v[196:197], v[164:165] op_sel:[1,1,0] op_sel_hi:[0,1,1] neg_lo:[1,0,0] neg_hi:[1,0,0]
    v_cvt_pk_bf16_f32 v26, v164, v165
    v_pk_mul_f32 v[166:167], v[118:119], v[198:199] op_sel:[0,0] op_sel_hi:[1,0] neg_hi:[1,0]
    v_pk_fma_f32 v[166:167], v[118:119], v[198:199], v[166:167] op_sel:[1,1,0] op_sel_hi:[0,1,1] neg_lo:[1,0,0] neg_hi:[1,0,0]
    v_cvt_pk_bf16_f32 v27, v166, v167
    ds_write_b64 v12, v[26:27] offset:8720
    v_pk_mul_f32 v[168:169], v[120:121], v[200:201] op_sel:[0,0] op_sel_hi:[1,0] neg_hi:[1,0]
    v_pk_fma_f32 v[168:169], v[120:121], v[200:201], v[168:169] op_sel:[1,1,0] op_sel_hi:[0,1,1] neg_lo:[1,0,0] neg_hi:[1,0,0]
    v_cvt_pk_bf16_f32 v28, v168, v169
    v_pk_mul_f32 v[170:171], v[122:123], v[202:203] op_sel:[0,0] op_sel_hi:[1,0] neg_hi:[1,0]
    v_pk_fma_f32 v[170:171], v[122:123], v[202:203], v[170:171] op_sel:[1,1,0] op_sel_hi:[0,1,1] neg_lo:[1,0,0] neg_hi:[1,0,0]
    v_cvt_pk_bf16_f32 v29, v170, v171
    ds_write_b64 v12, v[28:29] offset:8736
    v_pk_mul_f32 v[172:173], v[124:125], v[204:205] op_sel:[0,0] op_sel_hi:[1,0] neg_hi:[1,0]
    v_pk_fma_f32 v[172:173], v[124:125], v[204:205], v[172:173] op_sel:[1,1,0] op_sel_hi:[0,1,1] neg_lo:[1,0,0] neg_hi:[1,0,0]
    v_cvt_pk_bf16_f32 v30, v172, v173
    v_pk_mul_f32 v[174:175], v[126:127], v[206:207] op_sel:[0,0] op_sel_hi:[1,0] neg_hi:[1,0]
    v_pk_fma_f32 v[174:175], v[126:127], v[206:207], v[174:175] op_sel:[1,1,0] op_sel_hi:[0,1,1] neg_lo:[1,0,0] neg_hi:[1,0,0]
    v_cvt_pk_bf16_f32 v31, v174, v175
    ds_write_b64 v12, v[30:31] offset:8752
    s_waitcnt lgkmcnt(0)
    s_barrier
    ds_read_b128 v[144:147], v11 offset:8704
    ds_read_b128 v[148:151], v11 offset:8736
    ds_read_b128 v[152:155], v11 offset:8768
    ds_read_b128 v[156:159], v11 offset:8800
    ds_read_b128 v[160:163], v11 offset:8832
    ds_read_b128 v[164:167], v11 offset:8864
    ds_read_b128 v[168:171], v11 offset:8896
    ds_read_b128 v[172:175], v11 offset:8928
    s_waitcnt lgkmcnt(7)
    v_mfma_f32_32x32x16_bf16 v[112:127], v[80:83], v[144:147], 0
    s_waitcnt lgkmcnt(6)
    v_mfma_f32_32x32x16_bf16 v[112:127], v[84:87], v[148:151], v[112:127]
    s_waitcnt lgkmcnt(5)
    v_mfma_f32_32x32x16_bf16 v[112:127], v[88:91], v[152:155], v[112:127]
    s_waitcnt lgkmcnt(4)
    v_mfma_f32_32x32x16_bf16 v[112:127], v[92:95], v[156:159], v[112:127]
    s_waitcnt lgkmcnt(3)
    v_mfma_f32_32x32x16_bf16 v[112:127], v[96:99], v[160:163], v[112:127]
    s_waitcnt lgkmcnt(2)
    v_mfma_f32_32x32x16_bf16 v[112:127], v[100:103], v[164:167], v[112:127]
    s_waitcnt lgkmcnt(1)
    v_mfma_f32_32x32x16_bf16 v[112:127], v[104:107], v[168:171], v[112:127]
    s_waitcnt lgkmcnt(0)
    v_mfma_f32_32x32x16_bf16 v[112:127], v[108:111], v[172:175], v[112:127]
    s_nop 11
    v_pk_mul_f32 v[144:145], v[112:113], v[128:129] op_sel:[0,1] op_sel_hi:[0,0]
    v_pk_fma_f32 v[144:145], v[112:113], v[128:129], v[144:145] op_sel:[1,0,0] op_sel_hi:[1,1,1] neg_lo:[1,0,0]
    v_cvt_pk_bf16_f32 v24, v144, v145
    ds_write_b32 v13, v24 offset:17408
    v_pk_mul_f32 v[146:147], v[114:115], v[130:131] op_sel:[0,1] op_sel_hi:[0,0]
    v_pk_fma_f32 v[146:147], v[114:115], v[130:131], v[146:147] op_sel:[1,0,0] op_sel_hi:[1,1,1] neg_lo:[1,0,0]
    v_cvt_pk_bf16_f32 v25, v146, v147
    ds_write_b32 v13, v25 offset:17552
    v_pk_mul_f32 v[148:149], v[116:117], v[132:133] op_sel:[0,1] op_sel_hi:[0,0]
    v_pk_fma_f32 v[148:149], v[116:117], v[132:133], v[148:149] op_sel:[1,0,0] op_sel_hi:[1,1,1] neg_lo:[1,0,0]
    v_cvt_pk_bf16_f32 v26, v148, v149
    ds_write_b32 v13, v26 offset:17984
    v_pk_mul_f32 v[150:151], v[118:119], v[134:135] op_sel:[0,1] op_sel_hi:[0,0]
    v_pk_fma_f32 v[150:151], v[118:119], v[134:135], v[150:151] op_sel:[1,0,0] op_sel_hi:[1,1,1] neg_lo:[1,0,0]
    v_cvt_pk_bf16_f32 v27, v150, v151
    ds_write_b32 v13, v27 offset:18128
    v_pk_mul_f32 v[152:153], v[120:121], v[136:137] op_sel:[0,1] op_sel_hi:[0,0]
    v_pk_fma_f32 v[152:153], v[120:121], v[136:137], v[152:153] op_sel:[1,0,0] op_sel_hi:[1,1,1] neg_lo:[1,0,0]
    v_cvt_pk_bf16_f32 v28, v152, v153
    ds_write_b32 v13, v28 offset:18560
    v_pk_mul_f32 v[154:155], v[122:123], v[138:139] op_sel:[0,1] op_sel_hi:[0,0]
    v_pk_fma_f32 v[154:155], v[122:123], v[138:139], v[154:155] op_sel:[1,0,0] op_sel_hi:[1,1,1] neg_lo:[1,0,0]
    v_cvt_pk_bf16_f32 v29, v154, v155
    ds_write_b32 v13, v29 offset:18704
    v_pk_mul_f32 v[156:157], v[124:125], v[140:141] op_sel:[0,1] op_sel_hi:[0,0]
    v_pk_fma_f32 v[156:157], v[124:125], v[140:141], v[156:157] op_sel:[1,0,0] op_sel_hi:[1,1,1] neg_lo:[1,0,0]
    v_cvt_pk_bf16_f32 v30, v156, v157
    ds_write_b32 v13, v30 offset:19136
    v_pk_mul_f32 v[158:159], v[126:127], v[142:143] op_sel:[0,1] op_sel_hi:[0,0]
    v_pk_fma_f32 v[158:159], v[126:127], v[142:143], v[158:159] op_sel:[1,0,0] op_sel_hi:[1,1,1] neg_lo:[1,0,0]
    v_cvt_pk_bf16_f32 v31, v158, v159
    ds_write_b32 v13, v31 offset:19280
    s_waitcnt lgkmcnt(0)
    ds_read_b128 v[144:147], v14 offset:17408
    ds_read_b128 v[148:151], v14 offset:17424
    s_waitcnt lgkmcnt(0)
    v_mfma_f32_16x16x32_bf16 v[32:35], v[48:51], v[144:147], v[32:35]
    v_mfma_f32_16x16x32_bf16 v[36:39], v[56:59], v[144:147], v[36:39]
    v_mfma_f32_16x16x32_bf16 v[40:43], v[64:67], v[144:147], v[40:43]
    v_mfma_f32_16x16x32_bf16 v[44:47], v[72:75], v[144:147], v[44:47]
    v_mfma_f32_16x16x32_bf16 v[32:35], v[52:55], v[148:151], v[32:35]
    v_mfma_f32_16x16x32_bf16 v[36:39], v[60:63], v[148:151], v[36:39]
    v_mfma_f32_16x16x32_bf16 v[40:43], v[68:71], v[148:151], v[40:43]
    v_mfma_f32_16x16x32_bf16 v[44:47], v[76:79], v[148:151], v[44:47]
    s_cmp_eq_u32 s42, 0
    s_cbranch_scc1 L_col_z1
L_col_n1:
    s_nop 2
    v_cvt_pk_bf16_f32 v24, v33, v35
    v_cvt_pk_bf16_f32 v25, v37, v39
    v_cvt_pk_bf16_f32 v26, v41, v43
    v_cvt_pk_bf16_f32 v27, v45, v47
    buffer_store_dwordx4 v[24:27], v8, s[8:11], s40 offen offset:0 sc1
    v_cvt_pk_bf16_f32 v28, v32, v34
    v_cvt_pk_bf16_f32 v29, v36, v38
    v_cvt_pk_bf16_f32 v30, v40, v42
    v_cvt_pk_bf16_f32 v31, v44, v46
    buffer_store_dwordx4 v[28:31], v8, s[8:11], s40 offen offset:64 sc1
L_mha_ids:
    s_and_b32 s40, s2, 7
    s_lshr_b32 s41, s2, 3
    s_and_b32 s42, s40, 1
    s_lshl_b32 s42, s42, 4
    s_and_b32 s47, s41, 15
    s_add_u32 s42, s42, s47
    s_lshr_b32 s43, s40, 1
    s_lshl_b32 s43, s43, 1
    s_lshr_b32 s48, s41, 4
    s_add_u32 s43, s43, s48
    s_lshl_b32 s48, s48, 2
    s_add_u32 s51, s47, s48
    s_mul_i32 s46, s42, 49152
    s_add_u32 s46, s46, 0x600000
    s_lshl_b32 s44, s43, 3
    s_add_u32 s44, s44, s3
    s_lshl_b32 s45, s44, 15
    s_lshl_b32 s40, s66, 21
    s_add_u32 s45, s45, s40
    s_add_u32 s45, s45, 0x1700000
    s_lshl_b32 s64, s3, 13
    s_add_u32 s64, s64, 0x12000
    s_cmp_eq_u32 s3, 7
    s_cselect_b32 s64, 0xe000, s64
    v_mov_b32 v149, v1
    v_lshlrev_b32 v150, 2, v2
    v_lshl_add_u32 v151, v3, 9, v150
    s_lshl_b32 s58, s44, 10
    s_lshl_b32 s59, s66, 16
    s_add_u32 s58, s58, s59
    s_add_u32 s58, s58, 0x1610000
    s_and_b32 s59, s51, 7
    s_lshl_b32 s59, s59, 7
    s_add_u32 s59, s59, s58
    v_bfe_u32 v4, v1, 2, 2
    v_lshl_add_u32 v4, v3, 3, v4
    v_lshlrev_b32 v4, 6, v4
    v_bfe_u32 v5, v1, 4, 1
    v_lshl_add_u32 v4, v5, 5, v4
    v_and_b32 v5, 3, v1
    v_lshl_add_u32 v4, v5, 3, v4
    v_add_u32 v7, s64, v4
    s_and_b32 s40, s51, 7
    v_add_u32 v4, s40, v3
    v_cmp_eq_u32 vcc, 0, v4
    v_mov_b32 v8, 0xffff0000
    s_nop 0
    v_cndmask_b32 v8, v8, v4, vcc
    s_lshl_b32 s40, s40, 12
    s_lshr_b32 s68, s42, 3
    s_lshl_b32 s69, s68, 10
    s_add_u32 s69, s69, s40
    s_lshl_b32 s40, s44, 15
    s_add_u32 s69, s69, s40
    s_add_u32 s69, s69, 0x200000
    s_lshl_b32 s71, s44, 7
    s_lshl_b32 s40, s42, 2
    s_add_u32 s71, s71, s40
    s_lshl_b32 s40, s66, 13
    s_add_u32 s71, s71, s40
    s_add_u32 s71, s71, 0x1608000
    v_and_b32 v5, 15, v1
    v_lshlrev_b32 v5, 4, v5
    v_lshl_add_u32 v5, v3, 8, v5
    v_add_u32 v6, 0x2000, v9
    s_lshr_b32 s41, s3, 2
    s_lshl_b32 s55, s41, 12
    v_add_u32 v13, s55, v9
    s_add_u32 s55, s55, 0x10000
    v_add_u32 v4, s55, v5
    v_and_b32 v10, 27, v2
    v_cmp_eq_u32 vcc, 16, v10
    v_mov_b32 v10, 0x20010
    v_mov_b32 v11, 0x20000
    v_cndmask_b32 v10, v10, v11, vcc
    v_cmp_gt_u32 s[60:61], 16, v2
    v_mov_b32 v11, 0
    v_mov_b32 v12, 8192
    v_cndmask_b32 v14, v10, v4, s[60:61]
    v_cndmask_b32 v15, v11, v12, s[60:61]
    v_mov_b32 v12, 0xdddddddd
    v_lshrrev_b32 v4, 1, v1
    v_and_b32 v10, 7, v4
    v_lshrrev_b32 v4, 3, v4
    v_lshlrev_b32 v10, 9, v10
    v_lshl_add_u32 v4, v4, 13, v10
    v_and_b32 v10, 1, v1
    v_lshl_add_u32 v4, v10, 4, v4
    v_add_u32 v4, 0x20000, v4
    v_add_u32 v10, -1, v10
    v_and_b32 v16, 0x3f803f80, v10
    v_mov_b32 v17, v16
    v_mov_b32 v18, v16
    v_mov_b32 v19, v16
    s_mov_b64 exec, 0xfffff
    ds_write_b128 v4, v[16:19]
    s_mov_b64 exec, -1
    v_mov_b32 v10, 0
    v_mov_b32 v11, 0
    v_mov_b32 v216, 0
    v_mov_b32 v217, 0
    v_mov_b32 v218, 0
    v_mov_b32 v219, 0
    v_mov_b32 v220, 0
    v_mov_b32 v221, 0
    v_mov_b32 v222, 0
    v_mov_b32 v223, 0
    v_mov_b32 v224, 0
    v_mov_b32 v225, 0
    v_mov_b32 v226, 0
    v_mov_b32 v227, 0
    v_mov_b32 v228, 0
    v_mov_b32 v229, 0
    v_mov_b32 v230, 0
    v_mov_b32 v231, 0
    v_mov_b32 v112, 0
    v_mov_b32 v113, 0
    v_mov_b32 v114, 0
    v_mov_b32 v115, 0
    v_mov_b32 v116, 0
    v_mov_b32 v117, 0
    v_mov_b32 v118, 0
    v_mov_b32 v119, 0
    v_mov_b32 v120, 0
    v_mov_b32 v121, 0
    v_mov_b32 v122, 0
    v_mov_b32 v123, 0
    v_mov_b32 v124, 0
    v_mov_b32 v125, 0
    v_mov_b32 v126, 0
    v_mov_b32 v127, 0
    v_mov_b32 v128, 0
    v_mov_b32 v129, 0
    v_mov_b32 v130, 0
    v_mov_b32 v131, 0
    v_mov_b32 v132, 0
    v_mov_b32 v133, 0
    v_mov_b32 v134, 0
    v_mov_b32 v135, 0
    v_mov_b32 v136, 0
    v_mov_b32 v137, 0
    v_mov_b32 v138, 0
    v_mov_b32 v139, 0
    v_mov_b32 v140, 0
    v_mov_b32 v141, 0
    v_mov_b32 v142, 0
    v_mov_b32 v143, 0
    v_mov_b32 v72, 0
    v_mov_b32 v73, 0
    v_mov_b32 v74, 0
    v_mov_b32 v75, 0
    v_mov_b32 v76, 0
    v_mov_b32 v77, 0
    v_mov_b32 v78, 0
    v_mov_b32 v79, 0
    s_lshl_b32 s48, s3, 8
    s_add_u32 s48, s48, 0x21000
    v_lshl_add_u32 v64, v1, 2, s48
    v_and_b32 v65, 48, v1
    v_add_u32 v65, s48, v65
    v_bfe_u32 v4, v1, 4, 1
    v_lshl_add_u32 v66, v4, 9, v5
    s_lshl_b32 s48, s42, 16
    s_add_u32 s48, s48, s65
    s_add_u32 s48, s48, 0xa00000
    s_lshl_b32 s62, s44, 10
    s_add_u32 s62, s62, s48
    s_add_u32 s63, s62, 0x200000
    s_lshl_b32 s52, s3, 10
    v_add_u32 v68, s52, v9
    s_add_u32 s53, s52, 0x10000
    v_add_u32 v69, s53, v66
    s_add_u32 s53, s52, 0x22400
    v_add_u32 v70, s53, v9
    s_and_b32 s40, s3, 3
    s_lshl_b32 s40, s40, 1
    s_add_u32 s40, s40, s41
    s_lshl_b32 s44, s43, 3
    s_add_u32 s44, s44, s40
    s_lshl_b32 s40, s40, 10
    v_add_u32 v5, s40, v9
    v_xor_b32 v71, 1024, v5
    v_add_u32 v71, 0x22400, v71
    v_add_u32 v5, 0x22400, v5
    s_add_u32 s48, s48, s52
    s_add_u32 s49, s52, 8192
    s_add_u32 s50, s43, 1
    s_lshl_b32 s56, s42, 8
    s_lshl_b32 s57, s3, 5
    s_add_u32 s56, s56, s57
    s_lshl_b32 s57, s66, 13
    s_add_u32 s56, s56, s57
    s_add_u32 s56, s56, 0x1604000
    s_lshl_b32 s57, s43, 2
    s_add_u32 s57, s57, s56
    s_mov_b32 s67, 0
    s_mov_b32 s73, 0
    s_mov_b64 s[74:75], -1
    s_cmp_ge_u32 s3, 4
    s_cbranch_scc1 L_mha_wl
L_mha_join:
    s_waitcnt vmcnt(0) lgkmcnt(0)
    s_barrier
L_mha_p1:
    v_mov_b32 v10, 0
    v_mov_b32 v11, 0
    s_add_u32 s54, s51, 0
    s_and_b32 s54, s54, 7
    s_lshl_b32 s54, s54, 12
    s_add_u32 m0, s64, 0
    s_add_u32 s54, s54, s45
    buffer_load_dwordx4 v9, s[8:11], s54 offen offset:0 sc1 lds
    buffer_load_dwordx4 v9, s[8:11], s54 offen offset:1024 sc1 lds
    buffer_load_dwordx4 v9, s[8:11], s54 offen offset:2048 sc1 lds
    buffer_load_dwordx4 v9, s[8:11], s54 offen offset:3072 sc1 lds
L_mha_p1x:
    ds_read_b128 v[16:19], v6 offset:0
    ds_read_b128 v[20:23], v6 offset:1024
    ds_read_b128 v[24:27], v6 offset:32768
    s_waitcnt vmcnt(2)
    s_add_u32 s54, s51, 1
    s_and_b32 s54, s54, 7
    s_lshl_b32 s54, s54, 12
    s_add_u32 m0, s64, 4096
    s_add_u32 s54, s54, s45
    buffer_load_dwordx4 v9, s[8:11], s54 offen offset:0 sc1 lds
    buffer_load_dwordx4 v9, s[8:11], s54 offen offset:1024 sc1 lds
    buffer_load_dwordx4 v9, s[8:11], s54 offen offset:2048 sc1 lds
    buffer_load_dwordx4 v9, s[8:11], s54 offen offset:3072 sc1 lds
    ds_read_b64_tr_b16 v[152:153], v7 offset:0
    ds_read_b64_tr_b16 v[154:155], v7 offset:256
    ds_read_b64_tr_b16 v[156:157], v7 offset:1024
    ds_read_b64_tr_b16 v[158:159], v7 offset:1280
    ds_read_b128 v[28:31], v6 offset:2048
    ds_read_b128 v[32:35], v6 offset:3072
    ds_read_b128 v[36:39], v6 offset:33792
    s_waitcnt lgkmcnt(3)
    v_mfma_f32_32x32x16_bf16 v[80:95], v[16:19], v[152:155], 0
    s_add_u32 s54, s51, 2
    s_and_b32 s54, s54, 7
    s_lshl_b32 s54, s54, 12
    s_add_u32 m0, s64, 0
    s_add_u32 s54, s54, s45
    buffer_load_dwordx4 v9, s[8:11], s54 offen offset:0 sc1 lds
    buffer_load_dwordx4 v9, s[8:11], s54 offen offset:1024 sc1 lds
    v_mfma_f32_32x32x16_bf16 v[80:95], v[20:23], v[156:159], v[80:95]
    s_waitcnt vmcnt(6)
    ds_read_b64_tr_b16 v[160:161], v7 offset:2048
    ds_read_b64_tr_b16 v[162:163], v7 offset:2304
    ds_read_b64_tr_b16 v[164:165], v7 offset:3072
    ds_read_b64_tr_b16 v[166:167], v7 offset:3328
    ds_read_b128 v[40:43], v6 offset:4096
    ds_read_b128 v[44:47], v6 offset:5120
    ds_read_b128 v[48:51], v6 offset:34816
    s_branch L_mha_sq0
L_mha_sb0:
    v_permlane16_swap_b32 v152, v156
    v_permlane16_swap_b32 v153, v157
    v_permlane16_swap_b32 v154, v158
    v_permlane16_swap_b32 v155, v159
    s_setprio 3
    s_waitcnt lgkmcnt(3)
    v_cmp_u_f32 vcc, v80, v80
    s_nop 1
    s_and_b64 vcc, vcc, s[74:75]
    s_cbranch_vccnz L_mha_p1r
    v_mfma_f32_32x32x16_bf16 v[80:95], v[28:31], v[160:163], v[80:95]
    buffer_load_dwordx4 v9, s[8:11], s54 offen offset:2048 sc1 lds
    buffer_load_dwordx4 v9, s[8:11], s54 offen offset:3072 sc1 lds
    v_mfma_f32_16x16x32_bf16 v[96:99], v[152:155], v[24:27], 0
    v_mfma_f32_32x32x16_bf16 v[80:95], v[32:35], v[164:167], v[80:95]
    v_mfma_f32_16x16x32_bf16 v[100:103], v[156:159], v[24:27], 0
    s_waitcnt vmcnt(6)
    ds_read_b64_tr_b16 v[168:169], v7 offset:4096
    ds_read_b64_tr_b16 v[170:171], v7 offset:4352
    ds_read_b64_tr_b16 v[172:173], v7 offset:5120
    ds_read_b64_tr_b16 v[174:175], v7 offset:5376
    ds_read_b128 v[16:19], v6 offset:6144
    ds_read_b128 v[20:23], v6 offset:7168
    ds_read_b128 v[24:27], v6 offset:35840
    s_branch L_mha_sq1
L_mha_sb1:
    v_permlane16_swap_b32 v160, v164
    v_permlane16_swap_b32 v161, v165
    v_permlane16_swap_b32 v162, v166
    v_permlane16_swap_b32 v163, v167
    s_waitcnt lgkmcnt(3)
    v_cmp_u_f32 vcc, v80, v80
    s_nop 1
    s_and_b64 vcc, vcc, s[74:75]
    s_cbranch_vccnz L_mha_p1r
    v_mfma_f32_32x32x16_bf16 v[80:95], v[40:43], v[168:171], v[80:95]
    s_add_u32 s54, s51, 3
    s_and_b32 s54, s54, 7
    s_lshl_b32 s54, s54, 12
    s_add_u32 m0, s64, 4096
    s_add_u32 s54, s54, s45
    buffer_load_dwordx4 v9, s[8:11], s54 offen offset:0 sc1 lds
    buffer_load_dwordx4 v9, s[8:11], s54 offen offset:1024 sc1 lds
    v_mfma_f32_16x16x32_bf16 v[96:99], v[160:163], v[36:39], v[96:99]
    v_mfma_f32_32x32x16_bf16 v[80:95], v[44:47], v[172:175], v[80:95]
    v_mfma_f32_16x16x32_bf16 v[100:103], v[164:167], v[36:39], v[100:103]
    s_waitcnt vmcnt(6)
    ds_read_b64_tr_b16 v[152:153], v7 offset:6144
    ds_read_b64_tr_b16 v[154:155], v7 offset:6400
    ds_read_b64_tr_b16 v[156:157], v7 offset:7168
    ds_read_b64_tr_b16 v[158:159], v7 offset:7424
    ds_read_b128 v[28:31], v6 offset:8192
    ds_read_b128 v[32:35], v6 offset:9216
    ds_read_b128 v[36:39], v6 offset:36864
    v_permlane16_swap_b32 v168, v172
    v_permlane16_swap_b32 v169, v173
    v_permlane16_swap_b32 v170, v174
    v_permlane16_swap_b32 v171, v175
    s_waitcnt lgkmcnt(3)
    v_mfma_f32_32x32x16_bf16 v[80:95], v[16:19], v[152:155], v[80:95]
    buffer_load_dwordx4 v9, s[8:11], s54 offen offset:2048 sc1 lds
    buffer_load_dwordx4 v9, s[8:11], s54 offen offset:3072 sc1 lds
    v_mfma_f32_16x16x32_bf16 v[96:99], v[168:171], v[48:51], v[96:99]
    v_mfma_f32_32x32x16_bf16 v[80:95], v[20:23], v[156:159], v[80:95]
    v_mfma_f32_16x16x32_bf16 v[100:103], v[172:175], v[48:51], v[100:103]
    s_waitcnt vmcnt(6)
    ds_read_b64_tr_b16 v[160:161], v7 offset:0
    ds_read_b64_tr_b16 v[162:163], v7 offset:256
    ds_read_b64_tr_b16 v[164:165], v7 offset:1024
    ds_read_b64_tr_b16 v[166:167], v7 offset:1280
    ds_read_b128 v[40:43], v6 offset:10240
    ds_read_b128 v[44:47], v6 offset:11264
    ds_read_b128 v[48:51], v6 offset:37888
    v_permlane16_swap_b32 v152, v156
    v_permlane16_swap_b32 v153, v157
    v_permlane16_swap_b32 v154, v158
    v_permlane16_swap_b32 v155, v159
    s_waitcnt lgkmcnt(3)
    v_cmp_u_f32 vcc, v80, v80
    s_nop 1
    s_and_b64 vcc, vcc, s[74:75]
    s_cbranch_vccnz L_mha_p1r
    v_mfma_f32_32x32x16_bf16 v[80:95], v[28:31], v[160:163], v[80:95]
    s_add_u32 s54, s51, 4
    s_and_b32 s54, s54, 7
    s_lshl_b32 s54, s54, 12
    s_add_u32 m0, s64, 0
    s_add_u32 s54, s54, s45
    buffer_load_dwordx4 v9, s[8:11], s54 offen offset:0 sc1 lds
    buffer_load_dwordx4 v9, s[8:11], s54 offen offset:1024 sc1 lds
    v_mfma_f32_16x16x32_bf16 v[96:99], v[152:155], v[24:27], v[96:99]
    v_mfma_f32_32x32x16_bf16 v[80:95], v[32:35], v[164:167], v[80:95]
    v_mfma_f32_16x16x32_bf16 v[100:103], v[156:159], v[24:27], v[100:103]
    s_waitcnt vmcnt(6)
    ds_read_b64_tr_b16 v[168:169], v7 offset:2048
    ds_read_b64_tr_b16 v[170:171], v7 offset:2304
    ds_read_b64_tr_b16 v[172:173], v7 offset:3072
    ds_read_b64_tr_b16 v[174:175], v7 offset:3328
    ds_read_b128 v[16:19], v6 offset:12288
    ds_read_b128 v[20:23], v6 offset:13312
    ds_read_b128 v[24:27], v6 offset:38912
    v_permlane16_swap_b32 v160, v164
    v_permlane16_swap_b32 v161, v165
    v_permlane16_swap_b32 v162, v166
    v_permlane16_swap_b32 v163, v167
    s_setprio 2
    s_waitcnt lgkmcnt(3)
    v_mfma_f32_32x32x16_bf16 v[80:95], v[40:43], v[168:171], v[80:95]
    buffer_load_dwordx4 v9, s[8:11], s54 offen offset:2048 sc1 lds
    buffer_load_dwordx4 v9, s[8:11], s54 offen offset:3072 sc1 lds
    v_mfma_f32_16x16x32_bf16 v[96:99], v[160:163], v[36:39], v[96:99]
    v_mfma_f32_32x32x16_bf16 v[80:95], v[44:47], v[172:175], v[80:95]
    v_mfma_f32_16x16x32_bf16 v[100:103], v[164:167], v[36:39], v[100:103]
    s_waitcnt vmcnt(6)
    ds_read_b64_tr_b16 v[152:153], v7 offset:4096
    ds_read_b64_tr_b16 v[154:155], v7 offset:4352
    ds_read_b64_tr_b16 v[156:157], v7 offset:5120
    ds_read_b64_tr_b16 v[158:159], v7 offset:5376
    ds_read_b128 v[28:31], v6 offset:14336
    ds_read_b128 v[32:35], v6 offset:15360
    ds_read_b128 v[36:39], v6 offset:39936
    v_permlane16_swap_b32 v168, v172
    v_permlane16_swap_b32 v169, v173
    v_permlane16_swap_b32 v170, v174
    v_permlane16_swap_b32 v171, v175
    s_waitcnt lgkmcnt(3)
    v_mfma_f32_32x32x16_bf16 v[80:95], v[16:19], v[152:155], v[80:95]
    s_add_u32 s54, s51, 5
    s_and_b32 s54, s54, 7
    s_lshl_b32 s54, s54, 12
    s_add_u32 m0, s64, 4096
    s_add_u32 s54, s54, s45
    buffer_load_dwordx4 v9, s[8:11], s54 offen offset:0 sc1 lds
    buffer_load_dwordx4 v9, s[8:11], s54 offen offset:1024 sc1 lds
    v_mfma_f32_16x16x32_bf16 v[96:99], v[168:171], v[48:51], v[96:99]
    v_mfma_f32_32x32x16_bf16 v[80:95], v[20:23], v[156:159], v[80:95]
    v_mfma_f32_16x16x32_bf16 v[100:103], v[172:175], v[48:51], v[100:103]
    s_waitcnt vmcnt(6)
    ds_read_b64_tr_b16 v[160:161], v7 offset:6144
    ds_read_b64_tr_b16 v[162:163], v7 offset:6400
    ds_read_b64_tr_b16 v[164:165], v7 offset:7168
    ds_read_b64_tr_b16 v[166:167], v7 offset:7424
    ds_read_b128 v[40:43], v6 offset:16384
    ds_read_b128 v[44:47], v6 offset:17408
    ds_read_b128 v[48:51], v6 offset:40960
    v_permlane16_swap_b32 v152, v156
    v_permlane16_swap_b32 v153, v157
    v_permlane16_swap_b32 v154, v158
    v_permlane16_swap_b32 v155, v159
    s_waitcnt lgkmcnt(3)
    v_mfma_f32_32x32x16_bf16 v[80:95], v[28:31], v[160:163], v[80:95]
    buffer_load_dwordx4 v9, s[8:11], s54 offen offset:2048 sc1 lds
    buffer_load_dwordx4 v9, s[8:11], s54 offen offset:3072 sc1 lds
    v_mfma_f32_16x16x32_bf16 v[96:99], v[152:155], v[24:27], v[96:99]
    v_mfma_f32_32x32x16_bf16 v[80:95], v[32:35], v[164:167], v[80:95]
    v_mfma_f32_16x16x32_bf16 v[100:103], v[156:159], v[24:27], v[100:103]
    s_waitcnt vmcnt(6)
    ds_read_b64_tr_b16 v[168:169], v7 offset:0
    ds_read_b64_tr_b16 v[170:171], v7 offset:256
    ds_read_b64_tr_b16 v[172:173], v7 offset:1024
    ds_read_b64_tr_b16 v[174:175], v7 offset:1280
    ds_read_b128 v[16:19], v6 offset:18432
    ds_read_b128 v[20:23], v6 offset:19456
    ds_read_b128 v[24:27], v6 offset:41984
    v_permlane16_swap_b32 v160, v164
    v_permlane16_swap_b32 v161, v165
    v_permlane16_swap_b32 v162, v166
    v_permlane16_swap_b32 v163, v167
    s_waitcnt lgkmcnt(3)
    v_cmp_u_f32 vcc, v80, v80
    s_nop 1
    s_and_b64 vcc, vcc, s[74:75]
    s_cbranch_vccnz L_mha_p1r
    v_mfma_f32_32x32x16_bf16 v[80:95], v[40:43], v[168:171], v[80:95]
    s_add_u32 s54, s51, 6
    s_and_b32 s54, s54, 7
    s_lshl_b32 s54, s54, 12
    s_add_u32 m0, s64, 0
    s_add_u32 s54, s54, s45
    buffer_load_dwordx4 v9, s[8:11], s54 offen offset:0 sc1 lds
    buffer_load_dwordx4 v9, s[8:11], s54 offen offset:1024 sc1 lds
    v_mfma_f32_16x16x32_bf16 v[96:99], v[160:163], v[36:39], v[96:99]
    v_mfma_f32_32x32x16_bf16 v[80:95], v[44:47], v[172:175], v[80:95]
    v_mfma_f32_16x16x32_bf16 v[100:103], v[164:167], v[36:39], v[100:103]
    s_waitcnt vmcnt(6)
    ds_read_b64_tr_b16 v[152:153], v7 offset:2048
    ds_read_b64_tr_b16 v[154:155], v7 offset:2304
    ds_read_b64_tr_b16 v[156:157], v7 offset:3072
    ds_read_b64_tr_b16 v[158:159], v7 offset:3328
    ds_read_b128 v[28:31], v6 offset:20480
    ds_read_b128 v[32:35], v6 offset:21504
    ds_read_b128 v[36:39], v6 offset:43008
    v_permlane16_swap_b32 v168, v172
    v_permlane16_swap_b32 v169, v173
    v_permlane16_swap_b32 v170, v174
    v_permlane16_swap_b32 v171, v175
    s_setprio 1
    s_waitcnt lgkmcnt(3)
    v_mfma_f32_32x32x16_bf16 v[80:95], v[16:19], v[152:155], v[80:95]
    buffer_load_dwordx4 v9, s[8:11], s54 offen offset:2048 sc1 lds
    buffer_load_dwordx4 v9, s[8:11], s54 offen offset:3072 sc1 lds
    v_mfma_f32_16x16x32_bf16 v[96:99], v[168:171], v[48:51], v[96:99]
    v_mfma_f32_32x32x16_bf16 v[80:95], v[20:23], v[156:159], v[80:95]
    v_mfma_f32_16x16x32_bf16 v[100:103], v[172:175], v[48:51], v[100:103]
    s_waitcnt vmcnt(6)
    ds_read_b64_tr_b16 v[160:161], v7 offset:4096
    ds_read_b64_tr_b16 v[162:163], v7 offset:4352
    ds_read_b64_tr_b16 v[164:165], v7 offset:5120
    ds_read_b64_tr_b16 v[166:167], v7 offset:5376
    ds_read_b128 v[40:43], v6 offset:22528
    ds_read_b128 v[44:47], v6 offset:23552
    ds_read_b128 v[48:51], v6 offset:44032
    v_permlane16_swap_b32 v152, v156
    v_permlane16_swap_b32 v153, v157
    v_permlane16_swap_b32 v154, v158
    v_permlane16_swap_b32 v155, v159
    s_waitcnt lgkmcnt(3)
    v_mfma_f32_32x32x16_bf16 v[80:95], v[28:31], v[160:163], v[80:95]
    s_add_u32 s54, s51, 7
    s_and_b32 s54, s54, 7
    s_lshl_b32 s54, s54, 12
    s_add_u32 m0, s64, 4096
    s_add_u32 s54, s54, s45
    buffer_load_dwordx4 v9, s[8:11], s54 offen offset:0 sc1 lds
    buffer_load_dwordx4 v9, s[8:11], s54 offen offset:1024 sc1 lds
    v_mfma_f32_16x16x32_bf16 v[96:99], v[152:155], v[24:27], v[96:99]
    v_mfma_f32_32x32x16_bf16 v[80:95], v[32:35], v[164:167], v[80:95]
    v_mfma_f32_16x16x32_bf16 v[100:103], v[156:159], v[24:27], v[100:103]
    s_waitcnt vmcnt(6)
    ds_read_b64_tr_b16 v[168:169], v7 offset:6144
    ds_read_b64_tr_b16 v[170:171], v7 offset:6400
    ds_read_b64_tr_b16 v[172:173], v7 offset:7168
    ds_read_b64_tr_b16 v[174:175], v7 offset:7424
    ds_read_b128 v[16:19], v6 offset:24576
    ds_read_b128 v[20:23], v6 offset:25600
    ds_read_b128 v[24:27], v6 offset:45056
    v_permlane16_swap_b32 v160, v164
    v_permlane16_swap_b32 v161, v165
    v_permlane16_swap_b32 v162, v166
    v_permlane16_swap_b32 v163, v167
    buffer_load_dword v144, v151, s[8:11], s58 offen offset:0 sc1
    buffer_load_dword v145, v151, s[8:11], s58 offen offset:128 sc1
    buffer_load_dword v146, v151, s[8:11], s58 offen offset:256 sc1
    buffer_load_dword v147, v151, s[8:11], s58 offen offset:384 sc1
    s_waitcnt lgkmcnt(3)
    v_mfma_f32_32x32x16_bf16 v[80:95], v[40:43], v[168:171], v[80:95]
    buffer_load_dwordx4 v9, s[8:11], s54 offen offset:2048 sc1 lds
    buffer_load_dwordx4 v9, s[8:11], s54 offen offset:3072 sc1 lds
    v_mfma_f32_16x16x32_bf16 v[96:99], v[160:163], v[36:39], v[96:99]
    v_mfma_f32_32x32x16_bf16 v[80:95], v[44:47], v[172:175], v[80:95]
    v_mfma_f32_16x16x32_bf16 v[100:103], v[164:167], v[36:39], v[100:103]
    s_waitcnt vmcnt(10)
    ds_read_b64_tr_b16 v[152:153], v7 offset:0
    ds_read_b64_tr_b16 v[154:155], v7 offset:256
    ds_read_b64_tr_b16 v[156:157], v7 offset:1024
    ds_read_b64_tr_b16 v[158:159], v7 offset:1280
    ds_read_b128 v[28:31], v6 offset:26624
    ds_read_b128 v[32:35], v6 offset:27648
    ds_read_b128 v[36:39], v6 offset:46080
    v_permlane16_swap_b32 v168, v172
    v_permlane16_swap_b32 v169, v173
    v_permlane16_swap_b32 v170, v174
    v_permlane16_swap_b32 v171, v175
    s_waitcnt lgkmcnt(3)
    v_mfma_f32_32x32x16_bf16 v[80:95], v[16:19], v[152:155], v[80:95]
    v_mfma_f32_16x16x32_bf16 v[96:99], v[168:171], v[48:51], v[96:99]
    v_mfma_f32_32x32x16_bf16 v[80:95], v[20:23], v[156:159], v[80:95]
    v_mfma_f32_16x16x32_bf16 v[100:103], v[172:175], v[48:51], v[100:103]
    s_waitcnt vmcnt(8)
    ds_read_b64_tr_b16 v[160:161], v7 offset:2048
    ds_read_b64_tr_b16 v[162:163], v7 offset:2304
    ds_read_b64_tr_b16 v[164:165], v7 offset:3072
    ds_read_b64_tr_b16 v[166:167], v7 offset:3328
    ds_read_b128 v[40:43], v6 offset:28672
    ds_read_b128 v[44:47], v6 offset:29696
    ds_read_b128 v[48:51], v6 offset:47104
    v_permlane16_swap_b32 v152, v156
    v_permlane16_swap_b32 v153, v157
    v_permlane16_swap_b32 v154, v158
    v_permlane16_swap_b32 v155, v159
    s_setprio 0
    s_waitcnt lgkmcnt(3)
    v_mfma_f32_32x32x16_bf16 v[80:95], v[28:31], v[160:163], v[80:95]
    v_mfma_f32_16x16x32_bf16 v[96:99], v[152:155], v[24:27], v[96:99]
    v_mfma_f32_32x32x16_bf16 v[80:95], v[32:35], v[164:167], v[80:95]
    v_mfma_f32_16x16x32_bf16 v[100:103], v[156:159], v[24:27], v[100:103]
    s_waitcnt vmcnt(6)
    ds_read_b64_tr_b16 v[168:169], v7 offset:4096
    ds_read_b64_tr_b16 v[170:171], v7 offset:4352
    ds_read_b64_tr_b16 v[172:173], v7 offset:5120
    ds_read_b64_tr_b16 v[174:175], v7 offset:5376
    ds_read_b128 v[16:19], v6 offset:30720
    ds_read_b128 v[20:23], v6 offset:31744
    ds_read_b128 v[24:27], v6 offset:48128
    v_permlane16_swap_b32 v160, v164
    v_permlane16_swap_b32 v161, v165
    v_permlane16_swap_b32 v162, v166
    v_permlane16_swap_b32 v163, v167
    s_waitcnt lgkmcnt(3)
    v_mfma_f32_32x32x16_bf16 v[80:95], v[40:43], v[168:171], v[80:95]
    v_mfma_f32_16x16x32_bf16 v[96:99], v[160:163], v[36:39], v[96:99]
    v_mfma_f32_32x32x16_bf16 v[80:95], v[44:47], v[172:175], v[80:95]
    v_mfma_f32_16x16x32_bf16 v[100:103], v[164:167], v[36:39], v[100:103]
    s_waitcnt vmcnt(0)
    ds_read_b64_tr_b16 v[152:153], v7 offset:6144
    ds_read_b64_tr_b16 v[154:155], v7 offset:6400
    ds_read_b64_tr_b16 v[156:157], v7 offset:7168
    ds_read_b64_tr_b16 v[158:159], v7 offset:7424
    v_permlane16_swap_b32 v168, v172
    v_permlane16_swap_b32 v169, v173
    v_permlane16_swap_b32 v170, v174
    v_permlane16_swap_b32 v171, v175
    s_waitcnt vmcnt(2)
    v_or3_b32 v4, v144, v145, v146
    v_or_b32 v4, v4, v147
    v_cmp_gt_i32 vcc, 0, v4
    s_nop 1
    s_cbranch_vccnz L_mha_ps
L_mha_ps1:
    v_add_f32 v10, v144, v145
    v_add_f32 v11, v146, v147
    v_add_f32 v10, v10, v11
    v_mov_b32 v11, v10
    s_nop 1
    v_permlane32_swap_b32 v10, v11
    v_add_f32 v10, v10, v11
    v_mov_b32 v11, 0x3727c5ac
    v_fmac_f32 v11, 0x3b000000, v10
    v_rsq_f32 v10, v11
    s_nop 0
    ds_write_b32 v64, v10
    ds_read_b128 v[104:107], v65
    ds_read_b128 v[108:111], v65 offset:64
    s_waitcnt lgkmcnt(3)
    v_mfma_f32_32x32x16_bf16 v[80:95], v[16:19], v[152:155], v[80:95]
    v_mfma_f32_16x16x32_bf16 v[96:99], v[168:171], v[48:51], v[96:99]
    v_mfma_f32_32x32x16_bf16 v[80:95], v[20:23], v[156:159], v[80:95]
    v_mfma_f32_16x16x32_bf16 v[100:103], v[172:175], v[48:51], v[100:103]
    v_permlane16_swap_b32 v152, v156
    v_permlane16_swap_b32 v153, v157
    v_permlane16_swap_b32 v154, v158
    v_permlane16_swap_b32 v155, v159
    s_nop 1
    v_mfma_f32_16x16x32_bf16 v[96:99], v[152:155], v[24:27], v[96:99]
    v_mfma_f32_16x16x32_bf16 v[100:103], v[156:159], v[24:27], v[100:103]
    s_nop 2
    v_cmp_u_f32 vcc, v80, v80
    s_nop 1
    s_and_b64 vcc, vcc, s[74:75]
    s_cbranch_vccnz L_mha_p1r
    v_and_b32 v8, 7, v1
    v_lshlrev_b32 v8, 2, v8
    v_mov_b32 v0, 0
    v_mov_b32 v1, 1
    v_mov_b32 v6, v13
    v_mov_b32 v7, v14
    v_mov_b32 v44, 0
    v_mov_b32 v45, 0
    v_mov_b32 v46, 0
    v_mov_b32 v47, 0
    v_mul_f32 v88, v10, v88
    v_mul_f32 v89, v10, v89
    v_mul_f32 v90, v10, v90
    v_mul_f32 v91, v10, v91
    v_mul_f32 v92, v10, v92
    v_mul_f32 v93, v10, v93
    v_mul_f32 v94, v10, v94
    v_mul_f32 v95, v10, v95
    v_cvt_pk_bf16_f32 v56, v88, v89
    v_cvt_pk_bf16_f32 v57, v90, v91
    v_cvt_pk_bf16_f32 v58, v92, v93
    v_cvt_pk_bf16_f32 v59, v94, v95
    buffer_store_dwordx4 v[56:59], v9, s[8:11], s62 offen sc1
    ds_write_b128 v68, v[56:59]
    s_waitcnt lgkmcnt(1)
    v_mul_f32 v96, v96, v104
    v_mul_f32 v97, v97, v105
    v_mul_f32 v98, v98, v106
    v_mul_f32 v99, v99, v107
    v_mul_f32 v100, v100, v108
    v_mul_f32 v101, v101, v109
    v_mul_f32 v102, v102, v110
    v_mul_f32 v103, v103, v111
    v_cvt_pk_bf16_f32 v60, v96, v97
    v_cvt_pk_bf16_f32 v61, v98, v99
    v_cvt_pk_bf16_f32 v62, v100, v101
    v_cvt_pk_bf16_f32 v63, v102, v103
    s_nop 0
    v_permlane16_swap_b32 v60, v62
    v_permlane16_swap_b32 v61, v63
    buffer_store_dwordx4 v[60:63], v66, s[8:11], s63 offen sc1
    ds_write_b128 v69, v[60:63]
    buffer_store_dwordx4 v[232:235], v9, s[8:11], s69 offen sc1
    v_mul_f32 v80, v10, v80
    v_mul_f32 v81, v10, v81
    v_mul_f32 v82, v10, v82
    v_mul_f32 v83, v10, v83
    v_mul_f32 v84, v10, v84
    v_mul_f32 v85, v10, v85
    v_mul_f32 v86, v10, v86
    v_mul_f32 v87, v10, v87
    v_cvt_pk_bf16_f32 v48, v80, v81
    v_cvt_pk_bf16_f32 v49, v82, v83
    v_cvt_pk_bf16_f32 v50, v84, v85
    v_cvt_pk_bf16_f32 v51, v86, v87
    ds_write_b128 v70, v[48:51]
    v_mov_b32 v52, 0
    v_dot2c_f32_bf16 v52, v48, v56
    v_dot2c_f32_bf16 v52, v49, v57
    v_dot2c_f32_bf16 v52, v50, v58
    v_dot2c_f32_bf16 v52, v51, v59
    s_nop 2
    v_mov_b32 v53, v52
    s_nop 1
    v_permlane32_swap_b32 v52, v53
    v_sub_f32_e64 v54, -v52, v53
    v_sub_f32_e64 v55, -v52, v53
    v_mov_b32 v52, v54
    v_mov_b32 v53, v54
    ds_write_b128 v70, v[52:55] offset:8192
    v_mov_b32 v4, v71
    v_mov_b32 v151, v150
    s_cmp_lt_u32 s3, 4
    s_cbranch_scc1 L_mha_np
    s_setprio 1
L_mha_np:
    s_waitcnt lgkmcnt(0)
    s_barrier
    ds_read_b128 v[16:19], v4
    ds_read_b128 v[80:83], v4 offset:8192
    ds_read_b128 v[84:87], v4 offset:8192
    ds_read_b128 v[88:91], v4 offset:8192
    ds_read_b128 v[92:95], v4 offset:8192
    ds_read_b128 v[24:27], v6 offset:0
    ds_read_b128 v[20:23], v5
    ds_read_b128 v[96:99], v5 offset:8192
    ds_read_b128 v[100:103], v5 offset:8192
    ds_read_b128 v[104:107], v5 offset:8192
    ds_read_b128 v[108:111], v5 offset:8192
    ds_read_b128 v[32:35], v7 offset:0
    ds_read_b128 v[36:39], v7 offset:512
    ds_read_b128 v[28:31], v6 offset:1024
    s_waitcnt lgkmcnt(8)
    v_mfma_f32_32x32x16_bf16 v[48:63], v[24:27], v[16:19], v[80:95]
    s_waitcnt lgkmcnt(3)
    s_nop 10
    v_exp_f32 v48, v48
    v_exp_f32 v49, v49
    v_smfmac_f32_32x32x32_bf16 v[128:143], v[44:47], v[72:79], v12
    s_waitcnt vmcnt(0)
    buffer_store_dword v1, v0, s[8:11], s57 offen sc1
    buffer_store_dword v1, v0, s[8:11], s71 offen sc1
    ds_read_b128 v[40:43], v7 offset:1024
    ds_read_b128 v[44:47], v7 offset:1536
    v_exp_f32 v50, v50
    v_exp_f32 v51, v51
    v_exp_f32 v52, v52
    v_mfma_f32_32x32x16_bf16 v[64:79], v[24:27], v[20:23], v[96:111]
    ds_read_b128 v[24:27], v6 offset:2048
    v_exp_f32 v53, v53
    v_exp_f32 v54, v54
    v_exp_f32 v55, v55
    v_exp_f32 v56, v56
    v_exp_f32 v57, v57
    s_waitcnt lgkmcnt(3)
    v_smfmac_f32_32x32x32_bf16 v[112:127], v[32:35], v[48:55], v12
    v_exp_f32 v58, v58
    v_exp_f32 v59, v59
    v_exp_f32 v60, v60
    v_exp_f32 v61, v61
    v_exp_f32 v62, v62
    v_exp_f32 v63, v63
    v_exp_f32 v64, v64
    v_exp_f32 v65, v65
    v_smfmac_f32_32x32x32_bf16 v[112:127], v[36:39], v[56:63], v12
    v_exp_f32 v66, v66
    v_exp_f32 v67, v67
    v_exp_f32 v68, v68
    v_mfma_f32_32x32x16_bf16 v[48:63], v[28:31], v[16:19], v[80:95]
    v_exp_f32 v69, v69
    v_exp_f32 v70, v70
    v_exp_f32 v71, v71
    v_exp_f32 v72, v72
    v_exp_f32 v73, v73
    v_smfmac_f32_32x32x32_bf16 v[128:143], v[32:35], v[64:71], v12
    v_exp_f32 v74, v74
    v_exp_f32 v75, v75
    v_exp_f32 v76, v76
    v_exp_f32 v77, v77
    v_exp_f32 v78, v78
    v_exp_f32 v79, v79
    v_exp_f32 v48, v48
    v_exp_f32 v49, v49
    v_smfmac_f32_32x32x32_bf16 v[128:143], v[36:39], v[72:79], v12
    ds_read_b128 v[32:35], v7 offset:2048
    ds_read_b128 v[36:39], v7 offset:2560
    v_exp_f32 v50, v50
    v_exp_f32 v51, v51
    v_exp_f32 v52, v52
    v_mfma_f32_32x32x16_bf16 v[64:79], v[28:31], v[20:23], v[96:111]
    ds_read_b128 v[28:31], v6 offset:3072
    v_exp_f32 v53, v53
    v_exp_f32 v54, v54
    v_exp_f32 v55, v55
    v_exp_f32 v56, v56
    v_exp_f32 v57, v57
    s_waitcnt lgkmcnt(3)
    v_smfmac_f32_32x32x32_bf16 v[112:127], v[40:43], v[48:55], v12
    v_exp_f32 v58, v58
    v_exp_f32 v59, v59
    v_exp_f32 v60, v60
    v_exp_f32 v61, v61
    v_exp_f32 v62, v62
    v_exp_f32 v63, v63
    v_exp_f32 v64, v64
    v_exp_f32 v65, v65
    v_smfmac_f32_32x32x32_bf16 v[112:127], v[44:47], v[56:63], v12
    buffer_load_dword v2, v8, s[8:11], s56 offen sc1
    v_exp_f32 v66, v66
    v_exp_f32 v67, v67
    v_exp_f32 v68, v68
    v_mfma_f32_32x32x16_bf16 v[48:63], v[24:27], v[16:19], v[80:95]
    v_exp_f32 v69, v69
    v_exp_f32 v70, v70
    v_exp_f32 v71, v71
    v_exp_f32 v72, v72
    v_exp_f32 v73, v73
    v_smfmac_f32_32x32x32_bf16 v[128:143], v[40:43], v[64:71], v12
    v_exp_f32 v74, v74
    v_exp_f32 v75, v75
    v_exp_f32 v76, v76
    v_exp_f32 v77, v77
    v_exp_f32 v78, v78
    v_exp_f32 v79, v79
    v_exp_f32 v48, v48
    v_exp_f32 v49, v49
    v_smfmac_f32_32x32x32_bf16 v[128:143], v[44:47], v[72:79], v12
    ds_read_b128 v[40:43], v7 offset:3072
    ds_read_b128 v[44:47], v7 offset:3584
    v_exp_f32 v50, v50
    v_exp_f32 v51, v51
    v_exp_f32 v52, v52
    v_mfma_f32_32x32x16_bf16 v[64:79], v[24:27], v[20:23], v[96:111]
    v_exp_f32 v53, v53
    v_exp_f32 v54, v54
    v_exp_f32 v55, v55
    v_exp_f32 v56, v56
    v_exp_f32 v57, v57
    s_waitcnt lgkmcnt(2)
    v_smfmac_f32_32x32x32_bf16 v[112:127], v[32:35], v[48:55], v12
    v_exp_f32 v58, v58
    v_exp_f32 v59, v59
    v_exp_f32 v60, v60
    v_exp_f32 v61, v61
    v_exp_f32 v62, v62
    v_exp_f32 v63, v63
    v_exp_f32 v64, v64
    v_exp_f32 v65, v65
    v_smfmac_f32_32x32x32_bf16 v[112:127], v[36:39], v[56:63], v12
    s_waitcnt vmcnt(0)
    v_cmp_ne_u32 vcc, 1, v2
    s_nop 1
    s_cbranch_vccnz L_mha_re0
    s_and_b32 s51, s50, 7
    s_lshl_b32 s51, s51, 13
    s_mov_b32 m0, s49
    s_add_u32 s51, s51, s48
    buffer_load_dwordx4 v9, s[8:11], s51 offen sc1 lds
    s_add_u32 m0, s49, 0x10000
    s_add_u32 s51, s51, 0x200000
    buffer_load_dwordx4 v9, s[8:11], s51 offen sc1 lds
    s_add_u32 s49, s49, 8192
    s_add_u32 s50, s50, 1
    s_and_b32 s51, s50, 7
    s_lshl_b32 s51, s51, 13
    s_mov_b32 m0, s49
    s_add_u32 s51, s51, s48
    buffer_load_dwordx4 v9, s[8:11], s51 offen sc1 lds
    s_add_u32 m0, s49, 0x10000
    s_add_u32 s51, s51, 0x200000
    buffer_load_dwordx4 v9, s[8:11], s51 offen sc1 lds
    s_add_u32 s49, s49, 8192
    s_add_u32 s50, s50, 1
    s_mov_b32 s67, 1
L_mha_nr0:
    v_exp_f32 v66, v66
    v_exp_f32 v67, v67
    v_exp_f32 v68, v68
    v_mfma_f32_32x32x16_bf16 v[48:63], v[28:31], v[16:19], v[80:95]
    v_exp_f32 v69, v69
    v_exp_f32 v70, v70
    v_exp_f32 v71, v71
    v_exp_f32 v72, v72
    v_exp_f32 v73, v73
    v_smfmac_f32_32x32x32_bf16 v[128:143], v[32:35], v[64:71], v12
    v_exp_f32 v74, v74
    v_exp_f32 v75, v75
    v_exp_f32 v76, v76
    v_exp_f32 v77, v77
    v_exp_f32 v78, v78
    v_exp_f32 v79, v79
    v_exp_f32 v48, v48
    v_exp_f32 v49, v49
    v_smfmac_f32_32x32x32_bf16 v[128:143], v[36:39], v[72:79], v12
    v_exp_f32 v50, v50
    v_exp_f32 v51, v51
    v_exp_f32 v52, v52
    v_mfma_f32_32x32x16_bf16 v[64:79], v[28:31], v[20:23], v[96:111]
    v_exp_f32 v53, v53
    v_exp_f32 v54, v54
    v_exp_f32 v55, v55
    v_exp_f32 v56, v56
    v_exp_f32 v57, v57
    s_waitcnt lgkmcnt(0)
    v_smfmac_f32_32x32x32_bf16 v[112:127], v[40:43], v[48:55], v12
    v_exp_f32 v58, v58
    v_exp_f32 v59, v59
    v_exp_f32 v60, v60
    v_exp_f32 v61, v61
    v_exp_f32 v62, v62
    v_exp_f32 v63, v63
    v_exp_f32 v64, v64
    v_exp_f32 v65, v65
    v_smfmac_f32_32x32x32_bf16 v[112:127], v[44:47], v[56:63], v12
    s_cmp_eq_u32 s67, 1
    s_cbranch_scc1 L_mha_nr1
    s_waitcnt vmcnt(0)
    v_cmp_ne_u32 vcc, 1, v2
    s_nop 1
    s_cbranch_vccnz L_mha_re1
    s_and_b32 s51, s50, 7
    s_lshl_b32 s51, s51, 13
    s_mov_b32 m0, s49
    s_add_u32 s51, s51, s48
    buffer_load_dwordx4 v9, s[8:11], s51 offen sc1 lds
    s_add_u32 m0, s49, 0x10000
    s_add_u32 s51, s51, 0x200000
    buffer_load_dwordx4 v9, s[8:11], s51 offen sc1 lds
    s_add_u32 s49, s49, 8192
    s_add_u32 s50, s50, 1
    s_and_b32 s51, s50, 7
    s_lshl_b32 s51, s51, 13
    s_mov_b32 m0, s49
    s_add_u32 s51, s51, s48
    buffer_load_dwordx4 v9, s[8:11], s51 offen sc1 lds
    s_add_u32 m0, s49, 0x10000
    s_add_u32 s51, s51, 0x200000
    buffer_load_dwordx4 v9, s[8:11], s51 offen sc1 lds
    s_add_u32 s49, s49, 8192
    s_add_u32 s50, s50, 1
    s_mov_b32 s67, 1
L_mha_re1:
L_mha_nr1:
    v_exp_f32 v66, v66
    v_exp_f32 v67, v67
    v_exp_f32 v68, v68
    v_exp_f32 v69, v69
    v_exp_f32 v70, v70
    v_exp_f32 v71, v71
    v_exp_f32 v72, v72
    v_exp_f32 v73, v73
    v_smfmac_f32_32x32x32_bf16 v[128:143], v[40:43], v[64:71], v12
    v_exp_f32 v74, v74
    v_exp_f32 v75, v75
    v_exp_f32 v76, v76
    v_exp_f32 v77, v77
    v_exp_f32 v78, v78
    v_exp_f32 v79, v79
    v_add_u32 v6, 8192, v6
    v_add_u32 v7, v15, v7
    s_cmp_eq_u32 s67, 1
    s_cbranch_scc0 L_mha_spin0
L_mha_rdy:
    s_waitcnt vmcnt(2)
    s_barrier
    ds_read_b128 v[24:27], v6 offset:0
    ds_read_b128 v[32:35], v7 offset:0
    ds_read_b128 v[36:39], v7 offset:512
    ds_read_b128 v[28:31], v6 offset:1024
    s_and_b32 s51, s50, 7
    s_lshl_b32 s51, s51, 13
    s_mov_b32 m0, s49
    s_add_u32 s51, s51, s48
    buffer_load_dwordx4 v9, s[8:11], s51 offen sc1 lds
    s_add_u32 m0, s49, 0x10000
    s_add_u32 s51, s51, 0x200000
    buffer_load_dwordx4 v9, s[8:11], s51 offen sc1 lds
    s_add_u32 s49, s49, 8192
    s_add_u32 s50, s50, 1
    s_waitcnt lgkmcnt(3)
    v_mfma_f32_32x32x16_bf16 v[48:63], v[24:27], v[16:19], v[80:95]
    s_nop 11
    v_exp_f32 v48, v48
    v_exp_f32 v49, v49
    v_smfmac_f32_32x32x32_bf16 v[128:143], v[44:47], v[72:79], v12
    ds_read_b128 v[40:43], v7 offset:1024
    ds_read_b128 v[44:47], v7 offset:1536
    v_exp_f32 v50, v50
    v_exp_f32 v51, v51
    v_exp_f32 v52, v52
    v_mfma_f32_32x32x16_bf16 v[64:79], v[24:27], v[20:23], v[96:111]
    ds_read_b128 v[24:27], v6 offset:2048
    v_exp_f32 v53, v53
    v_exp_f32 v54, v54
    v_exp_f32 v55, v55
    v_exp_f32 v56, v56
    v_exp_f32 v57, v57
    s_waitcnt lgkmcnt(3)
    v_smfmac_f32_32x32x32_bf16 v[112:127], v[32:35], v[48:55], v12
    v_exp_f32 v58, v58
    v_exp_f32 v59, v59
    v_exp_f32 v60, v60
    v_exp_f32 v61, v61
    v_exp_f32 v62, v62
    v_exp_f32 v63, v63
    v_exp_f32 v64, v64
    v_exp_f32 v65, v65
    v_smfmac_f32_32x32x32_bf16 v[112:127], v[36:39], v[56:63], v12
    v_exp_f32 v66, v66
    v_exp_f32 v67, v67
    v_exp_f32 v68, v68
    v_mfma_f32_32x32x16_bf16 v[48:63], v[28:31], v[16:19], v[80:95]
    v_exp_f32 v69, v69
    v_exp_f32 v70, v70
    v_exp_f32 v71, v71
    v_exp_f32 v72, v72
    v_exp_f32 v73, v73
    v_smfmac_f32_32x32x32_bf16 v[128:143], v[32:35], v[64:71], v12
    v_exp_f32 v74, v74
    v_exp_f32 v75, v75
    v_exp_f32 v76, v76
    v_exp_f32 v77, v77
    v_exp_f32 v78, v78
    v_exp_f32 v79, v79
    v_exp_f32 v48, v48
    v_exp_f32 v49, v49
    v_smfmac_f32_32x32x32_bf16 v[128:143], v[36:39], v[72:79], v12
    s_and_b32 s51, s50, 7
    s_lshl_b32 s51, s51, 13
    s_mov_b32 m0, s49
    s_add_u32 s51, s51, s48
    buffer_load_dwordx4 v9, s[8:11], s51 offen sc1 lds
    s_add_u32 m0, s49, 0x10000
    s_add_u32 s51, s51, 0x200000
    buffer_load_dwordx4 v9, s[8:11], s51 offen sc1 lds
    s_add_u32 s49, s49, 8192
    s_add_u32 s50, s50, 1
    ds_read_b128 v[32:35], v7 offset:2048
    ds_read_b128 v[36:39], v7 offset:2560
    v_exp_f32 v50, v50
    v_exp_f32 v51, v51
    v_exp_f32 v52, v52
    v_mfma_f32_32x32x16_bf16 v[64:79], v[28:31], v[20:23], v[96:111]
    ds_read_b128 v[28:31], v6 offset:3072
    v_exp_f32 v53, v53
    v_exp_f32 v54, v54
    v_exp_f32 v55, v55
    v_exp_f32 v56, v56
    v_exp_f32 v57, v57
    s_waitcnt lgkmcnt(3)
    v_smfmac_f32_32x32x32_bf16 v[112:127], v[40:43], v[48:55], v12
    v_exp_f32 v58, v58
    v_exp_f32 v59, v59
    v_exp_f32 v60, v60
    v_exp_f32 v61, v61
    v_exp_f32 v62, v62
    v_exp_f32 v63, v63
    v_exp_f32 v64, v64
    v_exp_f32 v65, v65
    v_smfmac_f32_32x32x32_bf16 v[112:127], v[44:47], v[56:63], v12
    v_exp_f32 v66, v66
    v_exp_f32 v67, v67
    v_exp_f32 v68, v68
    v_mfma_f32_32x32x16_bf16 v[48:63], v[24:27], v[16:19], v[80:95]
    v_exp_f32 v69, v69
    v_exp_f32 v70, v70
    v_exp_f32 v71, v71
    v_exp_f32 v72, v72
    v_exp_f32 v73, v73
    v_smfmac_f32_32x32x32_bf16 v[128:143], v[40:43], v[64:71], v12
    v_exp_f32 v74, v74
    v_exp_f32 v75, v75
    v_exp_f32 v76, v76
    v_exp_f32 v77, v77
    v_exp_f32 v78, v78
    v_exp_f32 v79, v79
    v_exp_f32 v48, v48
    v_exp_f32 v49, v49
    v_smfmac_f32_32x32x32_bf16 v[128:143], v[44:47], v[72:79], v12
    s_waitcnt vmcnt(4)
    s_barrier
    s_and_b32 s51, s50, 7
    s_lshl_b32 s51, s51, 13
    s_mov_b32 m0, s49
    s_add_u32 s51, s51, s48
    buffer_load_dwordx4 v9, s[8:11], s51 offen sc1 lds
    s_add_u32 m0, s49, 0x10000
    s_add_u32 s51, s51, 0x200000
    buffer_load_dwordx4 v9, s[8:11], s51 offen sc1 lds
    s_add_u32 s49, s49, 8192
    s_add_u32 s50, s50, 1
    ds_read_b128 v[40:43], v7 offset:3072
    ds_read_b128 v[44:47], v7 offset:3584
    v_exp_f32 v50, v50
    v_exp_f32 v51, v51
    v_exp_f32 v52, v52
    v_mfma_f32_32x32x16_bf16 v[64:79], v[24:27], v[20:23], v[96:111]
    ds_read_b128 v[24:27], v6 offset:8192
    v_exp_f32 v53, v53
    v_exp_f32 v54, v54
    v_exp_f32 v55, v55
    v_exp_f32 v56, v56
    v_exp_f32 v57, v57
    s_waitcnt lgkmcnt(3)
    v_smfmac_f32_32x32x32_bf16 v[112:127], v[32:35], v[48:55], v12
    v_exp_f32 v58, v58
    v_exp_f32 v59, v59
    v_exp_f32 v60, v60
    v_exp_f32 v61, v61
    v_exp_f32 v62, v62
    v_exp_f32 v63, v63
    v_exp_f32 v64, v64
    v_exp_f32 v65, v65
    v_smfmac_f32_32x32x32_bf16 v[112:127], v[36:39], v[56:63], v12
    v_exp_f32 v66, v66
    v_exp_f32 v67, v67
    v_exp_f32 v68, v68
    v_mfma_f32_32x32x16_bf16 v[48:63], v[28:31], v[16:19], v[80:95]
    v_exp_f32 v69, v69
    v_exp_f32 v70, v70
    v_exp_f32 v71, v71
    v_exp_f32 v72, v72
    v_exp_f32 v73, v73
    v_smfmac_f32_32x32x32_bf16 v[128:143], v[32:35], v[64:71], v12
    v_exp_f32 v74, v74
    v_exp_f32 v75, v75
    v_exp_f32 v76, v76
    v_exp_f32 v77, v77
    v_exp_f32 v78, v78
    v_exp_f32 v79, v79
    v_exp_f32 v48, v48
    v_exp_f32 v49, v49
    v_smfmac_f32_32x32x32_bf16 v[128:143], v[36:39], v[72:79], v12
    s_and_b32 s51, s50, 7
    s_lshl_b32 s51, s51, 13
    s_mov_b32 m0, s49
    s_add_u32 s51, s51, s48
    buffer_load_dwordx4 v9, s[8:11], s51 offen sc1 lds
    s_add_u32 m0, s49, 0x10000
    s_add_u32 s51, s51, 0x200000
    buffer_load_dwordx4 v9, s[8:11], s51 offen sc1 lds
    s_add_u32 s49, s49, 8192
    s_add_u32 s50, s50, 1
    ds_read_b128 v[32:35], v7 offset:8192
    ds_read_b128 v[36:39], v7 offset:8704
    v_exp_f32 v50, v50
    v_exp_f32 v51, v51
    v_exp_f32 v52, v52
    v_mfma_f32_32x32x16_bf16 v[64:79], v[28:31], v[20:23], v[96:111]
    ds_read_b128 v[28:31], v6 offset:9216
    v_exp_f32 v53, v53
    v_exp_f32 v54, v54
    v_exp_f32 v55, v55
    v_exp_f32 v56, v56
    v_exp_f32 v57, v57
    s_waitcnt lgkmcnt(3)
    v_smfmac_f32_32x32x32_bf16 v[112:127], v[40:43], v[48:55], v12
    v_exp_f32 v58, v58
    v_exp_f32 v59, v59
    v_exp_f32 v60, v60
    v_exp_f32 v61, v61
    v_exp_f32 v62, v62
    v_exp_f32 v63, v63
    v_exp_f32 v64, v64
    v_exp_f32 v65, v65
    v_smfmac_f32_32x32x32_bf16 v[112:127], v[44:47], v[56:63], v12
    v_exp_f32 v66, v66
    v_exp_f32 v67, v67
    v_exp_f32 v68, v68
    v_mfma_f32_32x32x16_bf16 v[48:63], v[24:27], v[16:19], v[80:95]
    v_exp_f32 v69, v69
    v_exp_f32 v70, v70
    v_exp_f32 v71, v71
    v_exp_f32 v72, v72
    v_exp_f32 v73, v73
    v_smfmac_f32_32x32x32_bf16 v[128:143], v[40:43], v[64:71], v12
    v_add_u32 v6, 8192, v6
    v_add_u32 v7, v15, v7
    v_exp_f32 v74, v74
    v_exp_f32 v75, v75
    v_exp_f32 v76, v76
    v_exp_f32 v77, v77
    v_exp_f32 v78, v78
    v_exp_f32 v79, v79
    v_exp_f32 v48, v48
    v_exp_f32 v49, v49
    v_smfmac_f32_32x32x32_bf16 v[128:143], v[44:47], v[72:79], v12
    s_and_b32 s51, s50, 7
    s_lshl_b32 s51, s51, 13
    s_mov_b32 m0, s49
    s_add_u32 s51, s51, s48
    buffer_load_dwordx4 v9, s[8:11], s51 offen sc1 lds
    s_add_u32 m0, s49, 0x10000
    s_add_u32 s51, s51, 0x200000
    buffer_load_dwordx4 v9, s[8:11], s51 offen sc1 lds
    s_add_u32 s49, s49, 8192
    s_add_u32 s50, s50, 1
    ds_read_b128 v[40:43], v7 offset:1024
    ds_read_b128 v[44:47], v7 offset:1536
    v_exp_f32 v50, v50
    v_exp_f32 v51, v51
    v_exp_f32 v52, v52
    v_mfma_f32_32x32x16_bf16 v[64:79], v[24:27], v[20:23], v[96:111]
    ds_read_b128 v[24:27], v6 offset:2048
    v_exp_f32 v53, v53
    v_exp_f32 v54, v54
    v_exp_f32 v55, v55
    v_exp_f32 v56, v56
    v_exp_f32 v57, v57
    s_waitcnt lgkmcnt(3)
    v_smfmac_f32_32x32x32_bf16 v[112:127], v[32:35], v[48:55], v12
    v_exp_f32 v58, v58
    v_exp_f32 v59, v59
    v_exp_f32 v60, v60
    v_exp_f32 v61, v61
    v_exp_f32 v62, v62
    v_exp_f32 v63, v63
    v_exp_f32 v64, v64
    v_exp_f32 v65, v65
    v_smfmac_f32_32x32x32_bf16 v[112:127], v[36:39], v[56:63], v12
    v_exp_f32 v66, v66
    v_exp_f32 v67, v67
    v_exp_f32 v68, v68
    v_mfma_f32_32x32x16_bf16 v[48:63], v[28:31], v[16:19], v[80:95]
    v_exp_f32 v69, v69
    v_exp_f32 v70, v70
    v_exp_f32 v71, v71
    v_exp_f32 v72, v72
    v_exp_f32 v73, v73
    v_smfmac_f32_32x32x32_bf16 v[128:143], v[32:35], v[64:71], v12
    v_exp_f32 v74, v74
    v_exp_f32 v75, v75
    v_exp_f32 v76, v76
    v_exp_f32 v77, v77
    v_exp_f32 v78, v78
    v_exp_f32 v79, v79
    v_exp_f32 v48, v48
    v_exp_f32 v49, v49
    v_smfmac_f32_32x32x32_bf16 v[128:143], v[36:39], v[72:79], v12
    ds_read_b128 v[32:35], v7 offset:2048
    ds_read_b128 v[36:39], v7 offset:2560
    v_exp_f32 v50, v50
    v_exp_f32 v51, v51
    v_exp_f32 v52, v52
    v_mfma_f32_32x32x16_bf16 v[64:79], v[28:31], v[20:23], v[96:111]
    ds_read_b128 v[28:31], v6 offset:3072
    v_exp_f32 v53, v53
    v_exp_f32 v54, v54
    v_exp_f32 v55, v55
    v_exp_f32 v56, v56
    v_exp_f32 v57, v57
    s_waitcnt lgkmcnt(3)
    v_smfmac_f32_32x32x32_bf16 v[112:127], v[40:43], v[48:55], v12
    v_exp_f32 v58, v58
    v_exp_f32 v59, v59
    v_exp_f32 v60, v60
    v_exp_f32 v61, v61
    v_exp_f32 v62, v62
    v_exp_f32 v63, v63
    v_exp_f32 v64, v64
    v_exp_f32 v65, v65
    v_smfmac_f32_32x32x32_bf16 v[112:127], v[44:47], v[56:63], v12
    v_exp_f32 v66, v66
    v_exp_f32 v67, v67
    v_exp_f32 v68, v68
    v_mfma_f32_32x32x16_bf16 v[48:63], v[24:27], v[16:19], v[80:95]
    v_exp_f32 v69, v69
    v_exp_f32 v70, v70
    v_exp_f32 v71, v71
    v_exp_f32 v72, v72
    v_exp_f32 v73, v73
    v_smfmac_f32_32x32x32_bf16 v[128:143], v[40:43], v[64:71], v12
    v_exp_f32 v74, v74
    v_exp_f32 v75, v75
    v_exp_f32 v76, v76
    v_exp_f32 v77, v77
    v_exp_f32 v78, v78
    v_exp_f32 v79, v79
    v_exp_f32 v48, v48
    v_exp_f32 v49, v49
    v_smfmac_f32_32x32x32_bf16 v[128:143], v[44:47], v[72:79], v12
    s_waitcnt vmcnt(0)
    s_barrier
    ds_read_b128 v[40:43], v7 offset:3072
    ds_read_b128 v[44:47], v7 offset:3584
    v_exp_f32 v50, v50
    v_exp_f32 v51, v51
    v_exp_f32 v52, v52
    v_mfma_f32_32x32x16_bf16 v[64:79], v[24:27], v[20:23], v[96:111]
    ds_read_b128 v[24:27], v6 offset:8192
    v_exp_f32 v53, v53
    v_exp_f32 v54, v54
    v_exp_f32 v55, v55
    v_exp_f32 v56, v56
    v_exp_f32 v57, v57
    s_waitcnt lgkmcnt(3)
    v_smfmac_f32_32x32x32_bf16 v[112:127], v[32:35], v[48:55], v12
    v_exp_f32 v58, v58
    v_exp_f32 v59, v59
    v_exp_f32 v60, v60
    v_exp_f32 v61, v61
    v_exp_f32 v62, v62
    v_exp_f32 v63, v63
    v_exp_f32 v64, v64
    v_exp_f32 v65, v65
    v_smfmac_f32_32x32x32_bf16 v[112:127], v[36:39], v[56:63], v12
    s_lshl_b32 s72, s43, 3
    s_lshr_b32 s73, s42, 2
    s_add_u32 s72, s72, s73
    s_lshl_b32 s69, s72, 7
    s_lshl_b32 s73, s66, 13
    s_add_u32 s69, s69, s73
    s_add_u32 s69, s69, 0x1608000
    buffer_load_dword v2, v151, s[8:11], s69 offen sc1
    v_exp_f32 v66, v66
    v_exp_f32 v67, v67
    v_exp_f32 v68, v68
    v_mfma_f32_32x32x16_bf16 v[48:63], v[28:31], v[16:19], v[80:95]
    v_exp_f32 v69, v69
    v_exp_f32 v70, v70
    v_exp_f32 v71, v71
    v_exp_f32 v72, v72
    v_exp_f32 v73, v73
    v_smfmac_f32_32x32x32_bf16 v[128:143], v[32:35], v[64:71], v12
    v_exp_f32 v74, v74
    v_exp_f32 v75, v75
    v_exp_f32 v76, v76
    v_exp_f32 v77, v77
    v_exp_f32 v78, v78
    v_exp_f32 v79, v79
    v_exp_f32 v48, v48
    v_exp_f32 v49, v49
    v_smfmac_f32_32x32x32_bf16 v[128:143], v[36:39], v[72:79], v12
    ds_read_b128 v[32:35], v7 offset:8192
    ds_read_b128 v[36:39], v7 offset:8704
    v_exp_f32 v50, v50
    v_exp_f32 v51, v51
    v_exp_f32 v52, v52
    v_mfma_f32_32x32x16_bf16 v[64:79], v[28:31], v[20:23], v[96:111]
    ds_read_b128 v[28:31], v6 offset:9216
    v_exp_f32 v53, v53
    v_exp_f32 v54, v54
    v_exp_f32 v55, v55
    v_exp_f32 v56, v56
    v_exp_f32 v57, v57
    s_waitcnt lgkmcnt(3)
    v_smfmac_f32_32x32x32_bf16 v[112:127], v[40:43], v[48:55], v12
    v_exp_f32 v58, v58
    v_exp_f32 v59, v59
    v_exp_f32 v60, v60
    v_exp_f32 v61, v61
    v_exp_f32 v62, v62
    v_exp_f32 v63, v63
    v_exp_f32 v64, v64
    v_exp_f32 v65, v65
    v_smfmac_f32_32x32x32_bf16 v[112:127], v[44:47], v[56:63], v12
    v_exp_f32 v66, v66
    v_exp_f32 v67, v67
    v_exp_f32 v68, v68
    v_mfma_f32_32x32x16_bf16 v[48:63], v[24:27], v[16:19], v[80:95]
    v_exp_f32 v69, v69
    v_exp_f32 v70, v70
    v_exp_f32 v71, v71
    v_exp_f32 v72, v72
    v_exp_f32 v73, v73
    v_smfmac_f32_32x32x32_bf16 v[128:143], v[40:43], v[64:71], v12
    v_add_u32 v6, 8192, v6
    v_add_u32 v7, v15, v7
    v_exp_f32 v74, v74
    v_exp_f32 v75, v75
    v_exp_f32 v76, v76
    v_exp_f32 v77, v77
    v_exp_f32 v78, v78
    v_exp_f32 v79, v79
    v_exp_f32 v48, v48
    v_exp_f32 v49, v49
    v_smfmac_f32_32x32x32_bf16 v[128:143], v[44:47], v[72:79], v12
    s_waitcnt vmcnt(0)
    v_cmp_ne_u32 vcc, 1, v2
    s_nop 1
    s_cbranch_vccnz L_mha_us
L_mha_ub:
    s_and_b32 s73, s42, 3
    s_lshl_b32 s73, s73, 2
    s_and_b32 s74, s3, 3
    s_add_u32 s73, s73, s74
    s_lshl_b32 s74, s73, 15
    s_lshl_b32 s75, s41, 14
    s_add_u32 s74, s74, s75
    s_lshl_b32 s71, s72, 15
    s_add_u32 s71, s71, 0x200000
    s_add_u32 s78, s71, s75
    s_add_u32 s76, s74, 0x1b00000
    s_add_u32 s77, s76, 4096
    s_add_u32 s79, s78, 4096
    s_lshl_b32 s75, s41, 8
    v_xor_b32 v148, s75, v9
    v_mov_b32 v150, v9
    s_lshl_b32 s75, s73, 11
    s_add_u32 s71, s71, s75
    s_lshl_b32 s75, s41, 10
    s_add_u32 s71, s71, s75
    buffer_load_dwordx4 v[144:147], v9, s[8:11], s71 offen sc1
    s_mul_i32 s75, s3, 2560
    s_add_u32 s75, s75, 0x22400
    v_add_u32 v240, s75, v9
    v_lshrrev_b32 v243, 1, v9
    v_add_u32 v241, s75, v243
    s_xor_b32 s75, s3, 4
    s_mul_i32 s75, s75, 2560
    s_add_u32 s75, s75, 0x22400
    v_add_u32 v242, s75, v9
    v_add_u32 v243, s75, v243
    v_mov_b32 v244, 0x4e800000
    s_lshl_b32 s75, s41, 2
    s_add_u32 s75, s75, 0x21a00
    v_mov_b32 v245, s75
    ds_write_b32 v245, v0
    s_lshl_b32 s58, s44, 15
    s_lshl_b32 s59, s42, 10
    s_add_u32 s58, s58, s59
    s_add_u32 s58, s58, s65
    s_add_u32 s58, s58, 0xe00000
    ds_read_b128 v[40:43], v7 offset:1024
    ds_read_b128 v[44:47], v7 offset:1536
    v_exp_f32 v50, v50
    v_exp_f32 v51, v51
    v_exp_f32 v52, v52
    v_mfma_f32_32x32x16_bf16 v[64:79], v[24:27], v[20:23], v[96:111]
    ds_read_b128 v[24:27], v6 offset:2048
    v_exp_f32 v53, v53
    v_exp_f32 v54, v54
    v_exp_f32 v55, v55
    v_exp_f32 v56, v56
    v_exp_f32 v57, v57
    s_waitcnt lgkmcnt(3)
    v_smfmac_f32_32x32x32_bf16 v[112:127], v[32:35], v[48:55], v12
    v_exp_f32 v58, v58
    v_exp_f32 v59, v59
    v_exp_f32 v60, v60
    v_exp_f32 v61, v61
    v_exp_f32 v62, v62
    v_exp_f32 v63, v63
    v_exp_f32 v64, v64
    v_exp_f32 v65, v65
    v_smfmac_f32_32x32x32_bf16 v[112:127], v[36:39], v[56:63], v12
    v_exp_f32 v66, v66
    v_exp_f32 v67, v67
    v_exp_f32 v68, v68
    v_mfma_f32_32x32x16_bf16 v[48:63], v[28:31], v[16:19], v[80:95]
    v_exp_f32 v69, v69
    v_exp_f32 v70, v70
    v_exp_f32 v71, v71
    v_exp_f32 v72, v72
    v_exp_f32 v73, v73
    v_smfmac_f32_32x32x32_bf16 v[128:143], v[32:35], v[64:71], v12
    v_exp_f32 v74, v74
    v_exp_f32 v75, v75
    v_exp_f32 v76, v76
    v_exp_f32 v77, v77
    v_exp_f32 v78, v78
    v_exp_f32 v79, v79
    v_exp_f32 v48, v48
    v_exp_f32 v49, v49
    v_smfmac_f32_32x32x32_bf16 v[128:143], v[36:39], v[72:79], v12
    ds_read_b128 v[32:35], v7 offset:2048
    ds_read_b128 v[36:39], v7 offset:2560
    v_exp_f32 v50, v50
    v_exp_f32 v51, v51
    v_exp_f32 v52, v52
    v_mfma_f32_32x32x16_bf16 v[64:79], v[28:31], v[20:23], v[96:111]
    ds_read_b128 v[28:31], v6 offset:3072
    v_exp_f32 v53, v53
    v_exp_f32 v54, v54
    v_exp_f32 v55, v55
    v_exp_f32 v56, v56
    v_exp_f32 v57, v57
    s_waitcnt lgkmcnt(3)
    v_smfmac_f32_32x32x32_bf16 v[112:127], v[40:43], v[48:55], v12
    v_exp_f32 v58, v58
    v_exp_f32 v59, v59
    v_exp_f32 v60, v60
    v_exp_f32 v61, v61
    v_exp_f32 v62, v62
    v_exp_f32 v63, v63
    v_exp_f32 v64, v64
    v_exp_f32 v65, v65
    v_smfmac_f32_32x32x32_bf16 v[112:127], v[44:47], v[56:63], v12
    v_exp_f32 v66, v66
    v_exp_f32 v67, v67
    v_exp_f32 v68, v68
    v_mfma_f32_32x32x16_bf16 v[48:63], v[24:27], v[16:19], v[80:95]
    v_exp_f32 v69, v69
    v_exp_f32 v70, v70
    v_exp_f32 v71, v71
    v_exp_f32 v72, v72
    v_exp_f32 v73, v73
    v_smfmac_f32_32x32x32_bf16 v[128:143], v[40:43], v[64:71], v12
    v_exp_f32 v74, v74
    v_exp_f32 v75, v75
    v_exp_f32 v76, v76
    v_exp_f32 v77, v77
    v_exp_f32 v78, v78
    v_exp_f32 v79, v79
    v_exp_f32 v48, v48
    v_exp_f32 v49, v49
    v_smfmac_f32_32x32x32_bf16 v[128:143], v[44:47], v[72:79], v12
    ds_read_b128 v[40:43], v7 offset:3072
    ds_read_b128 v[44:47], v7 offset:3584
    v_exp_f32 v50, v50
    v_exp_f32 v51, v51
    v_exp_f32 v52, v52
    v_mfma_f32_32x32x16_bf16 v[64:79], v[24:27], v[20:23], v[96:111]
    ds_read_b128 v[24:27], v6 offset:8192
    v_exp_f32 v53, v53
    v_exp_f32 v54, v54
    v_exp_f32 v55, v55
    v_exp_f32 v56, v56
    v_exp_f32 v57, v57
    s_waitcnt lgkmcnt(3)
    v_smfmac_f32_32x32x32_bf16 v[112:127], v[32:35], v[48:55], v12
    v_exp_f32 v58, v58
    v_exp_f32 v59, v59
    v_exp_f32 v60, v60
    v_exp_f32 v61, v61
    v_exp_f32 v62, v62
    v_exp_f32 v63, v63
    v_exp_f32 v64, v64
    v_exp_f32 v65, v65
    v_smfmac_f32_32x32x32_bf16 v[112:127], v[36:39], v[56:63], v12
    v_exp_f32 v66, v66
    v_exp_f32 v67, v67
    v_exp_f32 v68, v68
    v_mfma_f32_32x32x16_bf16 v[48:63], v[28:31], v[16:19], v[80:95]
    v_exp_f32 v69, v69
    v_exp_f32 v70, v70
    v_exp_f32 v71, v71
    v_exp_f32 v72, v72
    v_exp_f32 v73, v73
    v_smfmac_f32_32x32x32_bf16 v[128:143], v[32:35], v[64:71], v12
    v_exp_f32 v74, v74
    v_exp_f32 v75, v75
    v_exp_f32 v76, v76
    v_exp_f32 v77, v77
    v_exp_f32 v78, v78
    v_exp_f32 v79, v79
    v_exp_f32 v48, v48
    v_exp_f32 v49, v49
    v_smfmac_f32_32x32x32_bf16 v[128:143], v[36:39], v[72:79], v12
    ds_read_b128 v[32:35], v7 offset:8192
    ds_read_b128 v[36:39], v7 offset:8704
    v_exp_f32 v50, v50
    v_exp_f32 v51, v51
    v_exp_f32 v52, v52
    v_mfma_f32_32x32x16_bf16 v[64:79], v[28:31], v[20:23], v[96:111]
    ds_read_b128 v[28:31], v6 offset:9216
    v_exp_f32 v53, v53
    v_exp_f32 v54, v54
    v_exp_f32 v55, v55
    v_exp_f32 v56, v56
    v_exp_f32 v57, v57
    s_waitcnt lgkmcnt(3)
    v_smfmac_f32_32x32x32_bf16 v[112:127], v[40:43], v[48:55], v12
    v_exp_f32 v58, v58
    v_exp_f32 v59, v59
    v_exp_f32 v60, v60
    v_exp_f32 v61, v61
    v_exp_f32 v62, v62
    v_exp_f32 v63, v63
    v_exp_f32 v64, v64
    v_exp_f32 v65, v65
    v_smfmac_f32_32x32x32_bf16 v[112:127], v[44:47], v[56:63], v12
    v_exp_f32 v66, v66
    v_exp_f32 v67, v67
    v_exp_f32 v68, v68
    v_mfma_f32_32x32x16_bf16 v[48:63], v[24:27], v[16:19], v[80:95]
    v_exp_f32 v69, v69
    v_exp_f32 v70, v70
    v_exp_f32 v71, v71
    v_exp_f32 v72, v72
    v_exp_f32 v73, v73
    v_smfmac_f32_32x32x32_bf16 v[128:143], v[40:43], v[64:71], v12
    v_add_u32 v6, 8192, v6
    v_add_u32 v7, v15, v7
    v_exp_f32 v74, v74
    v_exp_f32 v75, v75
    v_exp_f32 v76, v76
    v_exp_f32 v77, v77
    v_exp_f32 v78, v78
    v_exp_f32 v79, v79
    s_cmp_eq_u32 s66, 0
    s_cbranch_scc0 L_mha_x45
    v_exp_f32 v48, v48
    v_exp_f32 v49, v49
    v_smfmac_f32_32x32x32_bf16 v[128:143], v[44:47], v[72:79], v12
    ds_read_b128 v[40:43], v7 offset:1024
    ds_read_b128 v[44:47], v7 offset:1536
    v_exp_f32 v50, v50
    v_exp_f32 v51, v51
    v_exp_f32 v52, v52
    v_mfma_f32_32x32x16_bf16 v[64:79], v[24:27], v[20:23], v[96:111]
    ds_read_b128 v[24:27], v6 offset:2048
    v_exp_f32 v53, v53
    v_exp_f32 v54, v54
    v_exp_f32 v55, v55
    v_exp_f32 v56, v56
    v_exp_f32 v57, v57
    s_waitcnt lgkmcnt(3)
    v_smfmac_f32_32x32x32_bf16 v[112:127], v[32:35], v[48:55], v12
    v_exp_f32 v58, v58
    v_exp_f32 v59, v59
    v_exp_f32 v60, v60
    v_exp_f32 v61, v61
    v_exp_f32 v62, v62
    v_exp_f32 v63, v63
    v_exp_f32 v64, v64
    v_exp_f32 v65, v65
    v_smfmac_f32_32x32x32_bf16 v[112:127], v[36:39], v[56:63], v12
    v_exp_f32 v66, v66
    v_exp_f32 v67, v67
    v_exp_f32 v68, v68
    v_mfma_f32_32x32x16_bf16 v[48:63], v[28:31], v[16:19], v[80:95]
    v_exp_f32 v69, v69
    v_exp_f32 v70, v70
    v_exp_f32 v71, v71
    v_exp_f32 v72, v72
    v_exp_f32 v73, v73
    v_smfmac_f32_32x32x32_bf16 v[128:143], v[32:35], v[64:71], v12
    v_exp_f32 v74, v74
    v_exp_f32 v75, v75
    v_exp_f32 v76, v76
    v_exp_f32 v77, v77
    v_exp_f32 v78, v78
    v_exp_f32 v79, v79
    v_exp_f32 v48, v48
    v_exp_f32 v49, v49
    v_smfmac_f32_32x32x32_bf16 v[128:143], v[36:39], v[72:79], v12
    ds_read_b128 v[32:35], v7 offset:2048
    ds_read_b128 v[36:39], v7 offset:2560
    v_exp_f32 v50, v50
    v_exp_f32 v51, v51
    v_exp_f32 v52, v52
    v_mfma_f32_32x32x16_bf16 v[64:79], v[28:31], v[20:23], v[96:111]
    ds_read_b128 v[28:31], v6 offset:3072
    v_exp_f32 v53, v53
    v_exp_f32 v54, v54
    v_exp_f32 v55, v55
    v_exp_f32 v56, v56
    v_exp_f32 v57, v57
    s_waitcnt lgkmcnt(3)
    v_smfmac_f32_32x32x32_bf16 v[112:127], v[40:43], v[48:55], v12
    v_exp_f32 v58, v58
    v_exp_f32 v59, v59
    v_exp_f32 v60, v60
    v_exp_f32 v61, v61
    v_exp_f32 v62, v62
    v_exp_f32 v63, v63
    v_exp_f32 v64, v64
    v_exp_f32 v65, v65
    v_smfmac_f32_32x32x32_bf16 v[112:127], v[44:47], v[56:63], v12
    v_exp_f32 v66, v66
    v_exp_f32 v67, v67
    v_exp_f32 v68, v68
    v_mfma_f32_32x32x16_bf16 v[48:63], v[24:27], v[16:19], v[80:95]
    v_exp_f32 v69, v69
    v_exp_f32 v70, v70
    v_exp_f32 v71, v71
    v_exp_f32 v72, v72
    v_exp_f32 v73, v73
    v_smfmac_f32_32x32x32_bf16 v[128:143], v[40:43], v[64:71], v12
    v_exp_f32 v74, v74
    v_exp_f32 v75, v75
    v_exp_f32 v76, v76
    v_exp_f32 v77, v77
    v_exp_f32 v78, v78
    v_exp_f32 v79, v79
    v_exp_f32 v48, v48
    v_exp_f32 v49, v49
    v_smfmac_f32_32x32x32_bf16 v[128:143], v[44:47], v[72:79], v12
    ds_read_b128 v[40:43], v7 offset:3072
    ds_read_b128 v[44:47], v7 offset:3584
    v_exp_f32 v50, v50
    v_exp_f32 v51, v51
    v_exp_f32 v52, v52
    v_mfma_f32_32x32x16_bf16 v[64:79], v[24:27], v[20:23], v[96:111]
    ds_read_b128 v[24:27], v6 offset:8192
    v_exp_f32 v53, v53
    v_exp_f32 v54, v54
    v_exp_f32 v55, v55
    v_exp_f32 v56, v56
    v_exp_f32 v57, v57
    s_waitcnt lgkmcnt(3)
    v_smfmac_f32_32x32x32_bf16 v[112:127], v[32:35], v[48:55], v12
    v_exp_f32 v58, v58
    v_exp_f32 v59, v59
    v_exp_f32 v60, v60
    v_exp_f32 v61, v61
    v_exp_f32 v62, v62
    v_exp_f32 v63, v63
    v_exp_f32 v64, v64
    v_exp_f32 v65, v65
    v_smfmac_f32_32x32x32_bf16 v[112:127], v[36:39], v[56:63], v12
    v_exp_f32 v66, v66
    v_exp_f32 v67, v67
    v_exp_f32 v68, v68
    v_mfma_f32_32x32x16_bf16 v[48:63], v[28:31], v[16:19], v[80:95]
    v_exp_f32 v69, v69
    v_exp_f32 v70, v70
    v_exp_f32 v71, v71
    v_exp_f32 v72, v72
    v_exp_f32 v73, v73
    v_smfmac_f32_32x32x32_bf16 v[128:143], v[32:35], v[64:71], v12
    v_exp_f32 v74, v74
    v_exp_f32 v75, v75
    v_exp_f32 v76, v76
    v_exp_f32 v77, v77
    v_exp_f32 v78, v78
    v_exp_f32 v79, v79
    v_exp_f32 v48, v48
    v_exp_f32 v49, v49
    v_smfmac_f32_32x32x32_bf16 v[128:143], v[36:39], v[72:79], v12
    v_mov_b32 v232, -1
    v_mov_b32 v233, -1
    v_mov_b32 v234, -1
    v_mov_b32 v235, -1
    s_lshl_b32 s75, s2, 13
    s_add_u32 s75, s75, s52
    s_add_u32 s75, s75, 0x1400000
    s_add_u32 s75, s75, 0x500000
    buffer_store_dwordx4 v[232:235], v9, s[8:11], s75 offen sc1
    ds_read_b128 v[32:35], v7 offset:8192
    ds_read_b128 v[36:39], v7 offset:8704
    v_exp_f32 v50, v50
    v_exp_f32 v51, v51
    v_exp_f32 v52, v52
    v_mfma_f32_32x32x16_bf16 v[64:79], v[28:31], v[20:23], v[96:111]
    ds_read_b128 v[28:31], v6 offset:9216
    v_exp_f32 v53, v53
    v_exp_f32 v54, v54
    v_exp_f32 v55, v55
    v_exp_f32 v56, v56
    v_exp_f32 v57, v57
    s_waitcnt lgkmcnt(3)
    v_smfmac_f32_32x32x32_bf16 v[112:127], v[40:43], v[48:55], v12
    v_exp_f32 v58, v58
    v_exp_f32 v59, v59
    v_exp_f32 v60, v60
    v_exp_f32 v61, v61
    v_exp_f32 v62, v62
    v_exp_f32 v63, v63
    v_exp_f32 v64, v64
    v_exp_f32 v65, v65
    v_smfmac_f32_32x32x32_bf16 v[112:127], v[44:47], v[56:63], v12
    v_exp_f32 v66, v66
    v_exp_f32 v67, v67
    v_exp_f32 v68, v68
    v_mfma_f32_32x32x16_bf16 v[48:63], v[24:27], v[16:19], v[80:95]
    v_exp_f32 v69, v69
    v_exp_f32 v70, v70
    v_exp_f32 v71, v71
    v_exp_f32 v72, v72
    v_exp_f32 v73, v73
    v_smfmac_f32_32x32x32_bf16 v[128:143], v[40:43], v[64:71], v12
    v_add_u32 v6, 8192, v6
    v_add_u32 v7, v15, v7
    v_exp_f32 v74, v74
    v_exp_f32 v75, v75
    v_exp_f32 v76, v76
    v_exp_f32 v77, v77
    v_exp_f32 v78, v78
    v_exp_f32 v79, v79
    v_exp_f32 v48, v48
    v_exp_f32 v49, v49
    v_smfmac_f32_32x32x32_bf16 v[128:143], v[44:47], v[72:79], v12
    ds_read_b128 v[40:43], v7 offset:1024
    ds_read_b128 v[44:47], v7 offset:1536
    v_exp_f32 v50, v50
    v_exp_f32 v51, v51
    v_exp_f32 v52, v52
    v_mfma_f32_32x32x16_bf16 v[64:79], v[24:27], v[20:23], v[96:111]
    ds_read_b128 v[24:27], v6 offset:2048
    v_exp_f32 v53, v53
    v_exp_f32 v54, v54
    v_exp_f32 v55, v55
    v_exp_f32 v56, v56
    v_exp_f32 v57, v57
    s_waitcnt lgkmcnt(3)
    v_smfmac_f32_32x32x32_bf16 v[112:127], v[32:35], v[48:55], v12
    v_exp_f32 v58, v58
    v_exp_f32 v59, v59
    v_exp_f32 v60, v60
    v_exp_f32 v61, v61
    v_exp_f32 v62, v62
    v_exp_f32 v63, v63
    v_exp_f32 v64, v64
    v_exp_f32 v65, v65
    v_smfmac_f32_32x32x32_bf16 v[112:127], v[36:39], v[56:63], v12
    v_exp_f32 v66, v66
    v_exp_f32 v67, v67
    v_exp_f32 v68, v68
    v_mfma_f32_32x32x16_bf16 v[48:63], v[28:31], v[16:19], v[80:95]
    v_exp_f32 v69, v69
    v_exp_f32 v70, v70
    v_exp_f32 v71, v71
    v_exp_f32 v72, v72
    v_exp_f32 v73, v73
    v_smfmac_f32_32x32x32_bf16 v[128:143], v[32:35], v[64:71], v12
    v_exp_f32 v74, v74
    v_exp_f32 v75, v75
    v_exp_f32 v76, v76
    v_exp_f32 v77, v77
    v_exp_f32 v78, v78
    v_exp_f32 v79, v79
    v_exp_f32 v48, v48
    v_exp_f32 v49, v49
    v_smfmac_f32_32x32x32_bf16 v[128:143], v[36:39], v[72:79], v12
    ds_read_b128 v[32:35], v7 offset:2048
    ds_read_b128 v[36:39], v7 offset:2560
    v_exp_f32 v50, v50
    v_exp_f32 v51, v51
    v_exp_f32 v52, v52
    v_mfma_f32_32x32x16_bf16 v[64:79], v[28:31], v[20:23], v[96:111]
    ds_read_b128 v[28:31], v6 offset:3072
    v_exp_f32 v53, v53
    v_exp_f32 v54, v54
    v_exp_f32 v55, v55
    v_exp_f32 v56, v56
    v_exp_f32 v57, v57
    s_waitcnt lgkmcnt(3)
    v_smfmac_f32_32x32x32_bf16 v[112:127], v[40:43], v[48:55], v12
    v_exp_f32 v58, v58
    v_exp_f32 v59, v59
    v_exp_f32 v60, v60
    v_exp_f32 v61, v61
    v_exp_f32 v62, v62
    v_exp_f32 v63, v63
    v_exp_f32 v64, v64
    v_exp_f32 v65, v65
    v_smfmac_f32_32x32x32_bf16 v[112:127], v[44:47], v[56:63], v12
    v_exp_f32 v66, v66
    v_exp_f32 v67, v67
    v_exp_f32 v68, v68
    v_mfma_f32_32x32x16_bf16 v[48:63], v[24:27], v[16:19], v[80:95]
    v_exp_f32 v69, v69
    v_exp_f32 v70, v70
    v_exp_f32 v71, v71
    v_exp_f32 v72, v72
    v_exp_f32 v73, v73
    v_smfmac_f32_32x32x32_bf16 v[128:143], v[40:43], v[64:71], v12
    v_exp_f32 v74, v74
    v_exp_f32 v75, v75
    v_exp_f32 v76, v76
    v_exp_f32 v77, v77
    v_exp_f32 v78, v78
    v_exp_f32 v79, v79
    v_exp_f32 v48, v48
    v_exp_f32 v49, v49
    v_smfmac_f32_32x32x32_bf16 v[128:143], v[44:47], v[72:79], v12
    ds_read_b128 v[40:43], v7 offset:3072
    ds_read_b128 v[44:47], v7 offset:3584
    v_exp_f32 v50, v50
    v_exp_f32 v51, v51
    v_exp_f32 v52, v52
    v_mfma_f32_32x32x16_bf16 v[64:79], v[24:27], v[20:23], v[96:111]
    ds_read_b128 v[24:27], v6 offset:8192
    v_exp_f32 v53, v53
    v_exp_f32 v54, v54
    v_exp_f32 v55, v55
    v_exp_f32 v56, v56
    v_exp_f32 v57, v57
    s_waitcnt lgkmcnt(3)
    v_smfmac_f32_32x32x32_bf16 v[112:127], v[32:35], v[48:55], v12
    v_exp_f32 v58, v58
    v_exp_f32 v59, v59
    v_exp_f32 v60, v60
    v_exp_f32 v61, v61
    v_exp_f32 v62, v62
    v_exp_f32 v63, v63
    v_exp_f32 v64, v64
    v_exp_f32 v65, v65
    v_smfmac_f32_32x32x32_bf16 v[112:127], v[36:39], v[56:63], v12
    v_exp_f32 v66, v66
    v_exp_f32 v67, v67
    v_exp_f32 v68, v68
    v_mfma_f32_32x32x16_bf16 v[48:63], v[28:31], v[16:19], v[80:95]
    v_exp_f32 v69, v69
    v_exp_f32 v70, v70
    v_exp_f32 v71, v71
    v_exp_f32 v72, v72
    v_exp_f32 v73, v73
    v_smfmac_f32_32x32x32_bf16 v[128:143], v[32:35], v[64:71], v12
    v_exp_f32 v74, v74
    v_exp_f32 v75, v75
    v_exp_f32 v76, v76
    v_exp_f32 v77, v77
    v_exp_f32 v78, v78
    v_exp_f32 v79, v79
    v_exp_f32 v48, v48
    v_exp_f32 v49, v49
    v_smfmac_f32_32x32x32_bf16 v[128:143], v[36:39], v[72:79], v12
    s_mul_i32 s75, s3, 6144
    s_add_u32 s75, s75, s46
    v_lshlrev_b32 v236, 2, v9
    buffer_load_dword v237, v236, s[8:11], s75 offen
    s_add_u32 s75, s75, 2048
    buffer_load_dword v238, v236, s[8:11], s75 offen
    ds_read_b128 v[32:35], v7 offset:8192
    ds_read_b128 v[36:39], v7 offset:8704
    v_exp_f32 v50, v50
    v_exp_f32 v51, v51
    v_exp_f32 v52, v52
    v_mfma_f32_32x32x16_bf16 v[64:79], v[28:31], v[20:23], v[96:111]
    ds_read_b128 v[28:31], v6 offset:9216
    v_exp_f32 v53, v53
    v_exp_f32 v54, v54
    v_exp_f32 v55, v55
    v_exp_f32 v56, v56
    v_exp_f32 v57, v57
    s_waitcnt lgkmcnt(3)
    v_smfmac_f32_32x32x32_bf16 v[112:127], v[40:43], v[48:55], v12
    v_exp_f32 v58, v58
    v_exp_f32 v59, v59
    v_exp_f32 v60, v60
    v_exp_f32 v61, v61
    v_exp_f32 v62, v62
    v_exp_f32 v63, v63
    v_exp_f32 v64, v64
    v_exp_f32 v65, v65
    v_smfmac_f32_32x32x32_bf16 v[112:127], v[44:47], v[56:63], v12
    v_exp_f32 v66, v66
    v_exp_f32 v67, v67
    v_exp_f32 v68, v68
    v_mfma_f32_32x32x16_bf16 v[48:63], v[24:27], v[16:19], v[80:95]
    v_exp_f32 v69, v69
    v_exp_f32 v70, v70
    v_exp_f32 v71, v71
    v_exp_f32 v72, v72
    v_exp_f32 v73, v73
    v_smfmac_f32_32x32x32_bf16 v[128:143], v[40:43], v[64:71], v12
    v_add_u32 v6, 8192, v6
    v_add_u32 v7, v15, v7
    v_exp_f32 v74, v74
    v_exp_f32 v75, v75
    v_exp_f32 v76, v76
    v_exp_f32 v77, v77
    v_exp_f32 v78, v78
    v_exp_f32 v79, v79
    v_exp_f32 v48, v48
    v_exp_f32 v49, v49
    v_smfmac_f32_32x32x32_bf16 v[128:143], v[44:47], v[72:79], v12
    s_setprio 0
    s_lshl_b32 s75, s66, 19
    s_add_u32 s76, s74, s75
    s_add_u32 s76, s76, 0x800000
    s_add_u32 s78, s76, 8192
    v_mov_b32 v150, v148
    s_add_u32 s77, s76, 4096
    s_add_u32 s79, s78, 4096
    ds_read_b128 v[40:43], v7 offset:1024
    ds_read_b128 v[44:47], v7 offset:1536
    v_exp_f32 v50, v50
    v_exp_f32 v51, v51
    v_exp_f32 v52, v52
    v_mfma_f32_32x32x16_bf16 v[64:79], v[24:27], v[20:23], v[96:111]
    ds_read_b128 v[24:27], v6 offset:2048
    v_exp_f32 v53, v53
    v_exp_f32 v54, v54
    v_exp_f32 v55, v55
    v_exp_f32 v56, v56
    v_exp_f32 v57, v57
    s_waitcnt lgkmcnt(3)
    v_smfmac_f32_32x32x32_bf16 v[112:127], v[32:35], v[48:55], v12
    buffer_load_dwordx4 v[152:155], v148, s[8:11], s76 offen offset:0
    buffer_load_dwordx4 v[184:187], v150, s[8:11], s78 offen offset:0 sc1
    v_exp_f32 v58, v58
    v_exp_f32 v59, v59
    v_exp_f32 v60, v60
    v_exp_f32 v61, v61
    v_exp_f32 v62, v62
    v_exp_f32 v63, v63
    v_exp_f32 v64, v64
    v_exp_f32 v65, v65
    v_smfmac_f32_32x32x32_bf16 v[112:127], v[36:39], v[56:63], v12
    v_exp_f32 v66, v66
    v_exp_f32 v67, v67
    v_exp_f32 v68, v68
    v_mfma_f32_32x32x16_bf16 v[48:63], v[28:31], v[16:19], v[80:95]
    v_exp_f32 v69, v69
    v_exp_f32 v70, v70
    v_exp_f32 v71, v71
    v_exp_f32 v72, v72
    v_exp_f32 v73, v73
    v_smfmac_f32_32x32x32_bf16 v[128:143], v[32:35], v[64:71], v12
    buffer_load_dwordx4 v[156:159], v148, s[8:11], s76 offen offset:1024
    buffer_load_dwordx4 v[188:191], v150, s[8:11], s78 offen offset:1024 sc1
    v_exp_f32 v74, v74
    v_exp_f32 v75, v75
    v_exp_f32 v76, v76
    v_exp_f32 v77, v77
    v_exp_f32 v78, v78
    v_exp_f32 v79, v79
    v_exp_f32 v48, v48
    v_exp_f32 v49, v49
    v_smfmac_f32_32x32x32_bf16 v[128:143], v[36:39], v[72:79], v12
    ds_read_b128 v[32:35], v7 offset:2048
    ds_read_b128 v[36:39], v7 offset:2560
    v_exp_f32 v50, v50
    v_exp_f32 v51, v51
    v_exp_f32 v52, v52
    v_mfma_f32_32x32x16_bf16 v[64:79], v[28:31], v[20:23], v[96:111]
    ds_read_b128 v[28:31], v6 offset:3072
    v_exp_f32 v53, v53
    v_exp_f32 v54, v54
    v_exp_f32 v55, v55
    v_exp_f32 v56, v56
    v_exp_f32 v57, v57
    s_waitcnt lgkmcnt(3)
    v_smfmac_f32_32x32x32_bf16 v[112:127], v[40:43], v[48:55], v12
    buffer_load_dwordx4 v[160:163], v148, s[8:11], s76 offen offset:2048
    buffer_load_dwordx4 v[192:195], v150, s[8:11], s78 offen offset:2048 sc1
    v_exp_f32 v58, v58
    v_exp_f32 v59, v59
    v_exp_f32 v60, v60
    v_exp_f32 v61, v61
    v_exp_f32 v62, v62
    v_exp_f32 v63, v63
    v_exp_f32 v64, v64
    v_exp_f32 v65, v65
    v_smfmac_f32_32x32x32_bf16 v[112:127], v[44:47], v[56:63], v12
    v_exp_f32 v66, v66
    v_exp_f32 v67, v67
    v_exp_f32 v68, v68
    v_mfma_f32_32x32x16_bf16 v[48:63], v[24:27], v[16:19], v[80:95]
    v_exp_f32 v69, v69
    v_exp_f32 v70, v70
    v_exp_f32 v71, v71
    v_exp_f32 v72, v72
    v_exp_f32 v73, v73
    v_smfmac_f32_32x32x32_bf16 v[128:143], v[40:43], v[64:71], v12
    buffer_load_dwordx4 v[164:167], v148, s[8:11], s76 offen offset:3072
    buffer_load_dwordx4 v[196:199], v150, s[8:11], s78 offen offset:3072 sc1
    v_exp_f32 v74, v74
    v_exp_f32 v75, v75
    v_exp_f32 v76, v76
    v_exp_f32 v77, v77
    v_exp_f32 v78, v78
    v_exp_f32 v79, v79
    v_exp_f32 v48, v48
    v_exp_f32 v49, v49
    v_smfmac_f32_32x32x32_bf16 v[128:143], v[44:47], v[72:79], v12
    ds_read_b128 v[40:43], v7 offset:3072
    ds_read_b128 v[44:47], v7 offset:3584
    v_exp_f32 v50, v50
    v_exp_f32 v51, v51
    v_exp_f32 v52, v52
    v_mfma_f32_32x32x16_bf16 v[64:79], v[24:27], v[20:23], v[96:111]
    ds_read_b128 v[24:27], v6 offset:8192
    v_exp_f32 v53, v53
    v_exp_f32 v54, v54
    v_exp_f32 v55, v55
    v_exp_f32 v56, v56
    v_exp_f32 v57, v57
    s_waitcnt lgkmcnt(3)
    v_smfmac_f32_32x32x32_bf16 v[112:127], v[32:35], v[48:55], v12
    buffer_load_dwordx4 v[168:171], v148, s[8:11], s77 offen offset:0
    buffer_load_dwordx4 v[200:203], v150, s[8:11], s79 offen offset:0 sc1
    v_exp_f32 v58, v58
    v_exp_f32 v59, v59
    v_exp_f32 v60, v60
    v_exp_f32 v61, v61
    v_exp_f32 v62, v62
    v_exp_f32 v63, v63
    v_exp_f32 v64, v64
    v_exp_f32 v65, v65
    v_smfmac_f32_32x32x32_bf16 v[112:127], v[36:39], v[56:63], v12
    v_exp_f32 v66, v66
    v_exp_f32 v67, v67
    v_exp_f32 v68, v68
    v_mfma_f32_32x32x16_bf16 v[48:63], v[28:31], v[16:19], v[80:95]
    v_exp_f32 v69, v69
    v_exp_f32 v70, v70
    v_exp_f32 v71, v71
    v_exp_f32 v72, v72
    v_exp_f32 v73, v73
    v_smfmac_f32_32x32x32_bf16 v[128:143], v[32:35], v[64:71], v12
    buffer_load_dwordx4 v[172:175], v148, s[8:11], s77 offen offset:1024
    buffer_load_dwordx4 v[204:207], v150, s[8:11], s79 offen offset:1024 sc1
    v_exp_f32 v74, v74
    v_exp_f32 v75, v75
    v_exp_f32 v76, v76
    v_exp_f32 v77, v77
    v_exp_f32 v78, v78
    v_exp_f32 v79, v79
    v_exp_f32 v48, v48
    v_exp_f32 v49, v49
    v_smfmac_f32_32x32x32_bf16 v[128:143], v[36:39], v[72:79], v12
    ds_read_b128 v[32:35], v7 offset:8192
    ds_read_b128 v[36:39], v7 offset:8704
    v_exp_f32 v50, v50
    v_exp_f32 v51, v51
    v_exp_f32 v52, v52
    v_mfma_f32_32x32x16_bf16 v[64:79], v[28:31], v[20:23], v[96:111]
    ds_read_b128 v[28:31], v6 offset:9216
    v_exp_f32 v53, v53
    v_exp_f32 v54, v54
    v_exp_f32 v55, v55
    v_exp_f32 v56, v56
    v_exp_f32 v57, v57
    s_waitcnt lgkmcnt(3)
    v_smfmac_f32_32x32x32_bf16 v[112:127], v[40:43], v[48:55], v12
    buffer_load_dwordx4 v[176:179], v148, s[8:11], s77 offen offset:2048
    buffer_load_dwordx4 v[208:211], v150, s[8:11], s79 offen offset:2048 sc1
    v_exp_f32 v58, v58
    v_exp_f32 v59, v59
    v_exp_f32 v60, v60
    v_exp_f32 v61, v61
    v_exp_f32 v62, v62
    v_exp_f32 v63, v63
    v_exp_f32 v64, v64
    v_exp_f32 v65, v65
    v_smfmac_f32_32x32x32_bf16 v[112:127], v[44:47], v[56:63], v12
    v_exp_f32 v66, v66
    v_exp_f32 v67, v67
    v_exp_f32 v68, v68
    v_mfma_f32_32x32x16_bf16 v[48:63], v[24:27], v[16:19], v[80:95]
    v_exp_f32 v69, v69
    v_exp_f32 v70, v70
    v_exp_f32 v71, v71
    v_exp_f32 v72, v72
    v_exp_f32 v73, v73
    v_smfmac_f32_32x32x32_bf16 v[128:143], v[40:43], v[64:71], v12
    v_add_u32 v6, 8192, v6
    v_add_u32 v7, v15, v7
    buffer_load_dwordx4 v[180:183], v148, s[8:11], s77 offen offset:3072
    buffer_load_dwordx4 v[212:215], v150, s[8:11], s79 offen offset:3072 sc1
    v_exp_f32 v74, v74
    v_exp_f32 v75, v75
    v_exp_f32 v76, v76
    v_exp_f32 v77, v77
    v_exp_f32 v78, v78
    v_exp_f32 v79, v79
L_mha_i7:
    v_exp_f32 v48, v48
    v_exp_f32 v49, v49
    v_smfmac_f32_32x32x32_bf16 v[128:143], v[44:47], v[72:79], v12
    ds_read_b128 v[40:43], v7 offset:1024
    ds_read_b128 v[44:47], v7 offset:1536
    v_exp_f32 v50, v50
    v_exp_f32 v51, v51
    v_exp_f32 v52, v52
    v_mfma_f32_32x32x16_bf16 v[64:79], v[24:27], v[20:23], v[96:111]
    ds_read_b128 v[24:27], v6 offset:2048
    v_exp_f32 v53, v53
    v_exp_f32 v54, v54
    v_exp_f32 v55, v55
    v_exp_f32 v56, v56
    v_exp_f32 v57, v57
    s_waitcnt lgkmcnt(3)
    v_smfmac_f32_32x32x32_bf16 v[112:127], v[32:35], v[48:55], v12
    v_exp_f32 v58, v58
    v_exp_f32 v59, v59
    v_exp_f32 v60, v60
    v_exp_f32 v61, v61
    v_exp_f32 v62, v62
    v_exp_f32 v63, v63
    v_exp_f32 v64, v64
    v_exp_f32 v65, v65
    v_smfmac_f32_32x32x32_bf16 v[112:127], v[36:39], v[56:63], v12
    v_exp_f32 v66, v66
    v_exp_f32 v67, v67
    v_exp_f32 v68, v68
    v_mfma_f32_32x32x16_bf16 v[48:63], v[28:31], v[16:19], v[80:95]
    v_exp_f32 v69, v69
    v_exp_f32 v70, v70
    v_exp_f32 v71, v71
    v_exp_f32 v72, v72
    v_exp_f32 v73, v73
    v_smfmac_f32_32x32x32_bf16 v[128:143], v[32:35], v[64:71], v12
    v_exp_f32 v74, v74
    v_exp_f32 v75, v75
    v_exp_f32 v76, v76
    v_exp_f32 v77, v77
    v_exp_f32 v78, v78
    v_exp_f32 v79, v79
    v_exp_f32 v48, v48
    v_exp_f32 v49, v49
    v_smfmac_f32_32x32x32_bf16 v[128:143], v[36:39], v[72:79], v12
    ds_read_b128 v[32:35], v7 offset:2048
    ds_read_b128 v[36:39], v7 offset:2560
    v_exp_f32 v50, v50
    v_exp_f32 v51, v51
    v_exp_f32 v52, v52
    v_mfma_f32_32x32x16_bf16 v[64:79], v[28:31], v[20:23], v[96:111]
    ds_read_b128 v[28:31], v6 offset:3072
    v_exp_f32 v53, v53
    v_exp_f32 v54, v54
    v_exp_f32 v55, v55
    v_exp_f32 v56, v56
    v_exp_f32 v57, v57
    s_waitcnt lgkmcnt(3)
    v_smfmac_f32_32x32x32_bf16 v[112:127], v[40:43], v[48:55], v12
    v_exp_f32 v58, v58
    v_exp_f32 v59, v59
    v_exp_f32 v60, v60
    v_exp_f32 v61, v61
    v_exp_f32 v62, v62
    v_exp_f32 v63, v63
    v_exp_f32 v64, v64
    v_exp_f32 v65, v65
    v_smfmac_f32_32x32x32_bf16 v[112:127], v[44:47], v[56:63], v12
    v_exp_f32 v66, v66
    v_exp_f32 v67, v67
    v_exp_f32 v68, v68
    v_mfma_f32_32x32x16_bf16 v[48:63], v[24:27], v[16:19], v[80:95]
    v_exp_f32 v69, v69
    v_exp_f32 v70, v70
    v_exp_f32 v71, v71
    v_exp_f32 v72, v72
    v_exp_f32 v73, v73
    v_smfmac_f32_32x32x32_bf16 v[128:143], v[40:43], v[64:71], v12
    v_exp_f32 v74, v74
    v_exp_f32 v75, v75
    v_exp_f32 v76, v76
    v_exp_f32 v77, v77
    v_exp_f32 v78, v78
    v_exp_f32 v79, v79
    v_exp_f32 v48, v48
    v_exp_f32 v49, v49
    v_smfmac_f32_32x32x32_bf16 v[128:143], v[44:47], v[72:79], v12
    ds_read_b128 v[40:43], v7 offset:3072
    ds_read_b128 v[44:47], v7 offset:3584
    v_exp_f32 v50, v50
    v_exp_f32 v51, v51
    v_exp_f32 v52, v52
    v_mfma_f32_32x32x16_bf16 v[64:79], v[24:27], v[20:23], v[96:111]
    v_exp_f32 v53, v53
    v_exp_f32 v54, v54
    v_exp_f32 v55, v55
    v_exp_f32 v56, v56
    v_exp_f32 v57, v57
    s_waitcnt lgkmcnt(2)
    v_smfmac_f32_32x32x32_bf16 v[112:127], v[32:35], v[48:55], v12
    v_exp_f32 v58, v58
    v_exp_f32 v59, v59
    v_exp_f32 v60, v60
    v_exp_f32 v61, v61
    v_exp_f32 v62, v62
    v_exp_f32 v63, v63
    v_exp_f32 v64, v64
    v_exp_f32 v65, v65
    v_smfmac_f32_32x32x32_bf16 v[112:127], v[36:39], v[56:63], v12
    v_exp_f32 v66, v66
    v_exp_f32 v67, v67
    v_exp_f32 v68, v68
    v_mfma_f32_32x32x16_bf16 v[48:63], v[28:31], v[16:19], v[80:95]
    v_exp_f32 v69, v69
    v_exp_f32 v70, v70
    v_exp_f32 v71, v71
    v_exp_f32 v72, v72
    v_exp_f32 v73, v73
    v_smfmac_f32_32x32x32_bf16 v[128:143], v[32:35], v[64:71], v12
    v_exp_f32 v74, v74
    v_exp_f32 v75, v75
    v_exp_f32 v76, v76
    v_exp_f32 v77, v77
    v_exp_f32 v78, v78
    v_exp_f32 v79, v79
    v_exp_f32 v48, v48
    v_exp_f32 v49, v49
    v_smfmac_f32_32x32x32_bf16 v[128:143], v[36:39], v[72:79], v12
    v_exp_f32 v50, v50
    v_exp_f32 v51, v51
    v_exp_f32 v52, v52
    v_mfma_f32_32x32x16_bf16 v[64:79], v[28:31], v[20:23], v[96:111]
    v_exp_f32 v53, v53
    v_exp_f32 v54, v54
    v_exp_f32 v55, v55
    v_exp_f32 v56, v56
    v_exp_f32 v57, v57
    s_waitcnt lgkmcnt(0)
    v_smfmac_f32_32x32x32_bf16 v[112:127], v[40:43], v[48:55], v12
    v_exp_f32 v58, v58
    v_exp_f32 v59, v59
    v_exp_f32 v60, v60
    v_exp_f32 v61, v61
    v_exp_f32 v62, v62
    v_exp_f32 v63, v63
    v_exp_f32 v64, v64
    v_exp_f32 v65, v65
    v_smfmac_f32_32x32x32_bf16 v[112:127], v[44:47], v[56:63], v12
    v_exp_f32 v66, v66
    v_exp_f32 v67, v67
    v_exp_f32 v68, v68
    v_exp_f32 v69, v69
    v_exp_f32 v70, v70
    v_exp_f32 v71, v71
    v_exp_f32 v72, v72
    v_exp_f32 v73, v73
    v_smfmac_f32_32x32x32_bf16 v[128:143], v[40:43], v[64:71], v12
    v_exp_f32 v74, v74
    v_exp_f32 v75, v75
    v_exp_f32 v76, v76
    v_mov_b32 v121, v80
    ds_write_b128 v240, v[112:115]
    ds_write_b128 v240, v[116:119] offset:1024
    ds_write_b64 v241, v[120:121] offset:2048
    v_cmp_nlt_f32 s[68:69], v120, v244
    v_exp_f32 v77, v77
    v_exp_f32 v78, v78
    v_exp_f32 v79, v79
    s_nop 1
    v_smfmac_f32_32x32x32_bf16 v[128:143], v[44:47], v[72:79], v12
    s_nop 11
    v_cmp_nlt_f32 vcc, v136, v244
    s_nop 1
    s_or_b64 vcc, vcc, s[68:69]
    s_cbranch_vccnz L_mha_slow
L_mha_out:
    s_waitcnt lgkmcnt(0)
    s_barrier
    ds_read_b64 v[56:57], v243 offset:2048
    ds_read_b128 v[48:51], v242
    ds_read_b128 v[52:55], v242 offset:1024
    s_waitcnt lgkmcnt(2)
    v_min_f32 v4, v96, v57
    v_sub_f32 v5, v4, v96
    v_sub_f32 v4, v4, v57
    v_exp_f32 v10, v5
    v_exp_f32 v4, v4
    v_mul_f32 v5, v10, v136
    v_fmac_f32 v5, v4, v56
    v_rcp_f32 v5, v5
    s_nop 0
    v_mul_f32 v10, v10, v5
    v_mul_f32 v4, v4, v5
    s_waitcnt lgkmcnt(0)
    v_mul_f32 v128, v10, v128
    v_fmac_f32 v128, v4, v48
    v_mul_f32 v129, v10, v129
    v_fmac_f32 v129, v4, v49
    v_mul_f32 v130, v10, v130
    v_fmac_f32 v130, v4, v50
    v_mul_f32 v131, v10, v131
    v_fmac_f32 v131, v4, v51
    v_mul_f32 v132, v10, v132
    v_fmac_f32 v132, v4, v52
    v_mul_f32 v133, v10, v133
    v_fmac_f32 v133, v4, v53
    v_mul_f32 v134, v10, v134
    v_fmac_f32 v134, v4, v54
    v_mul_f32 v135, v10, v135
    v_fmac_f32 v135, v4, v55
    v_cvt_pk_bf16_f32 v128, v128, v129
    v_cvt_pk_bf16_f32 v129, v130, v131
    v_cvt_pk_bf16_f32 v130, v132, v133
    v_cvt_pk_bf16_f32 v131, v134, v135
    buffer_store_dwordx4 v[128:131], v9, s[8:11], s58 offen sc1
    s_lshl_b32 s46, s72, 15
    s_lshl_b32 s52, s3, 12
    s_add_u32 s46, s46, s52
    s_add_u32 s46, s46, s65
    s_add_u32 s46, s46, 0xe00000
    v_add_u32 v6, s52, v9
    s_lshl_b32 s53, s41, 14
    v_add_u32 v7, s53, v9
    v_and_b32 v5, 3, v149
    v_lshlrev_b32 v5, 10, v5
    s_lshl_b32 s52, s3, 11
    s_add_u32 s52, s52, 0x8000
    v_add_u32 v10, s52, v9
    v_xor_b32 v11, 0x2000, v10
    v_and_b32 v2, 31, v149
    s_mov_b32 s70, 0
    s_cmp_eq_u32 s66, 0
    s_cbranch_scc0 L_mha_f2
    s_and_b32 s40, s42, 3
    s_lshl_b32 s40, s40, 19
    s_lshl_b32 s52, s3, 16
    s_add_u32 s40, s40, s52
    s_lshl_b32 s47, s72, 7
    s_add_u32 s40, s40, s47
    s_add_u32 s52, s40, 0x0
    s_add_u32 s47, s47, 0x1602000
    v_lshrrev_b32 v16, 3, v149
    v_lshlrev_b32 v16, 13, v16
    v_and_b32 v21, 7, v149
    v_lshl_add_u32 v16, v21, 4, v16
    v_lshlrev_b32 v17, 2, v2
    s_and_b32 s40, s3, 3
    s_lshl_b32 s40, s40, 11
    s_lshl_b32 s53, s41, 10
    s_add_u32 s40, s40, s53
    s_add_u32 s40, s40, 0xc000
    v_lshl_add_u32 v21, v3, 9, v17
    v_add_u32 v21, s40, v21
    s_lshl_b32 s40, s3, 10
    s_add_u32 s40, s40, 0xc000
    v_add_u32 v22, s40, v9
    s_add_u32 s40, s73, s41
    v_add_u32 v18, s40, v3
    v_cmp_eq_u32 s[68:69], 0, v18
    s_waitcnt vmcnt(1)
    s_lshl_b32 s40, s3, 8
    s_add_u32 s40, s40, 0x21000
    v_lshl_add_u32 v19, v149, 2, s40
    v_lshlrev_b32 v20, 2, v149
    v_add_u32 v20, 0x21000, v20
    v_lshlrev_b32 v216, 16, v144
    v_and_b32 v217, 0xffff0000, v144
    v_lshlrev_b32 v218, 16, v145
    v_and_b32 v219, 0xffff0000, v145
    v_lshlrev_b32 v220, 16, v146
    v_and_b32 v221, 0xffff0000, v146
    v_lshlrev_b32 v222, 16, v147
    v_and_b32 v223, 0xffff0000, v147
    s_waitcnt vmcnt(0)
L_mha_opa:
    buffer_load_dword v4, v5, s[8:11], s46 offen offset:1020 sc1
    s_add_u32 s70, s70, 1
    s_waitcnt vmcnt(0)
    v_cmp_eq_u32 vcc, -1, v4
    s_cmp_gt_u32 s70, 0x40000
    s_cbranch_scc1 L_mha_ola
    s_cbranch_vccnz L_mha_opa
L_mha_ola:
    buffer_load_dwordx4 v[48:51], v9, s[8:11], s46 offen offset:0 sc1
    buffer_load_dwordx4 v[52:55], v9, s[8:11], s46 offen offset:1024 sc1
    buffer_load_dwordx4 v[56:59], v9, s[8:11], s46 offen offset:2048 sc1
    buffer_load_dwordx4 v[60:63], v9, s[8:11], s46 offen offset:3072 sc1
    s_add_u32 s70, s70, 1
    s_waitcnt vmcnt(3)
    ds_write_b128 v6, v[48:51] offset:0
    v_max_u32 v4, v48, v49
    v_max3_u32 v4, v4, v50, v51
    s_waitcnt vmcnt(2)
    ds_write_b128 v6, v[52:55] offset:1024
    v_max3_u32 v4, v4, v52, v53
    v_max3_u32 v4, v4, v54, v55
    s_waitcnt vmcnt(1)
    ds_write_b128 v6, v[56:59] offset:2048
    v_max3_u32 v4, v4, v56, v57
    v_max3_u32 v4, v4, v58, v59
    s_waitcnt vmcnt(0)
    ds_write_b128 v6, v[60:63] offset:3072
    v_max3_u32 v4, v4, v60, v61
    v_max3_u32 v4, v4, v62, v63
    v_cmp_eq_u32 vcc, -1, v4
    s_cmp_gt_u32 s70, 0x40000
    s_waitcnt lgkmcnt(0)
    s_cbranch_scc1 L_mha_oka
    s_cbranch_vccnz L_mha_ola
L_mha_oka:
    s_barrier
    ds_read_b128 v[48:51], v7 offset:0
    ds_read_b128 v[52:55], v7 offset:1024
    ds_read_b128 v[56:59], v7 offset:2048
    ds_read_b128 v[60:63], v7 offset:3072
    ds_read_b128 v[64:67], v7 offset:4096
    ds_read_b128 v[68:71], v7 offset:5120
    ds_read_b128 v[72:75], v7 offset:6144
    ds_read_b128 v[76:79], v7 offset:7168
    ds_read_b128 v[80:83], v7 offset:8192
    ds_read_b128 v[84:87], v7 offset:9216
    ds_read_b128 v[88:91], v7 offset:10240
    ds_read_b128 v[92:95], v7 offset:11264
    ds_read_b128 v[96:99], v7 offset:12288
    ds_read_b128 v[100:103], v7 offset:13312
    ds_read_b128 v[104:107], v7 offset:14336
    s_waitcnt lgkmcnt(14)
    ds_read_b128 v[108:111], v7 offset:15360
    s_waitcnt lgkmcnt(14)
    v_mfma_f32_32x32x16_bf16 v[216:231], v[152:155], v[48:51], v[216:231]
    s_waitcnt lgkmcnt(14)
    v_mfma_f32_32x32x16_bf16 v[216:231], v[156:159], v[52:55], v[216:231]
    s_waitcnt lgkmcnt(13)
    v_mfma_f32_32x32x16_bf16 v[216:231], v[160:163], v[56:59], v[216:231]
    s_waitcnt lgkmcnt(12)
    v_mfma_f32_32x32x16_bf16 v[216:231], v[164:167], v[60:63], v[216:231]
    s_waitcnt lgkmcnt(11)
    v_mfma_f32_32x32x16_bf16 v[216:231], v[168:171], v[64:67], v[216:231]
    s_waitcnt lgkmcnt(10)
    v_mfma_f32_32x32x16_bf16 v[216:231], v[172:175], v[68:71], v[216:231]
    s_waitcnt lgkmcnt(9)
    v_mfma_f32_32x32x16_bf16 v[216:231], v[176:179], v[72:75], v[216:231]
    s_waitcnt lgkmcnt(8)
    v_mfma_f32_32x32x16_bf16 v[216:231], v[180:183], v[76:79], v[216:231]
    s_waitcnt lgkmcnt(7)
    v_mfma_f32_32x32x16_bf16 v[216:231], v[184:187], v[80:83], v[216:231]
    s_waitcnt lgkmcnt(6)
    v_mfma_f32_32x32x16_bf16 v[216:231], v[188:191], v[84:87], v[216:231]
    s_waitcnt lgkmcnt(5)
    v_mfma_f32_32x32x16_bf16 v[216:231], v[192:195], v[88:91], v[216:231]
    s_waitcnt lgkmcnt(4)
    v_mfma_f32_32x32x16_bf16 v[216:231], v[196:199], v[92:95], v[216:231]
    s_waitcnt lgkmcnt(3)
    v_mfma_f32_32x32x16_bf16 v[216:231], v[200:203], v[96:99], v[216:231]
    s_waitcnt lgkmcnt(2)
    v_mfma_f32_32x32x16_bf16 v[216:231], v[204:207], v[100:103], v[216:231]
    s_waitcnt lgkmcnt(1)
    v_mfma_f32_32x32x16_bf16 v[216:231], v[208:211], v[104:107], v[216:231]
    s_waitcnt lgkmcnt(0)
    v_mfma_f32_32x32x16_bf16 v[216:231], v[212:215], v[108:111], v[216:231]
    s_nop 11
    ds_write_b128 v10, v[224:227]
    ds_write_b128 v10, v[228:231] offset:1024
    s_waitcnt lgkmcnt(0)
    s_barrier
    ds_read_b128 v[48:51], v11
    ds_read_b128 v[52:55], v11 offset:1024
    s_waitcnt lgkmcnt(1)
    v_add_f32 v216, v216, v48
    v_add_f32 v217, v217, v49
    v_add_f32 v218, v218, v50
    v_add_f32 v219, v219, v51
    s_waitcnt lgkmcnt(0)
    v_add_f32 v220, v220, v52
    v_add_f32 v221, v221, v53
    v_add_f32 v222, v222, v54
    v_add_f32 v223, v223, v55
    v_cvt_pk_bf16_f32 v56, v216, v217
    ds_write_b32 v21, v56 offset:0
    v_cvt_pk_bf16_f32 v57, v218, v219
    ds_write_b32 v21, v57 offset:128
    v_cvt_pk_bf16_f32 v58, v220, v221
    ds_write_b32 v21, v58 offset:256
    v_cvt_pk_bf16_f32 v59, v222, v223
    ds_write_b32 v21, v59 offset:384
    v_cndmask_b32 v7, v217, v18, s[68:69]
    v_mul_f32 v7, v7, v7
    v_mul_f32 v8, v216, v216
    v_fmac_f32 v7, v218, v218
    v_fmac_f32 v8, v219, v219
    v_fmac_f32 v7, v220, v220
    v_fmac_f32 v8, v221, v221
    v_fmac_f32 v7, v222, v222
    v_fmac_f32 v8, v223, v223
    v_add_f32 v7, v7, v8
    ds_write_b32 v19, v7
    s_waitcnt lgkmcnt(0)
    s_barrier
    ds_read_b128 v[60:63], v22
    s_waitcnt lgkmcnt(0)
    buffer_store_dwordx4 v[60:63], v16, s[8:11], s52 offen sc1
    s_cmp_eq_u32 s3, 0
    s_cbranch_scc0 L_mha_end
    ds_read2st64_b32 v[48:49], v20 offset0:0 offset1:1
    ds_read2st64_b32 v[50:51], v20 offset0:2 offset1:3
    ds_read2st64_b32 v[52:53], v20 offset0:4 offset1:5
    ds_read2st64_b32 v[54:55], v20 offset0:6 offset1:7
    s_waitcnt lgkmcnt(0)
    v_add_f32 v48, v48, v49
    v_add_f32 v50, v50, v51
    v_add_f32 v52, v52, v53
    v_add_f32 v54, v54, v55
    v_add_f32 v48, v48, v50
    v_add_f32 v52, v52, v54
    v_add_f32 v7, v48, v52
    v_mov_b32 v8, v7
    s_nop 1
    v_permlane32_swap_b32 v7, v8
    v_add_f32 v7, v7, v8
    s_mov_b32 exec_hi, 0
    buffer_atomic_add_f32 v7, v17, s[8:11], s47 offen
    s_endpgm
L_mha_f2:
    s_and_b32 s40, s3, 3
    s_lshl_b32 s40, s40, 6
    s_lshl_b32 s47, s41, 4
    s_add_u32 s40, s40, s47
    s_add_u32 s40, s40, 0xC000
    s_movk_i32 s47, 272
    v_mul_lo_u32 v16, v2, s47
    v_lshl_add_u32 v16, v3, 5, v16
    v_add_u32 v16, s40, v16
    v_lshrrev_b32 v4, 4, v149
    s_lshl_b32 s40, s3, 2
    v_add_u32 v4, s40, v4
    v_and_b32 v8, 15, v149
    v_lshlrev_b32 v8, 4, v8
    v_mad_u32_u24 v17, v4, s47, v8
    v_add_u32 v17, 0xC000, v17
    v_and_b32 v18, 7, v4
    v_lshl_add_u32 v18, v18, 16, v8
    v_lshrrev_b32 v4, 3, v4
    v_lshl_add_u32 v18, v4, 10, v18
    s_bfe_u32 s40, s72, 0x20002
    s_lshl_b32 s40, s40, 19
    s_lshr_b32 s47, s72, 4
    s_lshl_b32 s47, s47, 14
    s_add_u32 s40, s40, s47
    s_and_b32 s47, s72, 3
    s_lshl_b32 s47, s47, 12
    s_add_u32 s40, s40, s47
    s_and_b32 s47, s42, 3
    s_lshl_b32 s47, s47, 8
    s_add_u32 s40, s40, s47
    s_waitcnt vmcnt(0)
L_mha_opb:
    buffer_load_dword v4, v5, s[8:11], s46 offen offset:1020 sc1
    s_add_u32 s70, s70, 1
    s_waitcnt vmcnt(0)
    v_cmp_eq_u32 vcc, -1, v4
    s_cmp_gt_u32 s70, 0x40000
    s_cbranch_scc1 L_mha_olb
    s_cbranch_vccnz L_mha_opb
L_mha_olb:
    buffer_load_dwordx4 v[48:51], v9, s[8:11], s46 offen offset:0 sc1
    buffer_load_dwordx4 v[52:55], v9, s[8:11], s46 offen offset:1024 sc1
    buffer_load_dwordx4 v[56:59], v9, s[8:11], s46 offen offset:2048 sc1
    buffer_load_dwordx4 v[60:63], v9, s[8:11], s46 offen offset:3072 sc1
    s_add_u32 s70, s70, 1
    s_waitcnt vmcnt(3)
    ds_write_b128 v6, v[48:51] offset:0
    v_max_u32 v4, v48, v49
    v_max3_u32 v4, v4, v50, v51
    s_waitcnt vmcnt(2)
    ds_write_b128 v6, v[52:55] offset:1024
    v_max3_u32 v4, v4, v52, v53
    v_max3_u32 v4, v4, v54, v55
    s_waitcnt vmcnt(1)
    ds_write_b128 v6, v[56:59] offset:2048
    v_max3_u32 v4, v4, v56, v57
    v_max3_u32 v4, v4, v58, v59
    s_waitcnt vmcnt(0)
    ds_write_b128 v6, v[60:63] offset:3072
    v_max3_u32 v4, v4, v60, v61
    v_max3_u32 v4, v4, v62, v63
    v_cmp_eq_u32 vcc, -1, v4
    s_cmp_gt_u32 s70, 0x40000
    s_waitcnt lgkmcnt(0)
    s_cbranch_scc1 L_mha_okb
    s_cbranch_vccnz L_mha_olb
L_mha_okb:
    s_barrier
    ds_read_b128 v[48:51], v7 offset:0
    ds_read_b128 v[52:55], v7 offset:1024
    ds_read_b128 v[56:59], v7 offset:2048
    ds_read_b128 v[60:63], v7 offset:3072
    ds_read_b128 v[64:67], v7 offset:4096
    ds_read_b128 v[68:71], v7 offset:5120
    ds_read_b128 v[72:75], v7 offset:6144
    ds_read_b128 v[76:79], v7 offset:7168
    ds_read_b128 v[80:83], v7 offset:8192
    ds_read_b128 v[84:87], v7 offset:9216
    ds_read_b128 v[88:91], v7 offset:10240
    ds_read_b128 v[92:95], v7 offset:11264
    ds_read_b128 v[96:99], v7 offset:12288
    ds_read_b128 v[100:103], v7 offset:13312
    ds_read_b128 v[104:107], v7 offset:14336
    s_waitcnt lgkmcnt(14)
    ds_read_b128 v[108:111], v7 offset:15360
    s_waitcnt lgkmcnt(14)
    v_mfma_f32_32x32x16_bf16 v[216:231], v[152:155], v[48:51], v[216:231]
    s_waitcnt lgkmcnt(14)
    v_mfma_f32_32x32x16_bf16 v[216:231], v[156:159], v[52:55], v[216:231]
    s_waitcnt lgkmcnt(13)
    v_mfma_f32_32x32x16_bf16 v[216:231], v[160:163], v[56:59], v[216:231]
    s_waitcnt lgkmcnt(12)
    v_mfma_f32_32x32x16_bf16 v[216:231], v[164:167], v[60:63], v[216:231]
    s_waitcnt lgkmcnt(11)
    v_mfma_f32_32x32x16_bf16 v[216:231], v[168:171], v[64:67], v[216:231]
    s_waitcnt lgkmcnt(10)
    v_mfma_f32_32x32x16_bf16 v[216:231], v[172:175], v[68:71], v[216:231]
    s_waitcnt lgkmcnt(9)
    v_mfma_f32_32x32x16_bf16 v[216:231], v[176:179], v[72:75], v[216:231]
    s_waitcnt lgkmcnt(8)
    v_mfma_f32_32x32x16_bf16 v[216:231], v[180:183], v[76:79], v[216:231]
    s_waitcnt lgkmcnt(7)
    v_mfma_f32_32x32x16_bf16 v[216:231], v[184:187], v[80:83], v[216:231]
    s_waitcnt lgkmcnt(6)
    v_mfma_f32_32x32x16_bf16 v[216:231], v[188:191], v[84:87], v[216:231]
    s_waitcnt lgkmcnt(5)
    v_mfma_f32_32x32x16_bf16 v[216:231], v[192:195], v[88:91], v[216:231]
    s_waitcnt lgkmcnt(4)
    v_mfma_f32_32x32x16_bf16 v[216:231], v[196:199], v[92:95], v[216:231]
    s_waitcnt lgkmcnt(3)
    v_mfma_f32_32x32x16_bf16 v[216:231], v[200:203], v[96:99], v[216:231]
    s_waitcnt lgkmcnt(2)
    v_mfma_f32_32x32x16_bf16 v[216:231], v[204:207], v[100:103], v[216:231]
    s_waitcnt lgkmcnt(1)
    v_mfma_f32_32x32x16_bf16 v[216:231], v[208:211], v[104:107], v[216:231]
    s_waitcnt lgkmcnt(0)
    v_mfma_f32_32x32x16_bf16 v[216:231], v[212:215], v[108:111], v[216:231]
    s_nop 11
    ds_write_b128 v10, v[224:227]
    ds_write_b128 v10, v[228:231] offset:1024
    s_waitcnt lgkmcnt(0)
    s_barrier
    ds_read_b128 v[48:51], v11
    ds_read_b128 v[52:55], v11 offset:1024
    s_waitcnt lgkmcnt(1)
    v_add_f32 v216, v216, v48
    v_add_f32 v217, v217, v49
    v_add_f32 v218, v218, v50
    v_add_f32 v219, v219, v51
    s_waitcnt lgkmcnt(0)
    v_add_f32 v220, v220, v52
    v_add_f32 v221, v221, v53
    v_add_f32 v222, v222, v54
    v_add_f32 v223, v223, v55
    v_cvt_pk_bf16_f32 v56, v216, v217
    v_cvt_pk_bf16_f32 v57, v218, v219
    v_cvt_pk_bf16_f32 v58, v220, v221
    v_cvt_pk_bf16_f32 v59, v222, v223
    ds_write_b128 v16, v[56:59]
    s_waitcnt lgkmcnt(0)
    s_barrier
    ds_read_b128 v[60:63], v17
    s_waitcnt lgkmcnt(0)
    buffer_store_dwordx4 v[60:63], v18, s[12:15], s40 offen
L_mha_end:
    s_endpgm
L_col_z0:
    v_mov_b32 v144, 0
    v_mov_b32 v146, 0
    v_mov_b32 v148, 0
    v_mov_b32 v150, 0
    v_mov_b32 v152, 0
    v_mov_b32 v154, 0
    v_mov_b32 v156, 0
    v_mov_b32 v158, 0
    s_branch L_col_n0
L_col_z1:
    s_nop 2
    v_and_b32 v32, 0xffff0000, v16
    v_and_b32 v34, 0xffff0000, v17
    v_and_b32 v36, 0xffff0000, v18
    v_and_b32 v38, 0xffff0000, v19
    v_and_b32 v40, 0xffff0000, v20
    v_and_b32 v42, 0xffff0000, v21
    v_and_b32 v44, 0xffff0000, v22
    v_and_b32 v46, 0xffff0000, v23
    s_branch L_col_n1
L_mha_p1r:
    s_waitcnt vmcnt(0) lgkmcnt(0)
    s_add_u32 s73, s73, 1
    s_cmp_lt_u32 s73, 0x8000
    s_cselect_b64 s[74:75], -1, 0
    s_branch L_mha_p1
L_mha_wl:
    s_sub_u32 s76, s3, 4
    s_waitcnt lgkmcnt(0)
    s_barrier
    s_lshl_b32 s77, s76, 1
    s_add_u32 s77, s77, 0
    s_add_u32 s78, s51, s77
    s_and_b32 s78, s78, 7
    s_lshl_b32 s79, s78, 12
    s_add_u32 s79, s79, s46
    s_lshl_b32 s77, s77, 12
    s_add_u32 m0, s77, 0x2000
    s_nop 0
    buffer_load_dwordx4 v9, s[8:11], s79 offen offset:0 lds
    buffer_load_dwordx4 v9, s[8:11], s79 offen offset:1024 lds
    buffer_load_dwordx4 v9, s[8:11], s79 offen offset:2048 lds
    buffer_load_dwordx4 v9, s[8:11], s79 offen offset:3072 lds
    s_lshl_b32 s77, s76, 1
    s_add_u32 s77, s77, 1
    s_add_u32 s78, s51, s77
    s_and_b32 s78, s78, 7
    s_lshl_b32 s79, s78, 12
    s_add_u32 s79, s79, s46
    s_lshl_b32 s77, s77, 12
    s_add_u32 m0, s77, 0x2000
    s_nop 0
    buffer_load_dwordx4 v9, s[8:11], s79 offen offset:0 lds
    buffer_load_dwordx4 v9, s[8:11], s79 offen offset:1024 lds
    buffer_load_dwordx4 v9, s[8:11], s79 offen offset:2048 lds
    buffer_load_dwordx4 v9, s[8:11], s79 offen offset:3072 lds
    s_barrier
    s_lshl_b32 s77, s76, 1
    s_add_u32 s77, s77, 0
    s_add_u32 s78, s51, s77
    s_and_b32 s78, s78, 7
    s_lshl_b32 s79, s78, 11
    s_add_u32 s79, s79, s46
    s_add_u32 s79, s79, 32768
    s_lshl_b32 s77, s77, 11
    s_add_u32 m0, s77, 0xa000
    s_nop 0
    buffer_load_dwordx4 v9, s[8:11], s79 offen offset:0 lds
    buffer_load_dwordx4 v9, s[8:11], s79 offen offset:1024 lds
    s_lshl_b32 s77, s76, 1
    s_add_u32 s77, s77, 1
    s_add_u32 s78, s51, s77
    s_and_b32 s78, s78, 7
    s_lshl_b32 s79, s78, 11
    s_add_u32 s79, s79, s46
    s_add_u32 s79, s79, 32768
    s_lshl_b32 s77, s77, 11
    s_add_u32 m0, s77, 0xa000
    s_nop 0
    buffer_load_dwordx4 v9, s[8:11], s79 offen offset:0 lds
    buffer_load_dwordx4 v9, s[8:11], s79 offen offset:1024 lds
    v_mov_b32 v24, -1
    v_mov_b32 v25, -1
    v_mov_b32 v26, -1
    v_mov_b32 v27, -1
    s_lshl_b32 s77, s43, 3
    s_add_u32 s77, s77, s76
    s_lshl_b32 s77, s77, 15
    s_lshl_b32 s78, s42, 10
    s_add_u32 s77, s77, s78
    s_add_u32 s77, s77, s65
    s_add_u32 s77, s77, 0xe00000
    s_add_u32 s78, s77, 0x20000
    buffer_store_dwordx4 v[24:27], v9, s[8:11], s77 offen sc1
    buffer_store_dwordx4 v[24:27], v9, s[8:11], s78 offen sc1
    s_branch L_mha_join
L_mha_sq0:
    s_cmp_eq_u32 s68, 0
    s_cbranch_scc0 L_mha_kp0
    v_mov_b32 v232, v152
    v_mov_b32 v233, v153
    v_mov_b32 v234, v154
    v_mov_b32 v235, v155
L_mha_kp0:
    s_cmp_eq_u32 s68, 1
    s_cbranch_scc0 L_mha_kp1
    v_mov_b32 v232, v156
    v_mov_b32 v233, v157
    v_mov_b32 v234, v158
    v_mov_b32 v235, v159
L_mha_kp1:
    s_cmp_lt_u32 s42, 8
    s_cbranch_scc0 L_mha_sb0
    v_and_b32 v4, v8, v152
    v_lshlrev_b32 v0, 16, v152
    v_fmac_f32 v10, v4, v4
    v_fmac_f32 v11, v0, v0
    v_and_b32 v4, 0xffff0000, v153
    v_lshlrev_b32 v0, 16, v153
    v_fmac_f32 v10, v4, v4
    v_fmac_f32 v11, v0, v0
    v_and_b32 v4, 0xffff0000, v154
    v_lshlrev_b32 v0, 16, v154
    v_fmac_f32 v10, v4, v4
    v_fmac_f32 v11, v0, v0
    v_and_b32 v4, 0xffff0000, v155
    v_lshlrev_b32 v0, 16, v155
    v_fmac_f32 v10, v4, v4
    v_fmac_f32 v11, v0, v0
    v_and_b32 v4, 0xffff0000, v156
    v_lshlrev_b32 v0, 16, v156
    v_fmac_f32 v10, v4, v4
    v_fmac_f32 v11, v0, v0
    v_and_b32 v4, 0xffff0000, v157
    v_lshlrev_b32 v0, 16, v157
    v_fmac_f32 v10, v4, v4
    v_fmac_f32 v11, v0, v0
    v_and_b32 v4, 0xffff0000, v158
    v_lshlrev_b32 v0, 16, v158
    v_fmac_f32 v10, v4, v4
    v_fmac_f32 v11, v0, v0
    v_and_b32 v4, 0xffff0000, v159
    v_lshlrev_b32 v0, 16, v159
    v_fmac_f32 v10, v4, v4
    v_fmac_f32 v11, v0, v0
    s_branch L_mha_sb0
L_mha_sq1:
    s_cmp_eq_u32 s68, 2
    s_cbranch_scc0 L_mha_kp2
    v_mov_b32 v232, v160
    v_mov_b32 v233, v161
    v_mov_b32 v234, v162
    v_mov_b32 v235, v163
L_mha_kp2:
    s_cmp_eq_u32 s68, 3
    s_cbranch_scc0 L_mha_kp3
    v_mov_b32 v232, v164
    v_mov_b32 v233, v165
    v_mov_b32 v234, v166
    v_mov_b32 v235, v167
L_mha_kp3:
    s_cmp_lt_u32 s42, 8
    s_cbranch_scc0 L_mha_sb1
    v_and_b32 v4, 0xffff0000, v160
    v_lshlrev_b32 v0, 16, v160
    v_fmac_f32 v10, v4, v4
    v_fmac_f32 v11, v0, v0
    v_and_b32 v4, 0xffff0000, v161
    v_lshlrev_b32 v0, 16, v161
    v_fmac_f32 v10, v4, v4
    v_fmac_f32 v11, v0, v0
    v_and_b32 v4, 0xffff0000, v162
    v_lshlrev_b32 v0, 16, v162
    v_fmac_f32 v10, v4, v4
    v_fmac_f32 v11, v0, v0
    v_and_b32 v4, 0xffff0000, v163
    v_lshlrev_b32 v0, 16, v163
    v_fmac_f32 v10, v4, v4
    v_fmac_f32 v11, v0, v0
    v_and_b32 v4, 0xffff0000, v164
    v_lshlrev_b32 v0, 16, v164
    v_fmac_f32 v10, v4, v4
    v_fmac_f32 v11, v0, v0
    v_and_b32 v4, 0xffff0000, v165
    v_lshlrev_b32 v0, 16, v165
    v_fmac_f32 v10, v4, v4
    v_fmac_f32 v11, v0, v0
    v_and_b32 v4, 0xffff0000, v166
    v_lshlrev_b32 v0, 16, v166
    v_fmac_f32 v10, v4, v4
    v_fmac_f32 v11, v0, v0
    v_and_b32 v4, 0xffff0000, v167
    v_lshlrev_b32 v0, 16, v167
    v_fmac_f32 v10, v4, v4
    v_fmac_f32 v11, v0, v0
    v_add_f32 v10, v10, v11
    v_mov_b32 v11, v10
    s_nop 1
    v_permlane32_swap_b32 v10, v11
    v_add_f32 v10, v10, v11
    v_and_b32 v10, 0x7fffffff, v10
    v_cmp_u_f32 vcc, v10, v10
    s_nop 1
    s_and_b64 vcc, vcc, s[74:75]
    s_cbranch_vccnz L_mha_p1r
    s_mov_b32 exec_hi, 0
    buffer_store_dword v10, v150, s[8:11], s59 offen sc1
    s_mov_b64 exec, -1
    s_branch L_mha_sb1
L_mha_ps:
    s_mov_b32 s70, 0
L_mha_ps2:
    buffer_load_dword v144, v151, s[8:11], s58 offen sc1
    buffer_load_dword v145, v151, s[8:11], s58 offen offset:128 sc1
    buffer_load_dword v146, v151, s[8:11], s58 offen offset:256 sc1
    buffer_load_dword v147, v151, s[8:11], s58 offen offset:384 sc1
    s_add_u32 s70, s70, 1
    s_waitcnt vmcnt(0)
    v_or3_b32 v4, v144, v145, v146
    v_or_b32 v4, v4, v147
    v_cmp_gt_i32 vcc, 0, v4
    s_cmp_gt_u32 s70, 0x40000
    s_cbranch_scc1 L_mha_ps1
    s_cbranch_vccnz L_mha_ps2
    s_branch L_mha_ps1
L_mha_re0:
    buffer_load_dword v2, v8, s[8:11], s56 offen sc1
    s_branch L_mha_nr0
L_mha_us:
    s_mov_b32 s70, 0
L_mha_us2:
    buffer_load_dword v2, v151, s[8:11], s69 offen sc1
    s_add_u32 s70, s70, 1
    s_waitcnt vmcnt(0)
    v_cmp_ne_u32 vcc, 1, v2
    s_cmp_gt_u32 s70, 0x40000
    s_cbranch_scc1 L_mha_ub
    s_cbranch_vccnz L_mha_us2
    s_branch L_mha_ub
L_mha_spin0:
    s_mov_b32 s70, 0
L_mha_spin:
    buffer_load_dword v2, v8, s[8:11], s56 offen sc1
    s_add_u32 s70, s70, 1
    s_waitcnt vmcnt(0)
    v_cmp_ne_u32 vcc, 1, v2
    s_cmp_gt_u32 s70, 0x40000
    s_cbranch_scc1 L_mha_go
    s_cbranch_vccnz L_mha_spin
L_mha_go:
    s_and_b32 s51, s50, 7
    s_lshl_b32 s51, s51, 13
    s_mov_b32 m0, s49
    s_add_u32 s51, s51, s48
    buffer_load_dwordx4 v9, s[8:11], s51 offen sc1 lds
    s_add_u32 m0, s49, 0x10000
    s_add_u32 s51, s51, 0x200000
    buffer_load_dwordx4 v9, s[8:11], s51 offen sc1 lds
    s_add_u32 s49, s49, 8192
    s_add_u32 s50, s50, 1
    s_and_b32 s51, s50, 7
    s_lshl_b32 s51, s51, 13
    s_mov_b32 m0, s49
    s_add_u32 s51, s51, s48
    buffer_load_dwordx4 v9, s[8:11], s51 offen sc1 lds
    s_add_u32 m0, s49, 0x10000
    s_add_u32 s51, s51, 0x200000
    buffer_load_dwordx4 v9, s[8:11], s51 offen sc1 lds
    s_add_u32 s49, s49, 8192
    s_add_u32 s50, s50, 1
    s_branch L_mha_rdy
L_mha_x45:
    v_exp_f32 v48, v48
    v_exp_f32 v49, v49
    v_smfmac_f32_32x32x32_bf16 v[128:143], v[44:47], v[72:79], v12
    ds_read_b128 v[40:43], v7 offset:1024
    ds_read_b128 v[44:47], v7 offset:1536
    v_exp_f32 v50, v50
    v_exp_f32 v51, v51
    v_exp_f32 v52, v52
    v_mfma_f32_32x32x16_bf16 v[64:79], v[24:27], v[20:23], v[96:111]
    ds_read_b128 v[24:27], v6 offset:2048
    v_exp_f32 v53, v53
    v_exp_f32 v54, v54
    v_exp_f32 v55, v55
    v_exp_f32 v56, v56
    v_exp_f32 v57, v57
    s_waitcnt lgkmcnt(3)
    v_smfmac_f32_32x32x32_bf16 v[112:127], v[32:35], v[48:55], v12
    buffer_load_dwordx4 v[152:155], v148, s[8:11], s76 offen offset:0
    buffer_load_dwordx4 v[184:187], v150, s[8:11], s78 offen offset:0 sc1
    v_exp_f32 v58, v58
    v_exp_f32 v59, v59
    v_exp_f32 v60, v60
    v_exp_f32 v61, v61
    v_exp_f32 v62, v62
    v_exp_f32 v63, v63
    v_exp_f32 v64, v64
    v_exp_f32 v65, v65
    v_smfmac_f32_32x32x32_bf16 v[112:127], v[36:39], v[56:63], v12
    v_exp_f32 v66, v66
    v_exp_f32 v67, v67
    v_exp_f32 v68, v68
    v_mfma_f32_32x32x16_bf16 v[48:63], v[28:31], v[16:19], v[80:95]
    v_exp_f32 v69, v69
    v_exp_f32 v70, v70
    v_exp_f32 v71, v71
    v_exp_f32 v72, v72
    v_exp_f32 v73, v73
    v_smfmac_f32_32x32x32_bf16 v[128:143], v[32:35], v[64:71], v12
    buffer_load_dwordx4 v[156:159], v148, s[8:11], s76 offen offset:1024
    buffer_load_dwordx4 v[188:191], v150, s[8:11], s78 offen offset:1024 sc1
    v_exp_f32 v74, v74
    v_exp_f32 v75, v75
    v_exp_f32 v76, v76
    v_exp_f32 v77, v77
    v_exp_f32 v78, v78
    v_exp_f32 v79, v79
    v_exp_f32 v48, v48
    v_exp_f32 v49, v49
    v_smfmac_f32_32x32x32_bf16 v[128:143], v[36:39], v[72:79], v12
    ds_read_b128 v[32:35], v7 offset:2048
    ds_read_b128 v[36:39], v7 offset:2560
    v_exp_f32 v50, v50
    v_exp_f32 v51, v51
    v_exp_f32 v52, v52
    v_mfma_f32_32x32x16_bf16 v[64:79], v[28:31], v[20:23], v[96:111]
    ds_read_b128 v[28:31], v6 offset:3072
    v_exp_f32 v53, v53
    v_exp_f32 v54, v54
    v_exp_f32 v55, v55
    v_exp_f32 v56, v56
    v_exp_f32 v57, v57
    s_waitcnt lgkmcnt(3)
    v_smfmac_f32_32x32x32_bf16 v[112:127], v[40:43], v[48:55], v12
    buffer_load_dwordx4 v[160:163], v148, s[8:11], s76 offen offset:2048
    buffer_load_dwordx4 v[192:195], v150, s[8:11], s78 offen offset:2048 sc1
    v_exp_f32 v58, v58
    v_exp_f32 v59, v59
    v_exp_f32 v60, v60
    v_exp_f32 v61, v61
    v_exp_f32 v62, v62
    v_exp_f32 v63, v63
    v_exp_f32 v64, v64
    v_exp_f32 v65, v65
    v_smfmac_f32_32x32x32_bf16 v[112:127], v[44:47], v[56:63], v12
    v_exp_f32 v66, v66
    v_exp_f32 v67, v67
    v_exp_f32 v68, v68
    v_mfma_f32_32x32x16_bf16 v[48:63], v[24:27], v[16:19], v[80:95]
    v_exp_f32 v69, v69
    v_exp_f32 v70, v70
    v_exp_f32 v71, v71
    v_exp_f32 v72, v72
    v_exp_f32 v73, v73
    v_smfmac_f32_32x32x32_bf16 v[128:143], v[40:43], v[64:71], v12
    buffer_load_dwordx4 v[164:167], v148, s[8:11], s76 offen offset:3072
    buffer_load_dwordx4 v[196:199], v150, s[8:11], s78 offen offset:3072 sc1
    v_exp_f32 v74, v74
    v_exp_f32 v75, v75
    v_exp_f32 v76, v76
    v_exp_f32 v77, v77
    v_exp_f32 v78, v78
    v_exp_f32 v79, v79
    v_exp_f32 v48, v48
    v_exp_f32 v49, v49
    v_smfmac_f32_32x32x32_bf16 v[128:143], v[44:47], v[72:79], v12
    ds_read_b128 v[40:43], v7 offset:3072
    ds_read_b128 v[44:47], v7 offset:3584
    v_exp_f32 v50, v50
    v_exp_f32 v51, v51
    v_exp_f32 v52, v52
    v_mfma_f32_32x32x16_bf16 v[64:79], v[24:27], v[20:23], v[96:111]
    ds_read_b128 v[24:27], v6 offset:8192
    v_exp_f32 v53, v53
    v_exp_f32 v54, v54
    v_exp_f32 v55, v55
    v_exp_f32 v56, v56
    v_exp_f32 v57, v57
    s_waitcnt lgkmcnt(3)
    v_smfmac_f32_32x32x32_bf16 v[112:127], v[32:35], v[48:55], v12
    buffer_load_dwordx4 v[168:171], v148, s[8:11], s77 offen offset:0
    buffer_load_dwordx4 v[200:203], v150, s[8:11], s79 offen offset:0 sc1
    v_exp_f32 v58, v58
    v_exp_f32 v59, v59
    v_exp_f32 v60, v60
    v_exp_f32 v61, v61
    v_exp_f32 v62, v62
    v_exp_f32 v63, v63
    v_exp_f32 v64, v64
    v_exp_f32 v65, v65
    v_smfmac_f32_32x32x32_bf16 v[112:127], v[36:39], v[56:63], v12
    v_exp_f32 v66, v66
    v_exp_f32 v67, v67
    v_exp_f32 v68, v68
    v_mfma_f32_32x32x16_bf16 v[48:63], v[28:31], v[16:19], v[80:95]
    v_exp_f32 v69, v69
    v_exp_f32 v70, v70
    v_exp_f32 v71, v71
    v_exp_f32 v72, v72
    v_exp_f32 v73, v73
    v_smfmac_f32_32x32x32_bf16 v[128:143], v[32:35], v[64:71], v12
    buffer_load_dwordx4 v[172:175], v148, s[8:11], s77 offen offset:1024
    buffer_load_dwordx4 v[204:207], v150, s[8:11], s79 offen offset:1024 sc1
    v_exp_f32 v74, v74
    v_exp_f32 v75, v75
    v_exp_f32 v76, v76
    v_exp_f32 v77, v77
    v_exp_f32 v78, v78
    v_exp_f32 v79, v79
    v_exp_f32 v48, v48
    v_exp_f32 v49, v49
    v_smfmac_f32_32x32x32_bf16 v[128:143], v[36:39], v[72:79], v12
    ds_read_b128 v[32:35], v7 offset:8192
    ds_read_b128 v[36:39], v7 offset:8704
    v_exp_f32 v50, v50
    v_exp_f32 v51, v51
    v_exp_f32 v52, v52
    v_mfma_f32_32x32x16_bf16 v[64:79], v[28:31], v[20:23], v[96:111]
    ds_read_b128 v[28:31], v6 offset:9216
    v_exp_f32 v53, v53
    v_exp_f32 v54, v54
    v_exp_f32 v55, v55
    v_exp_f32 v56, v56
    v_exp_f32 v57, v57
    s_waitcnt lgkmcnt(3)
    v_smfmac_f32_32x32x32_bf16 v[112:127], v[40:43], v[48:55], v12
    buffer_load_dwordx4 v[176:179], v148, s[8:11], s77 offen offset:2048
    buffer_load_dwordx4 v[208:211], v150, s[8:11], s79 offen offset:2048 sc1
    v_exp_f32 v58, v58
    v_exp_f32 v59, v59
    v_exp_f32 v60, v60
    v_exp_f32 v61, v61
    v_exp_f32 v62, v62
    v_exp_f32 v63, v63
    v_exp_f32 v64, v64
    v_exp_f32 v65, v65
    v_smfmac_f32_32x32x32_bf16 v[112:127], v[44:47], v[56:63], v12
    v_exp_f32 v66, v66
    v_exp_f32 v67, v67
    v_exp_f32 v68, v68
    v_mfma_f32_32x32x16_bf16 v[48:63], v[24:27], v[16:19], v[80:95]
    v_exp_f32 v69, v69
    v_exp_f32 v70, v70
    v_exp_f32 v71, v71
    v_exp_f32 v72, v72
    v_exp_f32 v73, v73
    v_smfmac_f32_32x32x32_bf16 v[128:143], v[40:43], v[64:71], v12
    v_add_u32 v6, 8192, v6
    v_add_u32 v7, v15, v7
    buffer_load_dwordx4 v[180:183], v148, s[8:11], s77 offen offset:3072
    buffer_load_dwordx4 v[212:215], v150, s[8:11], s79 offen offset:3072 sc1
    v_exp_f32 v74, v74
    v_exp_f32 v75, v75
    v_exp_f32 v76, v76
    v_exp_f32 v77, v77
    v_exp_f32 v78, v78
    v_exp_f32 v79, v79
    v_exp_f32 v48, v48
    v_exp_f32 v49, v49
    v_smfmac_f32_32x32x32_bf16 v[128:143], v[44:47], v[72:79], v12
    s_add_u32 s76, s76, 8192
    s_add_u32 s77, s77, 8192
    s_add_u32 s78, s78, 8192
    s_add_u32 s79, s79, 8192
    ds_read_b128 v[40:43], v7 offset:1024
    ds_read_b128 v[44:47], v7 offset:1536
    v_exp_f32 v50, v50
    v_exp_f32 v51, v51
    v_exp_f32 v52, v52
    v_mfma_f32_32x32x16_bf16 v[64:79], v[24:27], v[20:23], v[96:111]
    ds_read_b128 v[24:27], v6 offset:2048
    v_exp_f32 v53, v53
    v_exp_f32 v54, v54
    v_exp_f32 v55, v55
    v_exp_f32 v56, v56
    v_exp_f32 v57, v57
    s_waitcnt lgkmcnt(3)
    v_smfmac_f32_32x32x32_bf16 v[112:127], v[32:35], v[48:55], v12
    v_exp_f32 v58, v58
    v_exp_f32 v59, v59
    v_exp_f32 v60, v60
    v_exp_f32 v61, v61
    s_waitcnt vmcnt(14)
    v_mfma_f32_32x32x16_bf16 v[216:231], v[152:155], v[184:187], v[216:231]
    buffer_load_dwordx4 v[152:155], v148, s[8:11], s76 offen offset:0
    buffer_load_dwordx4 v[184:187], v150, s[8:11], s78 offen offset:0 sc1
    v_exp_f32 v62, v62
    v_exp_f32 v63, v63
    v_exp_f32 v64, v64
    v_exp_f32 v65, v65
    v_smfmac_f32_32x32x32_bf16 v[112:127], v[36:39], v[56:63], v12
    v_exp_f32 v66, v66
    v_exp_f32 v67, v67
    v_exp_f32 v68, v68
    v_mfma_f32_32x32x16_bf16 v[48:63], v[28:31], v[16:19], v[80:95]
    v_exp_f32 v69, v69
    v_exp_f32 v70, v70
    v_exp_f32 v71, v71
    v_exp_f32 v72, v72
    v_exp_f32 v73, v73
    v_smfmac_f32_32x32x32_bf16 v[128:143], v[32:35], v[64:71], v12
    v_exp_f32 v74, v74
    v_exp_f32 v75, v75
    v_exp_f32 v76, v76
    v_exp_f32 v77, v77
    s_waitcnt vmcnt(14)
    v_mfma_f32_32x32x16_bf16 v[216:231], v[156:159], v[188:191], v[216:231]
    buffer_load_dwordx4 v[156:159], v148, s[8:11], s76 offen offset:1024
    buffer_load_dwordx4 v[188:191], v150, s[8:11], s78 offen offset:1024 sc1
    v_exp_f32 v78, v78
    v_exp_f32 v79, v79
    v_exp_f32 v48, v48
    v_exp_f32 v49, v49
    v_smfmac_f32_32x32x32_bf16 v[128:143], v[36:39], v[72:79], v12
    ds_read_b128 v[32:35], v7 offset:2048
    ds_read_b128 v[36:39], v7 offset:2560
    v_exp_f32 v50, v50
    v_exp_f32 v51, v51
    v_exp_f32 v52, v52
    v_mfma_f32_32x32x16_bf16 v[64:79], v[28:31], v[20:23], v[96:111]
    ds_read_b128 v[28:31], v6 offset:3072
    v_exp_f32 v53, v53
    v_exp_f32 v54, v54
    v_exp_f32 v55, v55
    v_exp_f32 v56, v56
    v_exp_f32 v57, v57
    s_waitcnt lgkmcnt(3)
    v_smfmac_f32_32x32x32_bf16 v[112:127], v[40:43], v[48:55], v12
    v_exp_f32 v58, v58
    v_exp_f32 v59, v59
    v_exp_f32 v60, v60
    v_exp_f32 v61, v61
    s_waitcnt vmcnt(14)
    v_mfma_f32_32x32x16_bf16 v[216:231], v[160:163], v[192:195], v[216:231]
    buffer_load_dwordx4 v[160:163], v148, s[8:11], s76 offen offset:2048
    buffer_load_dwordx4 v[192:195], v150, s[8:11], s78 offen offset:2048 sc1
    v_exp_f32 v62, v62
    v_exp_f32 v63, v63
    v_exp_f32 v64, v64
    v_exp_f32 v65, v65
    v_smfmac_f32_32x32x32_bf16 v[112:127], v[44:47], v[56:63], v12
    v_exp_f32 v66, v66
    v_exp_f32 v67, v67
    v_exp_f32 v68, v68
    v_mfma_f32_32x32x16_bf16 v[48:63], v[24:27], v[16:19], v[80:95]
    v_exp_f32 v69, v69
    v_exp_f32 v70, v70
    v_exp_f32 v71, v71
    v_exp_f32 v72, v72
    v_exp_f32 v73, v73
    v_smfmac_f32_32x32x32_bf16 v[128:143], v[40:43], v[64:71], v12
    v_exp_f32 v74, v74
    v_exp_f32 v75, v75
    v_exp_f32 v76, v76
    v_exp_f32 v77, v77
    s_waitcnt vmcnt(14)
    v_mfma_f32_32x32x16_bf16 v[216:231], v[164:167], v[196:199], v[216:231]
    buffer_load_dwordx4 v[164:167], v148, s[8:11], s76 offen offset:3072
    buffer_load_dwordx4 v[196:199], v150, s[8:11], s78 offen offset:3072 sc1
    v_exp_f32 v78, v78
    v_exp_f32 v79, v79
    v_exp_f32 v48, v48
    v_exp_f32 v49, v49
    v_smfmac_f32_32x32x32_bf16 v[128:143], v[44:47], v[72:79], v12
    ds_read_b128 v[40:43], v7 offset:3072
    ds_read_b128 v[44:47], v7 offset:3584
    v_exp_f32 v50, v50
    v_exp_f32 v51, v51
    v_exp_f32 v52, v52
    v_mfma_f32_32x32x16_bf16 v[64:79], v[24:27], v[20:23], v[96:111]
    ds_read_b128 v[24:27], v6 offset:8192
    v_exp_f32 v53, v53
    v_exp_f32 v54, v54
    v_exp_f32 v55, v55
    v_exp_f32 v56, v56
    v_exp_f32 v57, v57
    s_waitcnt lgkmcnt(3)
    v_smfmac_f32_32x32x32_bf16 v[112:127], v[32:35], v[48:55], v12
    v_exp_f32 v58, v58
    v_exp_f32 v59, v59
    v_exp_f32 v60, v60
    v_exp_f32 v61, v61
    s_waitcnt vmcnt(14)
    v_mfma_f32_32x32x16_bf16 v[216:231], v[168:171], v[200:203], v[216:231]
    buffer_load_dwordx4 v[168:171], v148, s[8:11], s77 offen offset:0
    buffer_load_dwordx4 v[200:203], v150, s[8:11], s79 offen offset:0 sc1
    v_exp_f32 v62, v62
    v_exp_f32 v63, v63
    v_exp_f32 v64, v64
    v_exp_f32 v65, v65
    v_smfmac_f32_32x32x32_bf16 v[112:127], v[36:39], v[56:63], v12
    v_exp_f32 v66, v66
    v_exp_f32 v67, v67
    v_exp_f32 v68, v68
    v_mfma_f32_32x32x16_bf16 v[48:63], v[28:31], v[16:19], v[80:95]
    v_exp_f32 v69, v69
    v_exp_f32 v70, v70
    v_exp_f32 v71, v71
    v_exp_f32 v72, v72
    v_exp_f32 v73, v73
    v_smfmac_f32_32x32x32_bf16 v[128:143], v[32:35], v[64:71], v12
    v_exp_f32 v74, v74
    v_exp_f32 v75, v75
    v_exp_f32 v76, v76
    v_exp_f32 v77, v77
    s_waitcnt vmcnt(14)
    v_mfma_f32_32x32x16_bf16 v[216:231], v[172:175], v[204:207], v[216:231]
    buffer_load_dwordx4 v[172:175], v148, s[8:11], s77 offen offset:1024
    buffer_load_dwordx4 v[204:207], v150, s[8:11], s79 offen offset:1024 sc1
    v_exp_f32 v78, v78
    v_exp_f32 v79, v79
    v_exp_f32 v48, v48
    v_exp_f32 v49, v49
    v_smfmac_f32_32x32x32_bf16 v[128:143], v[36:39], v[72:79], v12
    ds_read_b128 v[32:35], v7 offset:8192
    ds_read_b128 v[36:39], v7 offset:8704
    v_exp_f32 v50, v50
    v_exp_f32 v51, v51
    v_exp_f32 v52, v52
    v_mfma_f32_32x32x16_bf16 v[64:79], v[28:31], v[20:23], v[96:111]
    ds_read_b128 v[28:31], v6 offset:9216
    v_exp_f32 v53, v53
    v_exp_f32 v54, v54
    v_exp_f32 v55, v55
    v_exp_f32 v56, v56
    v_exp_f32 v57, v57
    s_waitcnt lgkmcnt(3)
    v_smfmac_f32_32x32x32_bf16 v[112:127], v[40:43], v[48:55], v12
    v_exp_f32 v58, v58
    v_exp_f32 v59, v59
    v_exp_f32 v60, v60
    v_exp_f32 v61, v61
    s_waitcnt vmcnt(14)
    v_mfma_f32_32x32x16_bf16 v[216:231], v[176:179], v[208:211], v[216:231]
    buffer_load_dwordx4 v[176:179], v148, s[8:11], s77 offen offset:2048
    buffer_load_dwordx4 v[208:211], v150, s[8:11], s79 offen offset:2048 sc1
    v_exp_f32 v62, v62
    v_exp_f32 v63, v63
    v_exp_f32 v64, v64
    v_exp_f32 v65, v65
    v_smfmac_f32_32x32x32_bf16 v[112:127], v[44:47], v[56:63], v12
    v_exp_f32 v66, v66
    v_exp_f32 v67, v67
    v_exp_f32 v68, v68
    v_mfma_f32_32x32x16_bf16 v[48:63], v[24:27], v[16:19], v[80:95]
    v_exp_f32 v69, v69
    v_exp_f32 v70, v70
    v_exp_f32 v71, v71
    v_exp_f32 v72, v72
    v_exp_f32 v73, v73
    v_smfmac_f32_32x32x32_bf16 v[128:143], v[40:43], v[64:71], v12
    v_add_u32 v6, 8192, v6
    v_add_u32 v7, v15, v7
    v_exp_f32 v74, v74
    v_exp_f32 v75, v75
    v_exp_f32 v76, v76
    v_exp_f32 v77, v77
    s_waitcnt vmcnt(14)
    v_mfma_f32_32x32x16_bf16 v[216:231], v[180:183], v[212:215], v[216:231]
    buffer_load_dwordx4 v[180:183], v148, s[8:11], s77 offen offset:3072
    buffer_load_dwordx4 v[212:215], v150, s[8:11], s79 offen offset:3072 sc1
    v_exp_f32 v78, v78
    v_exp_f32 v79, v79
    v_exp_f32 v48, v48
    v_exp_f32 v49, v49
    v_smfmac_f32_32x32x32_bf16 v[128:143], v[44:47], v[72:79], v12
    s_setprio 0
    s_lshl_b32 s75, s66, 19
    s_add_u32 s76, s74, s75
    s_add_u32 s76, s76, 0x800000
    s_add_u32 s78, s76, 8192
    v_mov_b32 v150, v148
    s_add_u32 s77, s76, 4096
    s_add_u32 s79, s78, 4096
    ds_read_b128 v[40:43], v7 offset:1024
    ds_read_b128 v[44:47], v7 offset:1536
    v_exp_f32 v50, v50
    v_exp_f32 v51, v51
    v_exp_f32 v52, v52
    v_mfma_f32_32x32x16_bf16 v[64:79], v[24:27], v[20:23], v[96:111]
    ds_read_b128 v[24:27], v6 offset:2048
    v_exp_f32 v53, v53
    v_exp_f32 v54, v54
    v_exp_f32 v55, v55
    v_exp_f32 v56, v56
    v_exp_f32 v57, v57
    s_waitcnt lgkmcnt(3)
    v_smfmac_f32_32x32x32_bf16 v[112:127], v[32:35], v[48:55], v12
    v_exp_f32 v58, v58
    v_exp_f32 v59, v59
    v_exp_f32 v60, v60
    v_exp_f32 v61, v61
    s_waitcnt vmcnt(14)
    v_mfma_f32_32x32x16_bf16 v[216:231], v[152:155], v[184:187], v[216:231]
    buffer_load_dwordx4 v[152:155], v148, s[8:11], s76 offen offset:0
    buffer_load_dwordx4 v[184:187], v150, s[8:11], s78 offen offset:0 sc1
    v_exp_f32 v62, v62
    v_exp_f32 v63, v63
    v_exp_f32 v64, v64
    v_exp_f32 v65, v65
    v_smfmac_f32_32x32x32_bf16 v[112:127], v[36:39], v[56:63], v12
    v_exp_f32 v66, v66
    v_exp_f32 v67, v67
    v_exp_f32 v68, v68
    v_mfma_f32_32x32x16_bf16 v[48:63], v[28:31], v[16:19], v[80:95]
    v_exp_f32 v69, v69
    v_exp_f32 v70, v70
    v_exp_f32 v71, v71
    v_exp_f32 v72, v72
    v_exp_f32 v73, v73
    v_smfmac_f32_32x32x32_bf16 v[128:143], v[32:35], v[64:71], v12
    v_exp_f32 v74, v74
    v_exp_f32 v75, v75
    v_exp_f32 v76, v76
    v_exp_f32 v77, v77
    s_waitcnt vmcnt(14)
    v_mfma_f32_32x32x16_bf16 v[216:231], v[156:159], v[188:191], v[216:231]
    buffer_load_dwordx4 v[156:159], v148, s[8:11], s76 offen offset:1024
    buffer_load_dwordx4 v[188:191], v150, s[8:11], s78 offen offset:1024 sc1
    v_exp_f32 v78, v78
    v_exp_f32 v79, v79
    v_exp_f32 v48, v48
    v_exp_f32 v49, v49
    v_smfmac_f32_32x32x32_bf16 v[128:143], v[36:39], v[72:79], v12
    ds_read_b128 v[32:35], v7 offset:2048
    ds_read_b128 v[36:39], v7 offset:2560
    v_exp_f32 v50, v50
    v_exp_f32 v51, v51
    v_exp_f32 v52, v52
    v_mfma_f32_32x32x16_bf16 v[64:79], v[28:31], v[20:23], v[96:111]
    ds_read_b128 v[28:31], v6 offset:3072
    v_exp_f32 v53, v53
    v_exp_f32 v54, v54
    v_exp_f32 v55, v55
    v_exp_f32 v56, v56
    v_exp_f32 v57, v57
    s_waitcnt lgkmcnt(3)
    v_smfmac_f32_32x32x32_bf16 v[112:127], v[40:43], v[48:55], v12
    v_exp_f32 v58, v58
    v_exp_f32 v59, v59
    v_exp_f32 v60, v60
    v_exp_f32 v61, v61
    s_waitcnt vmcnt(14)
    v_mfma_f32_32x32x16_bf16 v[216:231], v[160:163], v[192:195], v[216:231]
    buffer_load_dwordx4 v[160:163], v148, s[8:11], s76 offen offset:2048
    buffer_load_dwordx4 v[192:195], v150, s[8:11], s78 offen offset:2048 sc1
    v_exp_f32 v62, v62
    v_exp_f32 v63, v63
    v_exp_f32 v64, v64
    v_exp_f32 v65, v65
    v_smfmac_f32_32x32x32_bf16 v[112:127], v[44:47], v[56:63], v12
    v_exp_f32 v66, v66
    v_exp_f32 v67, v67
    v_exp_f32 v68, v68
    v_mfma_f32_32x32x16_bf16 v[48:63], v[24:27], v[16:19], v[80:95]
    v_exp_f32 v69, v69
    v_exp_f32 v70, v70
    v_exp_f32 v71, v71
    v_exp_f32 v72, v72
    v_exp_f32 v73, v73
    v_smfmac_f32_32x32x32_bf16 v[128:143], v[40:43], v[64:71], v12
    v_exp_f32 v74, v74
    v_exp_f32 v75, v75
    v_exp_f32 v76, v76
    v_exp_f32 v77, v77
    s_waitcnt vmcnt(14)
    v_mfma_f32_32x32x16_bf16 v[216:231], v[164:167], v[196:199], v[216:231]
    buffer_load_dwordx4 v[164:167], v148, s[8:11], s76 offen offset:3072
    buffer_load_dwordx4 v[196:199], v150, s[8:11], s78 offen offset:3072 sc1
    v_exp_f32 v78, v78
    v_exp_f32 v79, v79
    v_exp_f32 v48, v48
    v_exp_f32 v49, v49
    v_smfmac_f32_32x32x32_bf16 v[128:143], v[44:47], v[72:79], v12
    ds_read_b128 v[40:43], v7 offset:3072
    ds_read_b128 v[44:47], v7 offset:3584
    v_exp_f32 v50, v50
    v_exp_f32 v51, v51
    v_exp_f32 v52, v52
    v_mfma_f32_32x32x16_bf16 v[64:79], v[24:27], v[20:23], v[96:111]
    ds_read_b128 v[24:27], v6 offset:8192
    v_exp_f32 v53, v53
    v_exp_f32 v54, v54
    v_exp_f32 v55, v55
    v_exp_f32 v56, v56
    v_exp_f32 v57, v57
    s_waitcnt lgkmcnt(3)
    v_smfmac_f32_32x32x32_bf16 v[112:127], v[32:35], v[48:55], v12
    v_exp_f32 v58, v58
    v_exp_f32 v59, v59
    v_exp_f32 v60, v60
    v_exp_f32 v61, v61
    s_waitcnt vmcnt(14)
    v_mfma_f32_32x32x16_bf16 v[216:231], v[168:171], v[200:203], v[216:231]
    buffer_load_dwordx4 v[168:171], v148, s[8:11], s77 offen offset:0
    buffer_load_dwordx4 v[200:203], v150, s[8:11], s79 offen offset:0 sc1
    v_exp_f32 v62, v62
    v_exp_f32 v63, v63
    v_exp_f32 v64, v64
    v_exp_f32 v65, v65
    v_smfmac_f32_32x32x32_bf16 v[112:127], v[36:39], v[56:63], v12
    v_exp_f32 v66, v66
    v_exp_f32 v67, v67
    v_exp_f32 v68, v68
    v_mfma_f32_32x32x16_bf16 v[48:63], v[28:31], v[16:19], v[80:95]
    v_exp_f32 v69, v69
    v_exp_f32 v70, v70
    v_exp_f32 v71, v71
    v_exp_f32 v72, v72
    v_exp_f32 v73, v73
    v_smfmac_f32_32x32x32_bf16 v[128:143], v[32:35], v[64:71], v12
    v_exp_f32 v74, v74
    v_exp_f32 v75, v75
    v_exp_f32 v76, v76
    v_exp_f32 v77, v77
    s_waitcnt vmcnt(14)
    v_mfma_f32_32x32x16_bf16 v[216:231], v[172:175], v[204:207], v[216:231]
    buffer_load_dwordx4 v[172:175], v148, s[8:11], s77 offen offset:1024
    buffer_load_dwordx4 v[204:207], v150, s[8:11], s79 offen offset:1024 sc1
    v_exp_f32 v78, v78
    v_exp_f32 v79, v79
    v_exp_f32 v48, v48
    v_exp_f32 v49, v49
    v_smfmac_f32_32x32x32_bf16 v[128:143], v[36:39], v[72:79], v12
    ds_read_b128 v[32:35], v7 offset:8192
    ds_read_b128 v[36:39], v7 offset:8704
    v_exp_f32 v50, v50
    v_exp_f32 v51, v51
    v_exp_f32 v52, v52
    v_mfma_f32_32x32x16_bf16 v[64:79], v[28:31], v[20:23], v[96:111]
    ds_read_b128 v[28:31], v6 offset:9216
    v_exp_f32 v53, v53
    v_exp_f32 v54, v54
    v_exp_f32 v55, v55
    v_exp_f32 v56, v56
    v_exp_f32 v57, v57
    s_waitcnt lgkmcnt(3)
    v_smfmac_f32_32x32x32_bf16 v[112:127], v[40:43], v[48:55], v12
    v_exp_f32 v58, v58
    v_exp_f32 v59, v59
    v_exp_f32 v60, v60
    v_exp_f32 v61, v61
    s_waitcnt vmcnt(14)
    v_mfma_f32_32x32x16_bf16 v[216:231], v[176:179], v[208:211], v[216:231]
    buffer_load_dwordx4 v[176:179], v148, s[8:11], s77 offen offset:2048
    buffer_load_dwordx4 v[208:211], v150, s[8:11], s79 offen offset:2048 sc1
    v_exp_f32 v62, v62
    v_exp_f32 v63, v63
    v_exp_f32 v64, v64
    v_exp_f32 v65, v65
    v_smfmac_f32_32x32x32_bf16 v[112:127], v[44:47], v[56:63], v12
    v_exp_f32 v66, v66
    v_exp_f32 v67, v67
    v_exp_f32 v68, v68
    v_mfma_f32_32x32x16_bf16 v[48:63], v[24:27], v[16:19], v[80:95]
    v_exp_f32 v69, v69
    v_exp_f32 v70, v70
    v_exp_f32 v71, v71
    v_exp_f32 v72, v72
    v_exp_f32 v73, v73
    v_smfmac_f32_32x32x32_bf16 v[128:143], v[40:43], v[64:71], v12
    v_add_u32 v6, 8192, v6
    v_add_u32 v7, v15, v7
    v_exp_f32 v74, v74
    v_exp_f32 v75, v75
    v_exp_f32 v76, v76
    v_exp_f32 v77, v77
    s_waitcnt vmcnt(14)
    v_mfma_f32_32x32x16_bf16 v[216:231], v[180:183], v[212:215], v[216:231]
    buffer_load_dwordx4 v[180:183], v148, s[8:11], s77 offen offset:3072
    buffer_load_dwordx4 v[212:215], v150, s[8:11], s79 offen offset:3072 sc1
    v_exp_f32 v78, v78
    v_exp_f32 v79, v79
    s_branch L_mha_i7
L_mha_slow:
    s_waitcnt lgkmcnt(0)
    s_mov_b32 s63, 0
    v_mov_b32 v6, v13
    v_mov_b32 v4, 0xff800000
    v_mov_b32 v5, 0xff800000
    v_mov_b32 v112, 0
    v_mov_b32 v113, 0
    v_mov_b32 v114, 0
    v_mov_b32 v115, 0
    v_mov_b32 v116, 0
    v_mov_b32 v117, 0
    v_mov_b32 v118, 0
    v_mov_b32 v119, 0
    v_mov_b32 v120, 0
    v_mov_b32 v121, 0
    v_mov_b32 v122, 0
    v_mov_b32 v123, 0
    v_mov_b32 v124, 0
    v_mov_b32 v125, 0
    v_mov_b32 v126, 0
    v_mov_b32 v127, 0
    v_mov_b32 v128, 0
    v_mov_b32 v129, 0
    v_mov_b32 v130, 0
    v_mov_b32 v131, 0
    v_mov_b32 v132, 0
    v_mov_b32 v133, 0
    v_mov_b32 v134, 0
    v_mov_b32 v135, 0
    v_mov_b32 v136, 0
    v_mov_b32 v137, 0
    v_mov_b32 v138, 0
    v_mov_b32 v139, 0
    v_mov_b32 v140, 0
    v_mov_b32 v141, 0
    v_mov_b32 v142, 0
    v_mov_b32 v143, 0
L_mha_maxloop:
    ds_read_b128 v[24:27], v6 offset:0
    s_waitcnt lgkmcnt(0)
    v_mfma_f32_32x32x16_bf16 v[48:63], v[24:27], v[16:19], 0
    v_mfma_f32_32x32x16_bf16 v[64:79], v[24:27], v[20:23], 0
    s_nop 10
    v_max3_f32 v4, v4, v48, v49
    v_max3_f32 v4, v4, v50, v51
    v_max3_f32 v4, v4, v52, v53
    v_max3_f32 v4, v4, v54, v55
    v_max3_f32 v4, v4, v56, v57
    v_max3_f32 v4, v4, v58, v59
    v_max3_f32 v4, v4, v60, v61
    v_max3_f32 v4, v4, v62, v63
    v_max3_f32 v5, v5, v64, v65
    v_max3_f32 v5, v5, v66, v67
    v_max3_f32 v5, v5, v68, v69
    v_max3_f32 v5, v5, v70, v71
    v_max3_f32 v5, v5, v72, v73
    v_max3_f32 v5, v5, v74, v75
    v_max3_f32 v5, v5, v76, v77
    v_max3_f32 v5, v5, v78, v79
    ds_read_b128 v[24:27], v6 offset:1024
    s_waitcnt lgkmcnt(0)
    v_mfma_f32_32x32x16_bf16 v[48:63], v[24:27], v[16:19], 0
    v_mfma_f32_32x32x16_bf16 v[64:79], v[24:27], v[20:23], 0
    s_nop 10
    v_max3_f32 v4, v4, v48, v49
    v_max3_f32 v4, v4, v50, v51
    v_max3_f32 v4, v4, v52, v53
    v_max3_f32 v4, v4, v54, v55
    v_max3_f32 v4, v4, v56, v57
    v_max3_f32 v4, v4, v58, v59
    v_max3_f32 v4, v4, v60, v61
    v_max3_f32 v4, v4, v62, v63
    v_max3_f32 v5, v5, v64, v65
    v_max3_f32 v5, v5, v66, v67
    v_max3_f32 v5, v5, v68, v69
    v_max3_f32 v5, v5, v70, v71
    v_max3_f32 v5, v5, v72, v73
    v_max3_f32 v5, v5, v74, v75
    v_max3_f32 v5, v5, v76, v77
    v_max3_f32 v5, v5, v78, v79
    ds_read_b128 v[24:27], v6 offset:2048
    s_waitcnt lgkmcnt(0)
    v_mfma_f32_32x32x16_bf16 v[48:63], v[24:27], v[16:19], 0
    v_mfma_f32_32x32x16_bf16 v[64:79], v[24:27], v[20:23], 0
    s_nop 10
    v_max3_f32 v4, v4, v48, v49
    v_max3_f32 v4, v4, v50, v51
    v_max3_f32 v4, v4, v52, v53
    v_max3_f32 v4, v4, v54, v55
    v_max3_f32 v4, v4, v56, v57
    v_max3_f32 v4, v4, v58, v59
    v_max3_f32 v4, v4, v60, v61
    v_max3_f32 v4, v4, v62, v63
    v_max3_f32 v5, v5, v64, v65
    v_max3_f32 v5, v5, v66, v67
    v_max3_f32 v5, v5, v68, v69
    v_max3_f32 v5, v5, v70, v71
    v_max3_f32 v5, v5, v72, v73
    v_max3_f32 v5, v5, v74, v75
    v_max3_f32 v5, v5, v76, v77
    v_max3_f32 v5, v5, v78, v79
    ds_read_b128 v[24:27], v6 offset:3072
    s_waitcnt lgkmcnt(0)
    v_mfma_f32_32x32x16_bf16 v[48:63], v[24:27], v[16:19], 0
    v_mfma_f32_32x32x16_bf16 v[64:79], v[24:27], v[20:23], 0
    s_nop 10
    v_max3_f32 v4, v4, v48, v49
    v_max3_f32 v4, v4, v50, v51
    v_max3_f32 v4, v4, v52, v53
    v_max3_f32 v4, v4, v54, v55
    v_max3_f32 v4, v4, v56, v57
    v_max3_f32 v4, v4, v58, v59
    v_max3_f32 v4, v4, v60, v61
    v_max3_f32 v4, v4, v62, v63
    v_max3_f32 v5, v5, v64, v65
    v_max3_f32 v5, v5, v66, v67
    v_max3_f32 v5, v5, v68, v69
    v_max3_f32 v5, v5, v70, v71
    v_max3_f32 v5, v5, v72, v73
    v_max3_f32 v5, v5, v74, v75
    v_max3_f32 v5, v5, v76, v77
    v_max3_f32 v5, v5, v78, v79
    v_add_u32 v6, 8192, v6
    s_add_u32 s63, s63, 1
    s_cmp_lt_u32 s63, 8
    s_cbranch_scc1 L_mha_maxloop
    v_mov_b32 v6, v13
    v_mov_b32 v7, v14
    ds_read_b128 v[24:27], v6 offset:0
    ds_read_b128 v[32:35], v7 offset:0
    ds_read_b128 v[36:39], v7 offset:512
    ds_read_b128 v[28:31], v6 offset:1024
    v_mov_b32 v10, v4
    v_mov_b32 v11, v5
    s_nop 0
    v_permlane32_swap_b32 v4, v10
    v_permlane32_swap_b32 v5, v11
    v_max_f32 v4, v4, v10
    v_max_f32 v5, v5, v11
    v_sub_f32 v80, 0, v4
    v_sub_f32 v96, 0, v5
    v_sub_f32 v81, 0, v4
    v_sub_f32 v97, 0, v5
    v_sub_f32 v82, 0, v4
    v_sub_f32 v98, 0, v5
    v_sub_f32 v83, 0, v4
    v_sub_f32 v99, 0, v5
    v_sub_f32 v84, 0, v4
    v_sub_f32 v100, 0, v5
    v_sub_f32 v85, 0, v4
    v_sub_f32 v101, 0, v5
    v_sub_f32 v86, 0, v4
    v_sub_f32 v102, 0, v5
    v_sub_f32 v87, 0, v4
    v_sub_f32 v103, 0, v5
    v_sub_f32 v88, 0, v4
    v_sub_f32 v104, 0, v5
    v_sub_f32 v89, 0, v4
    v_sub_f32 v105, 0, v5
    v_sub_f32 v90, 0, v4
    v_sub_f32 v106, 0, v5
    v_sub_f32 v91, 0, v4
    v_sub_f32 v107, 0, v5
    v_sub_f32 v92, 0, v4
    v_sub_f32 v108, 0, v5
    v_sub_f32 v93, 0, v4
    v_sub_f32 v109, 0, v5
    v_sub_f32 v94, 0, v4
    v_sub_f32 v110, 0, v5
    v_sub_f32 v95, 0, v4
    v_sub_f32 v111, 0, v5
    v_mov_b32 v72, 0
    v_mov_b32 v73, 0
    v_mov_b32 v74, 0
    v_mov_b32 v75, 0
    v_mov_b32 v76, 0
    v_mov_b32 v77, 0
    v_mov_b32 v78, 0
    v_mov_b32 v79, 0
    v_mov_b32 v44, 0
    v_mov_b32 v45, 0
    v_mov_b32 v46, 0
    v_mov_b32 v47, 0
    s_waitcnt lgkmcnt(0)
    v_mfma_f32_32x32x16_bf16 v[48:63], v[24:27], v[16:19], v[80:95]
    s_mov_b32 s63, 0
    s_nop 7
    s_nop 3
L_mha_loop:
    v_exp_f32 v48, v48
    v_exp_f32 v49, v49
    v_smfmac_f32_32x32x32_bf16 v[128:143], v[44:47], v[72:79], v12
    ds_read_b128 v[40:43], v7 offset:1024
    ds_read_b128 v[44:47], v7 offset:1536
    v_exp_f32 v50, v50
    v_exp_f32 v51, v51
    v_exp_f32 v52, v52
    v_mfma_f32_32x32x16_bf16 v[64:79], v[24:27], v[20:23], v[96:111]
    ds_read_b128 v[24:27], v6 offset:2048
    v_exp_f32 v53, v53
    v_exp_f32 v54, v54
    v_exp_f32 v55, v55
    v_exp_f32 v56, v56
    v_exp_f32 v57, v57
    s_waitcnt lgkmcnt(3)
    v_smfmac_f32_32x32x32_bf16 v[112:127], v[32:35], v[48:55], v12
    v_exp_f32 v58, v58
    v_exp_f32 v59, v59
    v_exp_f32 v60, v60
    v_exp_f32 v61, v61
    v_exp_f32 v62, v62
    v_exp_f32 v63, v63
    v_exp_f32 v64, v64
    v_exp_f32 v65, v65
    v_smfmac_f32_32x32x32_bf16 v[112:127], v[36:39], v[56:63], v12
    v_exp_f32 v66, v66
    v_exp_f32 v67, v67
    v_exp_f32 v68, v68
    v_mfma_f32_32x32x16_bf16 v[48:63], v[28:31], v[16:19], v[80:95]
    v_exp_f32 v69, v69
    v_exp_f32 v70, v70
    v_exp_f32 v71, v71
    v_exp_f32 v72, v72
    v_exp_f32 v73, v73
    v_smfmac_f32_32x32x32_bf16 v[128:143], v[32:35], v[64:71], v12
    v_exp_f32 v74, v74
    v_exp_f32 v75, v75
    v_exp_f32 v76, v76
    v_exp_f32 v77, v77
    v_exp_f32 v78, v78
    v_exp_f32 v79, v79
    v_exp_f32 v48, v48
    v_exp_f32 v49, v49
    v_smfmac_f32_32x32x32_bf16 v[128:143], v[36:39], v[72:79], v12
    ds_read_b128 v[32:35], v7 offset:2048
    ds_read_b128 v[36:39], v7 offset:2560
    v_exp_f32 v50, v50
    v_exp_f32 v51, v51
    v_exp_f32 v52, v52
    v_mfma_f32_32x32x16_bf16 v[64:79], v[28:31], v[20:23], v[96:111]
    ds_read_b128 v[28:31], v6 offset:3072
    v_exp_f32 v53, v53
    v_exp_f32 v54, v54
    v_exp_f32 v55, v55
    v_exp_f32 v56, v56
    v_exp_f32 v57, v57
    s_waitcnt lgkmcnt(3)
    v_smfmac_f32_32x32x32_bf16 v[112:127], v[40:43], v[48:55], v12
    v_exp_f32 v58, v58
    v_exp_f32 v59, v59
    v_exp_f32 v60, v60
    v_exp_f32 v61, v61
    v_exp_f32 v62, v62
    v_exp_f32 v63, v63
    v_exp_f32 v64, v64
    v_exp_f32 v65, v65
    v_smfmac_f32_32x32x32_bf16 v[112:127], v[44:47], v[56:63], v12
    v_exp_f32 v66, v66
    v_exp_f32 v67, v67
    v_exp_f32 v68, v68
    v_mfma_f32_32x32x16_bf16 v[48:63], v[24:27], v[16:19], v[80:95]
    v_exp_f32 v69, v69
    v_exp_f32 v70, v70
    v_exp_f32 v71, v71
    v_exp_f32 v72, v72
    v_exp_f32 v73, v73
    v_smfmac_f32_32x32x32_bf16 v[128:143], v[40:43], v[64:71], v12
    v_exp_f32 v74, v74
    v_exp_f32 v75, v75
    v_exp_f32 v76, v76
    v_exp_f32 v77, v77
    v_exp_f32 v78, v78
    v_exp_f32 v79, v79
    v_exp_f32 v48, v48
    v_exp_f32 v49, v49
    v_smfmac_f32_32x32x32_bf16 v[128:143], v[44:47], v[72:79], v12
    ds_read_b128 v[40:43], v7 offset:3072
    ds_read_b128 v[44:47], v7 offset:3584
    v_exp_f32 v50, v50
    v_exp_f32 v51, v51
    v_exp_f32 v52, v52
    v_mfma_f32_32x32x16_bf16 v[64:79], v[24:27], v[20:23], v[96:111]
    ds_read_b128 v[24:27], v6 offset:8192
    v_exp_f32 v53, v53
    v_exp_f32 v54, v54
    v_exp_f32 v55, v55
    v_exp_f32 v56, v56
    v_exp_f32 v57, v57
    s_waitcnt lgkmcnt(3)
    v_smfmac_f32_32x32x32_bf16 v[112:127], v[32:35], v[48:55], v12
    v_exp_f32 v58, v58
    v_exp_f32 v59, v59
    v_exp_f32 v60, v60
    v_exp_f32 v61, v61
    v_exp_f32 v62, v62
    v_exp_f32 v63, v63
    v_exp_f32 v64, v64
    v_exp_f32 v65, v65
    v_smfmac_f32_32x32x32_bf16 v[112:127], v[36:39], v[56:63], v12
    v_exp_f32 v66, v66
    v_exp_f32 v67, v67
    v_exp_f32 v68, v68
    v_mfma_f32_32x32x16_bf16 v[48:63], v[28:31], v[16:19], v[80:95]
    v_exp_f32 v69, v69
    v_exp_f32 v70, v70
    v_exp_f32 v71, v71
    v_exp_f32 v72, v72
    v_exp_f32 v73, v73
    v_smfmac_f32_32x32x32_bf16 v[128:143], v[32:35], v[64:71], v12
    v_exp_f32 v74, v74
    v_exp_f32 v75, v75
    v_exp_f32 v76, v76
    v_exp_f32 v77, v77
    v_exp_f32 v78, v78
    v_exp_f32 v79, v79
    v_exp_f32 v48, v48
    v_exp_f32 v49, v49
    v_smfmac_f32_32x32x32_bf16 v[128:143], v[36:39], v[72:79], v12
    ds_read_b128 v[32:35], v7 offset:8192
    ds_read_b128 v[36:39], v7 offset:8704
    v_exp_f32 v50, v50
    v_exp_f32 v51, v51
    v_exp_f32 v52, v52
    v_mfma_f32_32x32x16_bf16 v[64:79], v[28:31], v[20:23], v[96:111]
    ds_read_b128 v[28:31], v6 offset:9216
    v_exp_f32 v53, v53
    v_exp_f32 v54, v54
    v_exp_f32 v55, v55
    v_exp_f32 v56, v56
    v_exp_f32 v57, v57
    s_waitcnt lgkmcnt(3)
    v_smfmac_f32_32x32x32_bf16 v[112:127], v[40:43], v[48:55], v12
    v_exp_f32 v58, v58
    v_exp_f32 v59, v59
    v_exp_f32 v60, v60
    v_exp_f32 v61, v61
    v_exp_f32 v62, v62
    v_exp_f32 v63, v63
    v_exp_f32 v64, v64
    v_exp_f32 v65, v65
    v_smfmac_f32_32x32x32_bf16 v[112:127], v[44:47], v[56:63], v12
    v_exp_f32 v66, v66
    v_exp_f32 v67, v67
    v_exp_f32 v68, v68
    v_mfma_f32_32x32x16_bf16 v[48:63], v[24:27], v[16:19], v[80:95]
    v_exp_f32 v69, v69
    v_exp_f32 v70, v70
    v_exp_f32 v71, v71
    v_exp_f32 v72, v72
    v_exp_f32 v73, v73
    v_smfmac_f32_32x32x32_bf16 v[128:143], v[40:43], v[64:71], v12
    v_add_u32 v6, 8192, v6
    v_add_u32 v7, v15, v7
    s_add_u32 s63, s63, 1
    s_cmp_lt_u32 s63, 8
    v_exp_f32 v74, v74
    v_exp_f32 v75, v75
    v_exp_f32 v76, v76
    v_exp_f32 v77, v77
    v_exp_f32 v78, v78
    v_exp_f32 v79, v79
    s_cbranch_scc1 L_mha_loop
    s_nop 0
    v_smfmac_f32_32x32x32_bf16 v[128:143], v[44:47], v[72:79], v12
    v_mov_b32 v121, v80
    ds_write_b128 v240, v[112:115]
    ds_write_b128 v240, v[116:119] offset:1024
    ds_write_b64 v241, v[120:121] offset:2048
    s_nop 7
    s_nop 3
    s_branch L_mha_out
code_end:
.section .rodata,"a"
.p2align 6
.amdhsa_kernel prep_kernel
  .amdhsa_next_free_vgpr 248
  .amdhsa_next_free_sgpr 96
  .amdhsa_accum_offset 248
  .amdhsa_group_segment_fixed_size 0
  .amdhsa_kernarg_size 72
  .amdhsa_user_sgpr_count 2
  .amdhsa_user_sgpr_kernarg_segment_ptr 1
  .amdhsa_system_sgpr_workgroup_id_x 1
.end_amdhsa_kernel
.section .rodata,"a"
.p2align 6
.amdhsa_kernel mha2_kernel
  .amdhsa_next_free_vgpr 248
  .amdhsa_next_free_sgpr 96
  .amdhsa_accum_offset 248
  .amdhsa_group_segment_fixed_size 0
  .amdhsa_kernarg_size 72
  .amdhsa_user_sgpr_count 2
  .amdhsa_user_sgpr_kernarg_segment_ptr 1
  .amdhsa_system_sgpr_workgroup_id_x 1
.end_amdhsa_kernel
.section .rodata,"a"
.p2align 6
.amdhsa_kernel mha1_kernel
  .amdhsa_next_free_vgpr 248
  .amdhsa_next_free_sgpr 96
  .amdhsa_accum_offset 248
  .amdhsa_group_segment_fixed_size 0
  .amdhsa_kernarg_size 72
  .amdhsa_user_sgpr_count 2
  .amdhsa_user_sgpr_kernarg_segment_ptr 1
  .amdhsa_system_sgpr_workgroup_id_x 1
.end_amdhsa_kernel
.section .rodata,"a"
.p2align 12
.type tables,@object
tables:
.quad 0x3f8000003f80,0x3f8000003f80,0x3f8080003f808000,0x3f8080003f808000,0x3e483f7b00003f80,0x3f0e3f553ec43f6d,0x3f7bbe483f808000,0x3f55bf0e3f6dbec4
.quad 0x3f80248d00003f80,0xbf80a554250dbf80,0x248dbf803f808000,0xa5543f80bf80a50d,0x3f7bbe4800003f80,0xbf553f0ebec4bf6d,0xbe48bf7b3f808000,0x3f0e3f55bf6d3ec4
.quad 0x250dbf8000003f80,0x25d4bf80a58d3f80,0xbf80a50d3f808000,0xbf80a5d43f80258d,0xbe48bf7b00003f80,0xbf0ebf553ec43f6d,0xbf7b3e483f808000,0xbf553f0e3f6dbec4
.quad 0xbf80a55400003f80,0x3f80261f25d4bf80,0xa5543f803f808000,0x261fbf80bf80a5d4,0xbf7b3e4800003f80,0x3f55bf0ebec4bf6d,0x3e483f7b3f808000,0xbf0ebf55bf6d3ec4
.quad 0x3f8000003f80,0x3f8000003f80,0x3f8080003f808000,0x3f8080003f808000,0x3f7bbe483f80248d,0x3f55bf0e3f6dbec4,0xbe48bf7b248dbf80,0xbf0ebf55bec4bf6d
.quad 0x3f80261fa60d3f80,0xbf80a7312630bf80,0x261fbf803f80260d,0xa7313f80bf80a630,0xbe48bf7b3f80261f,0x3f0e3f55bf6d3ec4,0xbf7b3e48261fbf80,0x3f55bf0e3ec43f6d
.quad 0x269fbf80a68d3f80,0x27b1bf80a6b03f80,0xbf80a69f3f80268d,0xbf80a7b13f8026b0,0xbf7b3e483f80a654,0xbf553f0e3f6dbec4,0x3e483f7ba654bf80,0x3f0e3f55bec4bf6d
.quad 0xbf80a777a6d43f80,0x3f80258d27c2bf80,0xa7773f803f8026d4,0x258dbf80bf80a7c2,0x3e483f7b3f80a58e,0xbf0ebf55bf6d3ec4,0x3f7bbe48a58ebf80,0xbf553f0e3ec43f6d
.quad 0x3f8000003f80,0x3f8000003f80,0x3f8080003f808000,0x3f8080003f808000,0xbe48bf7b250dbf80,0xbf0ebf55bec4bf6d,0xbf7b3e48bf80a50d,0xbf553f0ebf6d3ec4
.quad 0x3f80a654a68d3f80,0xbf80a754269fbf80,0xa654bf803f80268d,0xa7543f80bf80a69f,0xbf7b3e48269fbf80,0x3f55bf0e3ec43f6d,0x3e483f7bbf80a69f,0xbf0ebf553f6dbec4
.quad 0xa6d4bf80a70d3f80,0x27d4bf80a71f3f80,0xbf8026d43f80270d,0xbf80a7d43f80271f,0x3e483f7ba6d4bf80,0x3f0e3f55bec4bf6d,0x3f7bbe48bf8026d4,0x3f55bf0ebf6d3ec4
.quad 0xbf80a7b1a7543f80,0x3f80281f27f7bf80,0xa7b13f803f802754,0x281fbf80bf80a7f7,0x3f7bbe48a60ebf80,0xbf553f0e3ec43f6d,0xbe48bf7bbf80260e,0x3f0e3f553f6dbec4
.quad 0x3f8000003f80,0x3f8000003f80,0x3f8080003f808000,0x3f8080003f808000,0xbf7b3e48bf80a554,0xbf553f0ebf6d3ec4,0x3e483f7ba5543f80,0x3f0e3f553ec43f6d
.quad 0x3f80a58ea6d43f80,0xbf80a777a70dbf80,0xa58ebf803f8026d4,0xa7773f80bf80270d,0x3e483f7bbf80a777,0xbf0ebf553f6dbec4,0x3f7bbe48a7773f80,0xbf553f0ebec4bf6d
.quad 0xa60ebf80a7543f80,0x27f7bf80278d3f80,0xbf80260e3f802754,0xbf80a7f73f80a78d,0x3f7bbe48bf802828,0x3f55bf0ebf6d3ec4,0xbe48bf7b28283f80,0xbf0ebf553ec43f6d
.quad 0xbf80a7e5a79f3f80,0x3f8028392816bf80,0xa7e53f803f80279f,0x2839bf80bf80a816,0xbe48bf7bbf80a7e5,0x3f0e3f553f6dbec4,0xbf7b3e48a7e53f80,0x3f55bf0ebec4bf6d
.quad 0x3f8000003f80,0x3f8000003f80,0x3f8080003f808000,0x3f8080003f808000,0x3f553f0e3f353f35,0x3f7b3e483f6d3ec4,0x3f0ebf553f35bf35,0x3e48bf7b3ec4bf6d
.quad 0x3f8025b0a58d3f80,0xbf80a5f725d4bf80,0x25b0bf803f80258d,0xa5f73f80bf80a5d4,0x3f0ebf553f353f35,0xbe483f7bbf6dbec4,0xbf55bf0e3f35bf35,0x3f7b3e48bec43f6d
.quad 0x2630bf80a60d3f80,0x2677bf80a6543f80,0xbf80a6303f80260d,0xbf80a6773f802654,0xbf55bf0e3f353f35,0xbf7bbe483f6d3ec4,0xbf0e3f553f35bf35,0xbe483f7b3ec4bf6d
.quad 0xbf80a742a6543f80,0x3f80a60d269fbf80,0xa7423f803f802654,0xa60dbf80bf80a69f,0xbf0e3f553f353f35,0x3e48bf7bbf6dbec4,0x3f553f0e3f35bf35,0xbf7bbe48bec43f6d
.quad 0x3f8000003f80,0x3f8000003f80,0x3f8080003f808000,0x3f8080003f808000,0x3f0ebf553f35bf35,0x3e48bf7b3ec4bf6d,0xbf55bf0ebf35bf35,0xbf7bbe48bf6dbec4
.quad 0x3f80a68da6543f80,0xbf80a7422677bf80,0xa68dbf803f802654,0xa7423f80bf80a677,0xbf55bf0e3f35bf35,0x3f7b3e48bec43f6d,0xbf0e3f55bf35bf35,0x3e48bf7b3f6d3ec4
.quad 0xa70dbf80a6d43f80,0x27c2bf80a6f73f80,0xbf80270d3f8026d4,0xbf80a7c23f8026f7,0xbf0e3f553f35bf35,0xbe483f7b3ec4bf6d,0x3f553f0ebf35bf35,0x3f7b3e48bf6dbec4
.quad 0xbf80a796a71f3f80,0x3f80268da68dbf80,0xa7963f803f80271f,0x268dbf80bf80268d,0x3f553f0e3f35bf35,0xbf7bbe48bec43f6d,0x3f0ebf55bf35bf35,0xbe483f7b3f6d3ec4
.quad 0x3f8000003f80,0x3f8000003f80,0x3f8080003f808000,0x3f8080003f808000,0xbf55bf0ebf35bf35,0xbf7bbe48bf6dbec4,0xbf0e3f55bf353f35,0xbe483f7bbec43f6d
.quad 0x3f80a60da6b03f80,0xbf80a76527b1bf80,0xa60dbf803f8026b0,0xa7653f80bf80a7b1,0xbf0e3f55bf35bf35,0x3e48bf7b3f6d3ec4,0x3f553f0ebf353f35,0xbf7bbe483ec4bf6d
.quad 0xa68dbf80a7303f80,0x27e5bf80a8313f80,0xbf80268d3f802730,0xbf80a7e53f802831,0x3f553f0ebf35bf35,0x3f7b3e48bf6dbec4,0x3f0ebf55bf353f35,0x3e48bf7bbec43f6d
.quad 0xbf8026d4a8423f80,0x3f802730260dbf80,0x26d43f803f802842,0x2730bf80bf80a60d,0x3f0ebf55bf35bf35,0xbe483f7b3f6d3ec4,0xbf55bf0ebf353f35,0x3f7b3e483ec4bf6d
.quad 0x3f8000003f80,0x3f8000003f80,0x3f8080003f808000,0x3f8080003f808000,0xbf0e3f55bf353f35,0xbe483f7bbec43f6d,0x3f553f0e3f353f35,0x3f7b3e483f6d3ec4
.quad 0x3f80a137a6f73f80,0xbf80a78427c2bf80,0xa137bf803f8026f7,0xa7843f80bf80a7c2,0x3f553f0ebf353f35,0xbf7bbe483ec4bf6d,0x3f0ebf553f353f35,0xbe483f7bbf6dbec4
.quad 0xa1b7bf80a7773f80,0x2804bf80a8423f80,0xbf8021b73f802777,0xbf80a8043f802842,0x3f0ebf55bf353f35,0x3e48bf7bbec43f6d,0xbf55bf0e3f353f35,0xbf7bbe483f6d3ec4
.quad 0xbf80a880270d3f80,0x3f8028a3270dbf80,0xa8803f803f80a70d,0x28a3bf80bf80a70d,0xbf55bf0ebf353f35,0x3f7b3e483ec4bf6d,0xbf0e3f553f353f35,0x3e48bf7bbf6dbec4
.quad 0x3ec43f6d00003f80,0x3f6d3ec43f353f35,0x3f6dbec43f808000,0x3ec4bf6d3f35bf35,0x3f0e3f5500003f80,0x3f7bbe483f6d3ec4,0x3f55bf0e3f808000,0xbe48bf7b3ec4bf6d
.quad 0x3f6dbec400003f80,0xbec43f6dbf35bf35,0xbec4bf6d3f808000,0x3f6d3ec4bf353f35,0x3f55bf0e00003f80,0x3e483f7bbf6dbec4,0xbf0ebf553f808000,0x3f7bbe48bec43f6d
.quad 0xbec4bf6d00003f80,0xbf6dbec43f353f35,0xbf6d3ec43f808000,0xbec43f6d3f35bf35,0xbf0ebf5500003f80,0xbf7b3e483f6d3ec4,0xbf553f0e3f808000,0x3e483f7b3ec4bf6d
.quad 0xbf6d3ec400003f80,0x3ec4bf6dbf35bf35,0x3ec43f6d3f808000,0xbf6dbec4bf353f35,0xbf553f0e00003f80,0xbe48bf7bbf6dbec4,0x3f0e3f553f808000,0xbf7b3e48bec43f6d
.quad 0xbec4bf6d250dbf80,0xbf6dbec4bf35bf35,0xbf6d3ec4bf80a50d,0xbec43f6dbf353f35,0xbf553f0ebf80a554,0x3e483f7bbec43f6d,0x3f0e3f55a5543f80,0x3f7bbe483f6d3ec4
.quad 0xbf6d3ec42630bf80,0x3ec4bf6d3f353f35,0x3ec43f6dbf80a630,0xbf6dbec43f35bf35,0x3f0e3f55bf80a731,0xbf7b3e483ec4bf6d,0x3f55bf0ea7313f80,0x3e483f7bbf6dbec4
.quad 0x3ec43f6d269fbf80,0x3f6d3ec4bf35bf35,0x3f6dbec4bf80a69f,0x3ec4bf6dbf353f35,0x3f55bf0ebf80a754,0xbe48bf7bbec43f6d,0xbf0ebf55a7543f80,0xbf7b3e483f6d3ec4
.quad 0x3f6dbec4a70dbf80,0xbec43f6d3f353f35,0xbec4bf6dbf80270d,0x3f6d3ec43f35bf35,0xbf0ebf55bf80a777,0x3f7bbe483ec4bf6d,0xbf553f0ea7773f80,0xbe48bf7bbf6dbec4
.quad 0x3ec43f6da58d3f80,0x3f6d3ec43f353f35,0x3f6dbec43f80258d,0x3ec4bf6d3f35bf35,0xbf0ebf5525d4bf80,0xbf7b3e48bf6dbec4,0xbf553f0ebf80a5d4,0x3e483f7bbec43f6d
.quad 0x3f6dbec4a6b03f80,0xbec43f6dbf35bf35,0xbec4bf6d3f8026b0,0x3f6d3ec4bf353f35,0xbf553f0e27b1bf80,0xbe48bf7b3f6d3ec4,0x3f0e3f55bf80a7b1,0xbf7b3e483ec4bf6d
.quad 0xbec4bf6da71f3f80,0xbf6dbec43f353f35,0xbf6d3ec43f80271f,0xbec43f6d3f35bf35,0x3f0e3f5527d4bf80,0x3f7bbe48bf6dbec4,0x3f55bf0ebf80a7d4,0xbe48bf7bbec43f6d
.quad 0xbf6d3ec4278d3f80,0x3ec4bf6dbf35bf35,0x3ec43f6d3f80a78d,0xbf6dbec4bf353f35,0x3f55bf0e27f7bf80,0x3e483f7b3f6d3ec4,0xbf0ebf55bf80a7f7,0x3f7bbe483ec4bf6d
.quad 0xbec4bf6d25d4bf80,0xbf6dbec4bf35bf35,0xbf6d3ec4bf80a5d4,0xbec43f6dbf353f35,0x3f55bf0e3f80261f,0xbe48bf7b3ec4bf6d,0xbf0ebf55261fbf80,0xbf7b3e48bf6dbec4
.quad 0xbf6d3ec427c2bf80,0x3ec4bf6d3f353f35,0x3ec43f6dbf80a7c2,0xbf6dbec43f35bf35,0xbf0ebf553f802804,0x3f7bbe48bec43f6d,0xbf553f0e2804bf80,0xbe48bf7b3f6d3ec4
.quad 0x3ec43f6d27f7bf80,0x3f6d3ec4bf35bf35,0x3f6dbec4bf80a7f7,0x3ec4bf6dbf353f35,0xbf553f0e3f80281f,0x3e483f7b3ec4bf6d,0x3f0e3f55281fbf80,0x3f7bbe48bf6dbec4
.quad 0x3f6dbec4a7d4bf80,0xbec43f6d3f353f35,0xbec4bf6dbf8027d4,0x3f6d3ec43f35bf35,0x3f0e3f553f802839,0xbf7b3e48bec43f6d,0x3f55bf0e2839bf80,0x3e483f7b3f6d3ec4
.quad 0x3f6dbec43f80248d,0x3ec4bf6d3f35bf35,0xbec4bf6d248dbf80,0xbf6dbec4bf35bf35,0x3e48bf7b3f35bf35,0xbf55bf0ebec4bf6d,0xbf7bbe48bf35bf35,0xbf0e3f55bf6d3ec4
.quad 0xbec4bf6d3f8025b0,0x3f6d3ec4bf353f35,0xbf6d3ec425b0bf80,0x3ec4bf6d3f353f35,0xbf7bbe483f35bf35,0x3f0ebf553ec43f6d,0xbe483f7bbf35bf35,0xbf55bf0e3f6dbec4
.quad 0xbf6d3ec43f80261f,0xbec43f6d3f35bf35,0x3ec43f6d261fbf80,0x3f6d3ec4bf35bf35,0xbe483f7b3f35bf35,0x3f553f0ebec4bf6d,0x3f7b3e48bf35bf35,0x3f0ebf55bf6d3ec4
.quad 0x3ec43f6d3f80a68d,0xbf6dbec4bf353f35,0x3f6dbec4a68dbf80,0xbec43f6d3f353f35,0x3f7b3e483f35bf35,0xbf0e3f553ec43f6d,0x3e48bf7bbf35bf35,0x3f553f0e3f6dbec4
.quad 0xbf6d3ec4bf80a554,0xbec43f6dbf353f35,0x3ec43f6da5543f80,0x3f6d3ec43f353f35,0x3f7b3e483f353f35,0x3f0ebf553f6dbec4,0x3e48bf7b3f35bf35,0xbf55bf0ebec4bf6d
.quad 0x3ec43f6dbf80a742,0xbf6dbec43f35bf35,0x3f6dbec4a7423f80,0xbec43f6dbf35bf35,0x3e48bf7b3f353f35,0x3f553f0ebf6d3ec4,0xbf7bbe483f35bf35,0x3f0ebf553ec43f6d
.quad 0x3f6dbec4bf80a777,0x3ec4bf6dbf353f35,0xbec4bf6da7773f80,0xbf6dbec43f353f35,0xbf7bbe483f353f35,0xbf0e3f553f6dbec4,0xbe483f7b3f35bf35,0x3f553f0ebec4bf6d
.quad 0xbec4bf6dbf802754,0x3f6d3ec43f35bf35,0xbf6d3ec427543f80,0x3ec4bf6dbf35bf35,0xbe483f7b3f353f35,0xbf55bf0ebf6d3ec4,0x3f7b3e483f35bf35,0xbf0e3f553ec43f6d
.quad 0x3f6dbec43f8025b0,0x3ec4bf6d3f35bf35,0xbec4bf6d25b0bf80,0xbf6dbec4bf35bf35,0xbe483f7bbf353f35,0x3f553f0e3ec43f6d,0x3f7b3e483f353f35,0x3f0ebf553f6dbec4
.quad 0xbec4bf6d3f80a58e,0x3f6d3ec4bf353f35,0xbf6d3ec4a58ebf80,0x3ec4bf6d3f353f35,0x3f7b3e48bf353f35,0xbf0e3f55bec4bf6d,0x3e48bf7b3f353f35,0x3f553f0ebf6d3ec4
.quad 0xbf6d3ec43f80268d,0xbec43f6d3f35bf35,0x3ec43f6d268dbf80,0x3f6d3ec4bf35bf35,0x3e48bf7bbf353f35,0xbf55bf0e3ec43f6d,0xbf7bbe483f353f35,0xbf0e3f553f6dbec4
.quad 0x3ec43f6d3f80a7b1,0xbf6dbec4bf353f35,0x3f6dbec4a7b1bf80,0xbec43f6d3f353f35,0xbf7bbe48bf353f35,0x3f0ebf55bec4bf6d,0xbe483f7b3f353f35,0xbf55bf0ebf6d3ec4
.quad 0xbf6d3ec4bf80a5f7,0xbec43f6dbf353f35,0x3ec43f6da5f73f80,0x3f6d3ec43f353f35,0xbf7bbe48bf35bf35,0xbf0e3f55bf6d3ec4,0xbe483f7bbf353f35,0x3f553f0e3ec43f6d
.quad 0x3ec43f6dbf80a78d,0xbf6dbec43f35bf35,0x3f6dbec4a78d3f80,0xbec43f6dbf35bf35,0xbe483f7bbf35bf35,0xbf55bf0e3f6dbec4,0x3f7b3e48bf353f35,0xbf0e3f55bec4bf6d
.quad 0x3f6dbec4bf8026d4,0x3ec4bf6dbf353f35,0xbec4bf6d26d43f80,0xbf6dbec43f353f35,0x3f7b3e48bf35bf35,0x3f0ebf55bf6d3ec4,0x3e48bf7bbf353f35,0xbf55bf0e3ec43f6d
.quad 0xbec4bf6dbf8028be,0x3f6d3ec43f35bf35,0xbf6d3ec428be3f80,0x3ec4bf6dbf35bf35,0x3e48bf7bbf35bf35,0x3f553f0e3f6dbec4,0xbf7bbe48bf353f35,0x3f0ebf55bec4bf6d
.quad 0x3f353f3500003f80,0x3f35bf353f80248d,0x3f35bf353f808000,0xbf35bf35248dbf80,0x3f553f0e00003f80,0x3e48bf7b3f6dbec4,0x3f0ebf553f808000,0xbf7bbe48bec4bf6d
.quad 0x3f35bf3500003f80,0x3f353f35bf80a554,0xbf35bf353f808000,0x3f35bf35a5543f80,0x3f0ebf5500003f80,0x3f7b3e48bf6d3ec4,0xbf55bf0e3f808000,0x3e48bf7b3ec43f6d
.quad 0xbf35bf3500003f80,0xbf353f353f8025b0,0xbf353f353f808000,0x3f353f3525b0bf80,0xbf55bf0e00003f80,0xbe483f7b3f6dbec4,0xbf0e3f553f808000,0x3f7b3e48bec4bf6d
.quad 0xbf353f3500003f80,0xbf35bf35bf80a5f7,0x3f353f353f808000,0xbf353f35a5f73f80,0xbf0e3f5500003f80,0xbf7bbe48bf6d3ec4,0x3f553f0e3f808000,0xbe483f7b3ec43f6d
.quad 0x3f353f35a58d3f80,0x3f35bf353f8025b0,0x3f35bf353f80258d,0xbf35bf3525b0bf80,0x3f0ebf553f8025b0,0xbf7bbe48bec4bf6d,0xbf55bf0e25b0bf80,0xbe483f7bbf6d3ec4
.quad 0x3f35bf35a6543f80,0x3f353f35bf80a742,0xbf35bf353f802654,0x3f35bf35a7423f80,0xbf55bf0e3f80a68d,0x3e48bf7b3ec43f6d,0xbf0e3f55a68dbf80,0xbf7bbe483f6dbec4
.quad 0xbf35bf35a6b03f80,0xbf353f353f80a58e,0xbf353f353f8026b0,0x3f353f35a58ebf80,0xbf0e3f553f80a60d,0x3f7b3e48bec4bf6d,0x3f553f0ea60dbf80,0x3e48bf7bbf6d3ec4
.quad 0xbf353f35a6f73f80,0xbf35bf35bf80a78d,0x3f353f353f8026f7,0xbf353f35a78d3f80,0x3f553f0e3f80a137,0xbe483f7b3ec43f6d,0x3f0ebf55a137bf80,0x3f7b3e483f6dbec4
.quad 0x3f353f35a60d3f80,0x3f35bf353f80261f,0x3f35bf353f80260d,0xbf35bf35261fbf80,0xbf55bf0e2630bf80,0xbe483f7bbf6d3ec4,0xbf0e3f55bf80a630,0x3f7b3e483ec43f6d
.quad 0x3f35bf35a6d43f80,0x3f353f35bf80a777,0xbf35bf353f8026d4,0x3f35bf35a7773f80,0xbf0e3f55a70dbf80,0xbf7bbe483f6dbec4,0x3f553f0ebf80270d,0xbe483f7bbec4bf6d
.quad 0xbf35bf35a7303f80,0xbf353f353f80268d,0xbf353f353f802730,0x3f353f35268dbf80,0x3f553f0ea68dbf80,0x3e48bf7bbf6d3ec4,0x3f0ebf55bf80268d,0xbf7bbe483ec43f6d
.quad 0xbf353f35a7773f80,0xbf35bf35bf8026d4,0x3f353f353f802777,0xbf353f3526d43f80,0x3f0ebf55a1b7bf80,0x3f7b3e483f6dbec4,0xbf55bf0ebf8021b7,0x3e48bf7bbec4bf6d
.quad 0x3f353f35a6543f80,0x3f35bf353f80a68d,0x3f35bf353f802654,0xbf35bf35a68dbf80,0xbf0e3f55bf80a742,0x3f7b3e483ec43f6d,0x3f553f0ea7423f80,0x3e48bf7b3f6dbec4
.quad 0x3f35bf35a71f3f80,0x3f353f35bf80a796,0xbf35bf353f80271f,0x3f35bf35a7963f80,0x3f553f0ebf802754,0xbe483f7bbec4bf6d,0x3f0ebf5527543f80,0x3f7b3e48bf6d3ec4
.quad 0xbf35bf35a8423f80,0xbf353f353f802828,0xbf353f353f802842,0x3f353f352828bf80,0x3f0ebf55bf8026d4,0xbf7bbe483ec43f6d,0xbf55bf0e26d43f80,0xbe483f7b3f6dbec4
.quad 0xbf353f35270d3f80,0xbf35bf35bf80a804,0x3f353f353f80a70d,0xbf353f35a8043f80,0xbf55bf0ebf80a880,0x3e48bf7bbec4bf6d,0xbf0e3f55a8803f80,0xbf7bbe48bf6d3ec4
.quad 0xbf35bf35250dbf80,0xbf353f35bf80a554,0xbf353f35bf80a50d,0x3f353f35a5543f80,0xbf7b3e48bf35bf35,0x3f0e3f55bec43f6d,0x3e483f7bbf353f35,0x3f55bf0e3f6d3ec4
.quad 0xbf353f3525d4bf80,0xbf35bf353f80261f,0x3f353f35bf80a5d4,0xbf353f35261fbf80,0x3e483f7bbf35bf35,0xbf553f0e3ec4bf6d,0x3f7bbe48bf353f35,0x3f0e3f55bf6dbec4
.quad 0x3f353f352630bf80,0x3f35bf35bf80a742,0x3f35bf35bf80a630,0xbf35bf35a7423f80,0x3f7bbe48bf35bf35,0xbf0ebf55bec43f6d,0xbe48bf7bbf353f35,0xbf553f0e3f6d3ec4
.quad 0x3f35bf352677bf80,0x3f353f353f80a60d,0xbf35bf35bf80a677,0x3f35bf35a60dbf80,0xbe48bf7bbf35bf35,0x3f55bf0e3ec4bf6d,0xbf7b3e48bf353f35,0xbf0ebf55bf6dbec4
.quad 0xbf35bf3525d4bf80,0xbf353f35bf80a5f7,0xbf353f35bf80a5d4,0x3f353f35a5f73f80,0x3e483f7bbf353f35,0x3f55bf0e3f6d3ec4,0x3f7bbe483f353f35,0xbf0ebf553ec4bf6d
.quad 0xbf353f35269fbf80,0xbf35bf353f80a60d,0x3f353f35bf80a69f,0xbf353f35a60dbf80,0x3f7bbe48bf353f35,0x3f0e3f55bf6dbec4,0xbe48bf7b3f353f35,0x3f55bf0ebec43f6d
.quad 0x3f353f3527c2bf80,0x3f35bf35bf80a78d,0x3f35bf35bf80a7c2,0xbf35bf35a78d3f80,0xbe48bf7bbf353f35,0xbf553f0e3f6d3ec4,0xbf7b3e483f353f35,0x3f0e3f553ec4bf6d
.quad 0x3f35bf35a68dbf80,0x3f353f353f802816,0xbf35bf35bf80268d,0x3f35bf352816bf80,0xbf7b3e48bf353f35,0xbf0ebf55bf6dbec4,0x3e483f7b3f353f35,0xbf553f0ebec43f6d
.quad 0xbf35bf352630bf80,0xbf353f35bf80a731,0xbf353f35bf80a630,0x3f353f35a7313f80,0x3f7bbe483f353f35,0xbf0ebf553ec4bf6d,0xbe48bf7b3f35bf35,0xbf553f0ebf6dbec4
.quad 0xbf353f3527c2bf80,0xbf35bf353f80258d,0x3f353f35bf80a7c2,0xbf353f35258dbf80,0xbe48bf7b3f353f35,0x3f55bf0ebec43f6d,0xbf7b3e483f35bf35,0xbf0ebf553f6d3ec4
.quad 0x3f353f35a60ebf80,0x3f35bf35bf80270d,0x3f35bf35bf80260e,0xbf35bf35270d3f80,0xbf7b3e483f353f35,0x3f0e3f553ec4bf6d,0x3e483f7b3f35bf35,0x3f55bf0ebf6dbec4
.quad 0x3f35bf35280dbf80,0x3f353f353f802754,0xbf35bf35bf80a80d,0x3f35bf352754bf80,0x3e483f7b3f353f35,0xbf553f0ebec43f6d,0x3f7bbe483f35bf35,0x3f0e3f553f6d3ec4
.quad 0xbf35bf352677bf80,0xbf353f35bf80a742,0xbf353f35bf80a677,0x3f353f35a7423f80,0xbe48bf7b3f35bf35,0xbf553f0ebf6dbec4,0xbf7b3e48bf35bf35,0x3f0e3f55bec43f6d
.quad 0xbf353f35a68dbf80,0xbf35bf353f80268d,0x3f353f35bf80268d,0xbf353f35268dbf80,0xbf7b3e483f35bf35,0xbf0ebf553f6d3ec4,0x3e483f7bbf35bf35,0xbf553f0e3ec4bf6d
.quad 0x3f353f35280dbf80,0x3f35bf35bf80a7e5,0x3f35bf35bf80a80d,0xbf35bf35a7e53f80,0x3e483f7b3f35bf35,0x3f55bf0ebf6dbec4,0x3f7bbe48bf35bf35,0xbf0ebf55bec43f6d
.quad 0x3f35bf352896bf80,0x3f353f353f80a731,0xbf35bf35bf80a896,0x3f35bf35a731bf80,0x3f7bbe483f35bf35,0x3f0e3f553f6d3ec4,0xbe48bf7bbf35bf35,0x3f55bf0e3ec4bf6d
.quad 0x3f6d3ec400003f80,0xbec4bf6d3f35bf35,0x3ec4bf6d3f808000,0xbf6d3ec4bf35bf35,0x3f7b3e4800003f80,0xbf55bf0e3ec4bf6d,0x3e48bf7b3f808000,0xbf0e3f55bf6dbec4
.quad 0x3ec4bf6d00003f80,0x3f6dbec4bf353f35,0xbf6dbec43f808000,0xbec4bf6d3f353f35,0x3e48bf7b00003f80,0x3f0ebf55bec43f6d,0xbf7bbe483f808000,0xbf55bf0e3f6d3ec4
.quad 0xbf6dbec400003f80,0x3ec43f6d3f35bf35,0xbec43f6d3f808000,0x3f6dbec4bf35bf35,0xbf7bbe4800003f80,0x3f553f0e3ec4bf6d,0xbe483f7b3f808000,0x3f0ebf55bf6dbec4
.quad 0xbec43f6d00003f80,0xbf6d3ec4bf353f35,0x3f6d3ec43f808000,0x3ec43f6d3f353f35,0xbe483f7b00003f80,0xbf0e3f55bec43f6d,0x3f7b3e483f808000,0x3f553f0e3f6d3ec4
.quad 0xbf6dbec425d4bf80,0x3ec43f6dbf353f35,0xbec43f6dbf80a5d4,0x3f6dbec43f353f35,0xbe483f7bbf80a5f7,0x3f0ebf553f6d3ec4,0x3f7b3e48a5f73f80,0xbf55bf0e3ec4bf6d
.quad 0xbec43f6d2677bf80,0xbf6d3ec43f35bf35,0x3f6d3ec4bf80a677,0x3ec43f6dbf35bf35,0x3f7b3e48bf80a742,0x3f553f0ebf6dbec4,0x3e48bf7ba7423f80,0x3f0ebf55bec43f6d
.quad 0x3f6d3ec427b1bf80,0xbec4bf6dbf353f35,0x3ec4bf6dbf80a7b1,0xbf6d3ec43f353f35,0x3e48bf7bbf80a765,0xbf0e3f553f6d3ec4,0xbf7bbe48a7653f80,0x3f553f0e3ec4bf6d
.quad 0x3ec4bf6d27c2bf80,0x3f6dbec43f35bf35,0xbf6dbec4bf80a7c2,0xbec4bf6dbf35bf35,0xbf7bbe48bf80a784,0xbf55bf0ebf6dbec4,0xbe483f7ba7843f80,0xbf0e3f55bec43f6d
.quad 0x3f6d3ec4a6543f80,0xbec4bf6d3f35bf35,0x3ec4bf6d3f802654,0xbf6d3ec4bf35bf35,0xbf7bbe482677bf80,0x3f553f0ebec43f6d,0xbe483f7bbf80a677,0x3f0ebf553f6d3ec4
.quad 0x3ec4bf6da6f73f80,0x3f6dbec4bf353f35,0xbf6dbec43f8026f7,0xbec4bf6d3f353f35,0xbe483f7b27c2bf80,0xbf0e3f553ec4bf6d,0x3f7b3e48bf80a7c2,0x3f553f0ebf6dbec4
.quad 0xbf6dbec4a8313f80,0x3ec43f6d3f35bf35,0xbec43f6d3f802831,0x3f6dbec4bf35bf35,0x3f7b3e4827e5bf80,0xbf55bf0ebec43f6d,0x3e48bf7bbf80a7e5,0xbf0e3f553f6d3ec4
.quad 0xbec43f6da8423f80,0xbf6d3ec4bf353f35,0x3f6d3ec43f802842,0x3ec43f6d3f353f35,0x3e48bf7b2804bf80,0x3f0ebf553ec4bf6d,0xbf7bbe48bf80a804,0xbf55bf0ebf6dbec4
.quad 0xbf6dbec4269fbf80,0x3ec43f6dbf353f35,0xbec43f6dbf80a69f,0x3f6dbec43f353f35,0x3e48bf7b3f80a60d,0xbf0e3f55bf6dbec4,0xbf7bbe48a60dbf80,0x3f553f0ebec43f6d
.quad 0xbec43f6da68dbf80,0xbf6d3ec43f35bf35,0x3f6d3ec4bf80268d,0x3ec43f6dbf35bf35,0xbf7bbe483f802889,0xbf55bf0e3f6d3ec4,0xbe483f7b2889bf80,0xbf0e3f553ec4bf6d
.quad 0x3f6d3ec42884bf80,0xbec4bf6dbf353f35,0x3ec4bf6dbf80a884,0xbf6d3ec43f353f35,0xbe483f7b3f802730,0x3f0ebf55bf6dbec4,0x3f7b3e482730bf80,0xbf55bf0ebec43f6d
.quad 0x3ec4bf6d2909bf80,0x3f6dbec43f35bf35,0xbf6dbec4bf80a909,0xbec4bf6dbf35bf35,0x3f7b3e483f8028a3,0x3f553f0e3f6d3ec4,0x3e48bf7b28a3bf80,0x3f0ebf553ec4bf6d
.quad 0xbec43f6dbf80a554,0x3f6dbec43f353f35,0x3f6d3ec4a5543f80,0xbec4bf6d3f35bf35,0x3f0e3f55bf353f35,0xbe48bf7b3f6dbec4,0x3f55bf0e3f353f35,0xbf7b3e48bec4bf6d
.quad 0x3f6d3ec4bf80a5f7,0x3ec43f6dbf35bf35,0x3ec4bf6da5f73f80,0x3f6dbec4bf353f35,0x3f55bf0ebf353f35,0x3f7bbe48bf6d3ec4,0xbf0ebf553f353f35,0xbe48bf7b3ec43f6d
.quad 0x3ec4bf6dbf80a731,0xbf6d3ec43f353f35,0xbf6dbec4a7313f80,0x3ec43f6d3f35bf35,0xbf0ebf55bf353f35,0x3e483f7b3f6dbec4,0xbf553f0e3f353f35,0x3f7bbe48bec4bf6d
.quad 0xbf6dbec4bf80a742,0xbec4bf6dbf35bf35,0xbec43f6da7423f80,0xbf6d3ec4bf353f35,0xbf553f0ebf353f35,0xbf7b3e48bf6d3ec4,0x3f0e3f553f353f35,0x3e483f7b3ec43f6d
.quad 0x3ec4bf6d3f80261f,0xbf6d3ec4bf35bf35,0xbf6dbec4261fbf80,0x3ec43f6dbf353f35,0xbf553f0ebf35bf35,0x3f7bbe483ec43f6d,0x3f0e3f55bf353f35,0xbe48bf7b3f6dbec4
.quad 0xbf6dbec43f80a60d,0xbec4bf6d3f353f35,0xbec43f6da60dbf80,0xbf6d3ec43f35bf35,0x3f0e3f55bf35bf35,0x3e483f7bbec4bf6d,0x3f55bf0ebf353f35,0x3f7bbe48bf6d3ec4
.quad 0xbec43f6d3f802804,0x3f6dbec4bf35bf35,0x3f6d3ec42804bf80,0xbec4bf6dbf353f35,0x3f55bf0ebf35bf35,0xbf7b3e483ec43f6d,0xbf0ebf55bf353f35,0x3e483f7b3f6dbec4
.quad 0x3f6d3ec43f802889,0x3ec43f6d3f353f35,0x3ec4bf6d2889bf80,0x3f6dbec43f35bf35,0xbf0ebf55bf35bf35,0xbe48bf7bbec4bf6d,0xbf553f0ebf353f35,0xbf7b3e48bf6d3ec4
.quad 0xbec43f6dbf80a742,0x3f6dbec43f353f35,0x3f6d3ec4a7423f80,0xbec4bf6d3f35bf35,0xbf0ebf553f35bf35,0x3e483f7bbf6d3ec4,0xbf553f0ebf35bf35,0x3f7bbe483ec43f6d
.quad 0x3f6d3ec4bf80a78d,0x3ec43f6dbf35bf35,0x3ec4bf6da78d3f80,0x3f6dbec4bf353f35,0xbf553f0e3f35bf35,0xbf7b3e483f6dbec4,0x3f0e3f55bf35bf35,0x3e483f7bbec4bf6d
.quad 0x3ec4bf6dbf80a85d,0xbf6d3ec43f353f35,0xbf6dbec4a85d3f80,0x3ec43f6d3f35bf35,0x3f0e3f553f35bf35,0xbe48bf7bbf6d3ec4,0x3f55bf0ebf35bf35,0xbf7b3e483ec43f6d
.quad 0xbf6dbec4bf80a7e5,0xbec4bf6dbf35bf35,0xbec43f6da7e53f80,0xbf6d3ec4bf353f35,0x3f55bf0e3f35bf35,0x3f7bbe483f6dbec4,0xbf0ebf55bf35bf35,0xbe48bf7bbec4bf6d
.quad 0x3ec4bf6d3f80a60d,0xbf6d3ec4bf35bf35,0xbf6dbec4a60dbf80,0x3ec43f6dbf353f35,0x3f55bf0e3f353f35,0xbf7b3e48bec4bf6d,0xbf0ebf553f35bf35,0x3e483f7bbf6d3ec4
.quad 0xbf6dbec43f802816,0xbec4bf6d3f353f35,0xbec43f6d2816bf80,0xbf6d3ec43f35bf35,0xbf0ebf553f353f35,0xbe48bf7b3ec43f6d,0xbf553f0e3f35bf35,0xbf7b3e483f6dbec4
.quad 0xbec43f6d3f80289a,0x3f6dbec4bf35bf35,0x3f6d3ec4289abf80,0xbec4bf6dbf353f35,0xbf553f0e3f353f35,0x3f7bbe48bec4bf6d,0x3f0e3f553f35bf35,0xbe48bf7bbf6d3ec4
.quad 0x3f6d3ec43f8028ea,0x3ec43f6d3f353f35,0x3ec4bf6d28eabf80,0x3f6dbec43f35bf35,0x3f0e3f553f353f35,0x3e483f7b3ec43f6d,0x3f55bf0e3f35bf35,0x3f7bbe483f6dbec4
.quad 0x3f8000003f80,0x3f8000003f80,0x3f8080003f808000,0x3f8080003f808000,0x3dc93f7f00003f80,0x3e953f753e483f7b,0x3f7fbdc93f808000,0x3f75be953f7bbe48
.quad 0x3e483f7b00003f80,0x3f0e3f553ec43f6d,0x3f7bbe483f808000,0x3f55bf0e3f6dbec4,0x3e953f7500003f80,0x3f463f223f0e3f55,0x3f75be953f808000,0x3f22bf463f55bf0e
.quad 0x3ec43f6d00003f80,0x3f6d3ec43f353f35,0x3f6dbec43f808000,0x3ec4bf6d3f35bf35,0x3ef13f6200003f80,0x3f7f3dc93f553f0e,0x3f62bef13f808000,0x3dc9bf7f3f0ebf55
.quad 0x3f0e3f5500003f80,0x3f7bbe483f6d3ec4,0x3f55bf0e3f808000,0xbe48bf7b3ec4bf6d,0x3f223f4600003f80,0x3f62bef13f7b3e48,0x3f46bf223f808000,0xbef1bf623e48bf7b
.quad 0x3f353f3500003f80,0x3f35bf353f80248d,0x3f35bf353f808000,0xbf35bf35248dbf80,0x3f463f2200003f80,0x3ef1bf623f7bbe48,0x3f22bf463f808000,0xbf62bef1be48bf7b
.quad 0x3f553f0e00003f80,0x3e48bf7b3f6dbec4,0x3f0ebf553f808000,0xbf7bbe48bec4bf6d,0x3f623ef100003f80,0xbdc9bf7f3f55bf0e,0x3ef1bf623f808000,0xbf7f3dc9bf0ebf55
.quad 0x3f6d3ec400003f80,0xbec4bf6d3f35bf35,0x3ec4bf6d3f808000,0xbf6d3ec4bf35bf35,0x3f753e9500003f80,0xbf22bf463f0ebf55,0x3e95bf753f808000,0xbf463f22bf55bf0e
.quad 0x3f7b3e4800003f80,0xbf55bf0e3ec4bf6d,0x3e48bf7b3f808000,0xbf0e3f55bf6dbec4,0x3f7f3dc900003f80,0xbf75be953e48bf7b,0x3dc9bf7f3f808000,0xbe953f75bf7bbe48
.quad 0x3f8000003f80,0x3f8000003f80,0x3f8080003f808000,0x3f8080003f808000,0x3ef13f623ec43f6d,0x3f223f463f0e3f55,0x3f62bef13f6dbec4,0x3f46bf223f55bf0e
.quad 0x3f553f0e3f353f35,0x3f7b3e483f6d3ec4,0x3f0ebf553f35bf35,0x3e48bf7b3ec4bf6d,0x3f7f3dc93f6d3ec4,0x3f62bef13f7bbe48,0x3dc9bf7f3ec4bf6d,0xbef1bf62be48bf7b
.quad 0x3f6dbec43f80248d,0x3ec4bf6d3f35bf35,0xbec4bf6d248dbf80,0xbf6dbec4bf35bf35,0x3f22bf463f6dbec4,0xbe95bf753e48bf7b,0xbf46bf22bec4bf6d,0xbf753e95bf7bbe48
.quad 0x3e48bf7b3f35bf35,0xbf55bf0ebec4bf6d,0xbf7bbe48bf35bf35,0xbf0e3f55bf6d3ec4,0xbe95bf753ec4bf6d,0xbf7f3dc9bf55bf0e,0xbf753e95bf6dbec4,0x3dc93f7fbf0e3f55
.quad 0xbf35bf35250dbf80,0xbf353f35bf80a554,0xbf353f35bf80a50d,0x3f353f35a5543f80,0xbf75be95bec4bf6d,0xbdc93f7fbf553f0e,0xbe953f75bf6d3ec4,0x3f7f3dc93f0e3f55
.quad 0xbf7b3e48bf35bf35,0x3f0e3f55bec43f6d,0x3e483f7bbf353f35,0x3f55bf0e3f6d3ec4,0xbf463f22bf6dbec4,0x3f753e953e483f7b,0x3f223f46bec43f6d,0x3e95bf753f7bbe48
.quad 0xbec43f6dbf80a554,0x3f6dbec43f353f35,0x3f6d3ec4a5543f80,0xbec4bf6d3f35bf35,0x3dc93f7fbf6d3ec4,0x3ef1bf623f7b3e48,0x3f7fbdc93ec43f6d,0xbf62bef13e48bf7b
.quad 0x3f0e3f55bf353f35,0xbe48bf7b3f6dbec4,0x3f55bf0e3f353f35,0xbf7b3e48bec4bf6d,0x3f623ef1bec43f6d,0xbf46bf223f0ebf55,0x3ef1bf623f6d3ec4,0xbf223f46bf55bf0e
.quad 0x3f8000003f80,0x3f8000003f80,0x3f8080003f808000,0x3f8080003f808000,0x3f463f223f353f35,0x3f623ef13f553f0e,0x3f22bf463f35bf35,0x3ef1bf623f0ebf55
.quad 0x3f7bbe483f80248d,0x3f55bf0e3f6dbec4,0xbe48bf7b248dbf80,0xbf0ebf55bec4bf6d,0x3ef1bf623f35bf35,0xbdc9bf7f3e48bf7b,0xbf62bef1bf35bf35,0xbf7f3dc9bf7bbe48
.quad 0xbec4bf6d250dbf80,0xbf6dbec4bf35bf35,0xbf6d3ec4bf80a50d,0xbec43f6dbf353f35,0xbf75be95bf35bf35,0xbf463f22bf7b3e48,0xbe953f75bf353f35,0x3f223f463e483f7b
.quad 0xbf553f0ebf80a554,0x3e483f7bbec43f6d,0x3f0e3f55a5543f80,0x3f7bbe483f6d3ec4,0xbdc93f7fbf353f35,0x3f753e953f0e3f55,0x3f7f3dc93f353f35,0x3e95bf753f55bf0e
.quad 0x3f353f35a58d3f80,0x3f35bf353f8025b0,0x3f35bf353f80258d,0xbf35bf3525b0bf80,0x3f7fbdc93f353f35,0xbe95bf753f0ebf55,0xbdc9bf7f3f35bf35,0xbf753e95bf55bf0e
.quad 0x3f0ebf553f8025b0,0xbf7bbe48bec4bf6d,0xbf55bf0e25b0bf80,0xbe483f7bbf6d3ec4,0xbe95bf753f35bf35,0xbf223f46bf7bbe48,0xbf753e95bf35bf35,0x3f463f22be483f7b
.quad 0xbf6dbec425d4bf80,0x3ec43f6dbf353f35,0xbec43f6dbf80a5d4,0x3f6dbec43f353f35,0xbf623ef1bf35bf35,0x3f7f3dc93e483f7b,0x3ef13f62bf353f35,0x3dc9bf7f3f7bbe48
.quad 0xbe483f7bbf80a5f7,0x3f0ebf553f6d3ec4,0x3f7b3e48a5f73f80,0xbf55bf0e3ec4bf6d,0x3f223f46bf353f35,0xbef1bf623f55bf0e,0x3f46bf223f353f35,0xbf623ef1bf0ebf55
.quad 0x3f8000003f80,0x3f8000003f80,0x3f8080003f808000,0x3f8080003f808000,0x3f753e953f6d3ec4,0x3f7f3dc93f7b3e48,0x3e95bf753ec4bf6d,0x3dc9bf7f3e48bf7b
.quad 0x3f0ebf553f35bf35,0x3e48bf7b3ec4bf6d,0xbf55bf0ebf35bf35,0xbf7bbe48bf6dbec4,0xbf22bf46bec4bf6d,0xbf75be95bf55bf0e,0xbf463f22bf6d3ec4,0xbe953f75bf0e3f55
.quad 0xbf6d3ec4bf80a554,0xbec43f6dbf353f35,0x3ec43f6da5543f80,0x3f6d3ec43f353f35,0x3dc93f7fbec43f6d,0x3f623ef13f0e3f55,0x3f7fbdc93f6d3ec4,0x3ef1bf623f55bf0e
.quad 0x3f7b3e483f353f35,0x3f0ebf553f6dbec4,0x3e48bf7b3f35bf35,0xbf55bf0ebec4bf6d,0x3ef1bf623f6dbec4,0xbf46bf22be48bf7b,0xbf62bef1bec4bf6d,0xbf223f46bf7b3e48
.quad 0xbf35bf3525d4bf80,0xbf353f35bf80a5f7,0xbf353f35bf80a5d4,0x3f353f35a5f73f80,0xbf623ef1bf6dbec4,0x3f223f46be483f7b,0x3ef13f62bec43f6d,0x3f46bf223f7b3e48
.quad 0x3e483f7bbf353f35,0x3f55bf0e3f6d3ec4,0x3f7bbe483f353f35,0xbf0ebf553ec4bf6d,0x3f7f3dc93ec43f6d,0xbef1bf623f0ebf55,0x3dc9bf7f3f6dbec4,0xbf623ef1bf55bf0e
.quad 0x3ec4bf6d3f80261f,0xbf6d3ec4bf35bf35,0xbf6dbec4261fbf80,0x3ec43f6dbf353f35,0xbf46bf223ec4bf6d,0x3e953f75bf553f0e,0xbf223f46bf6dbec4,0x3f75be953f0e3f55
.quad 0xbf553f0ebf35bf35,0x3f7bbe483ec43f6d,0x3f0e3f55bf353f35,0xbe48bf7b3f6dbec4,0x3e953f75bf6d3ec4,0xbdc9bf7f3f7bbe48,0x3f75be953ec43f6d,0xbf7f3dc9be48bf7b
.quad 0x3f8000003f80,0x3f8000003f80,0x3f8080003f808000,0x3f8080003f808000,0x3f7fbdc93f80248d,0x3f75be953f7bbe48,0xbdc9bf7f248dbf80,0xbe95bf75be48bf7b
.quad 0xbe48bf7b250dbf80,0xbf0ebf55bec4bf6d,0xbf7b3e48bf80a50d,0xbf553f0ebf6d3ec4,0xbf753e95bf80a554,0xbf223f46bf553f0e,0x3e953f75a5543f80,0x3f463f223f0e3f55
.quad 0x3ec43f6da58d3f80,0x3f6d3ec43f353f35,0x3f6dbec43f80258d,0x3ec4bf6d3f35bf35,0x3f62bef13f8025b0,0x3dc9bf7f3f0ebf55,0xbef1bf6225b0bf80,0xbf7fbdc9bf55bf0e
.quad 0xbf0ebf5525d4bf80,0xbf7b3e48bf6dbec4,0xbf553f0ebf80a5d4,0x3e483f7bbec43f6d,0xbf463f22bf80a5f7,0x3ef13f62be483f7b,0x3f223f46a5f73f80,0x3f62bef13f7b3e48
.quad 0x3f353f35a60d3f80,0x3f35bf353f80261f,0x3f35bf353f80260d,0xbf35bf35261fbf80,0x3f22bf463f80261f,0xbf62bef1be48bf7b,0xbf46bf22261fbf80,0xbef13f62bf7b3e48
.quad 0xbf55bf0e2630bf80,0xbe483f7bbf6d3ec4,0xbf0e3f55bf80a630,0x3f7b3e483ec43f6d,0xbef13f62bf80a731,0x3f7fbdc93f0e3f55,0x3f623ef1a7313f80,0xbdc9bf7f3f55bf0e
.quad 0x3f6d3ec4a6543f80,0xbec4bf6d3f35bf35,0x3ec4bf6d3f802654,0xbf6d3ec4bf35bf35,0x3e95bf753f80a68d,0xbf463f22bf55bf0e,0xbf75be95a68dbf80,0x3f223f46bf0e3f55
.quad 0xbf7bbe482677bf80,0x3f553f0ebec43f6d,0xbe483f7bbf80a677,0x3f0ebf553f6d3ec4,0xbdc93f7fbf80a742,0x3e95bf753f7b3e48,0x3f7f3dc9a7423f80,0xbf75be953e48bf7b
.quad 0x3f8000003f80,0x3f8000003f80,0x3f8080003f808000,0x3f8080003f808000,0x3f62bef13f6dbec4,0x3f46bf223f55bf0e,0xbef1bf62bec4bf6d,0xbf22bf46bf0ebf55
.quad 0xbf55bf0ebf35bf35,0xbf7bbe48bf6dbec4,0xbf0e3f55bf353f35,0xbe483f7bbec43f6d,0xbdc93f7fbec43f6d,0x3ef13f623e483f7b,0x3f7f3dc93f6d3ec4,0x3f62bef13f7bbe48
.quad 0x3f6dbec43f8025b0,0x3ec4bf6d3f35bf35,0xbec4bf6d25b0bf80,0xbf6dbec4bf35bf35,0xbf46bf22bec4bf6d,0xbf753e95bf7bbe48,0xbf223f46bf6d3ec4,0x3e953f75be483f7b
.quad 0xbe483f7bbf353f35,0x3f553f0e3ec43f6d,0x3f7b3e483f353f35,0x3f0ebf553f6dbec4,0x3f75be953f6d3ec4,0xbdc9bf7f3f0ebf55,0xbe95bf753ec4bf6d,0xbf7f3dc9bf55bf0e
.quad 0xbf35bf352630bf80,0xbf353f35bf80a731,0xbf353f35bf80a630,0x3f353f35a7313f80,0xbe953f75bf6d3ec4,0x3f7f3dc93f0e3f55,0x3f753e953ec43f6d,0x3dc9bf7f3f55bf0e
.quad 0x3f7bbe483f353f35,0xbf0ebf553ec4bf6d,0xbe48bf7b3f35bf35,0xbf553f0ebf6dbec4,0xbf22bf463ec4bf6d,0xbe953f75bf7b3e48,0xbf463f22bf6dbec4,0x3f753e953e483f7b
.quad 0xbec43f6dbf80a742,0x3f6dbec43f353f35,0x3f6d3ec4a7423f80,0xbec4bf6d3f35bf35,0x3f7fbdc93ec43f6d,0xbf62bef13e48bf7b,0xbdc9bf7f3f6dbec4,0xbef13f62bf7bbe48
.quad 0xbf0ebf553f35bf35,0x3e483f7bbf6d3ec4,0xbf553f0ebf35bf35,0x3f7bbe483ec43f6d,0xbef13f62bf6dbec4,0x3f22bf463f553f0e,0x3f623ef1bec43f6d,0xbf46bf223f0ebf55
.quad 0x3f8000003f80,0x3f8000003f80,0x3f8080003f808000,0x3f8080003f808000,0x3f22bf463f35bf35,0x3ef1bf623f0ebf55,0xbf46bf22bf35bf35,0xbf62bef1bf55bf0e
.quad 0xbf7b3e48bf80a554,0xbf553f0ebf6d3ec4,0x3e483f7ba5543f80,0x3f0e3f553ec43f6d,0x3f623ef13f353f35,0x3f7fbdc93f7b3e48,0x3ef1bf623f35bf35,0xbdc9bf7f3e48bf7b
.quad 0xbec4bf6d25d4bf80,0xbf6dbec4bf35bf35,0xbf6d3ec4bf80a5d4,0xbec43f6dbf353f35,0xbe953f75bf353f35,0x3f223f463e483f7b,0x3f753e953f353f35,0x3f46bf223f7bbe48
.quad 0x3f55bf0e3f80261f,0xbe48bf7b3ec4bf6d,0xbf0ebf55261fbf80,0xbf7b3e48bf6dbec4,0xbf7fbdc9bf35bf35,0xbe953f75bf553f0e,0xbdc93f7fbf353f35,0x3f753e953f0e3f55
.quad 0x3f353f35a6543f80,0x3f35bf353f80a68d,0x3f35bf353f802654,0xbf35bf35a68dbf80,0xbdc9bf7f3f35bf35,0xbf753e95bf55bf0e,0xbf7f3dc9bf35bf35,0x3e953f75bf0e3f55
.quad 0xbf0e3f55bf80a742,0x3f7b3e483ec43f6d,0x3f553f0ea7423f80,0x3e48bf7b3f6dbec4,0x3f75be953f353f35,0xbf46bf223e48bf7b,0xbe95bf753f35bf35,0xbf223f46bf7bbe48
.quad 0xbf6dbec4269fbf80,0x3ec43f6dbf353f35,0xbec43f6dbf80a69f,0x3f6dbec43f353f35,0x3ef13f62bf353f35,0x3dc9bf7f3f7bbe48,0x3f62bef13f353f35,0xbf7fbdc9be48bf7b
.quad 0x3e48bf7b3f80a60d,0xbf0e3f55bf6dbec4,0xbf7bbe48a60dbf80,0x3f553f0ebec43f6d,0xbf463f22bf35bf35,0x3f62bef13f0e3f55,0x3f223f46bf353f35,0xbef1bf623f55bf0e
.quad 0x3f8000003f80,0x3f8000003f80,0x3f8080003f808000,0x3f8080003f808000,0x3e95bf753ec4bf6d,0x3dc9bf7f3e48bf7b,0xbf75be95bf6dbec4,0xbf7fbdc9bf7bbe48
.quad 0xbf0e3f55bf353f35,0xbe483f7bbec43f6d,0x3f553f0e3f353f35,0x3f7b3e483f6d3ec4,0x3f46bf223f6dbec4,0x3e95bf753f0ebf55,0xbf22bf46bec4bf6d,0xbf75be95bf55bf0e
.quad 0xbf6d3ec4bf80a5f7,0xbec43f6dbf353f35,0x3ec43f6da5f73f80,0x3f6d3ec43f353f35,0x3f7fbdc93f6d3ec4,0x3ef1bf623f55bf0e,0xbdc9bf7f3ec4bf6d,0xbf62bef1bf0ebf55
.quad 0xbf7bbe48bf35bf35,0xbf0e3f55bf6d3ec4,0xbe483f7bbf353f35,0x3f553f0e3ec43f6d,0x3f623ef13ec43f6d,0x3f22bf463f7bbe48,0x3ef1bf623f6dbec4,0xbf46bf22be48bf7b
.quad 0xbf35bf352677bf80,0xbf353f35bf80a742,0xbf353f35bf80a677,0x3f353f35a7423f80,0x3ef13f62bec43f6d,0x3f46bf223f7b3e48,0x3f62bef13f6d3ec4,0xbf22bf463e48bf7b
.quad 0xbe48bf7b3f35bf35,0xbf553f0ebf6dbec4,0xbf7b3e48bf35bf35,0x3f0e3f55bec43f6d,0xbdc93f7fbf6d3ec4,0x3f62bef13f553f0e,0x3f7f3dc93ec43f6d,0xbef1bf623f0ebf55
.quad 0x3ec4bf6d3f80a60d,0xbf6d3ec4bf35bf35,0xbf6dbec4a60dbf80,0x3ec43f6dbf353f35,0xbf223f46bf6dbec4,0x3f75be953f0e3f55,0x3f463f22bec43f6d,0xbe95bf753f55bf0e
.quad 0x3f55bf0e3f353f35,0xbf7b3e48bec4bf6d,0xbf0ebf553f35bf35,0x3e483f7bbf6d3ec4,0xbf753e95bec4bf6d,0x3f7fbdc93e483f7b,0x3e953f75bf6d3ec4,0xbdc9bf7f3f7bbe48
.quad 0x3f8000003f80,0x3f8000003f80,0x3f8080003f808000,0x3f8080003f808000,0xbdc9bf7f250dbf80,0xbe95bf75be48bf7b,0xbf7f3dc9bf80a50d,0xbf753e95bf7b3e48
.quad 0x3e483f7ba58d3f80,0x3f0e3f553ec43f6d,0x3f7bbe483f80258d,0x3f55bf0e3f6dbec4,0xbe95bf7525d4bf80,0xbf46bf22bf0ebf55,0xbf753e95bf80a5d4,0xbf223f46bf553f0e
.quad 0x3ec43f6da60d3f80,0x3f6d3ec43f353f35,0x3f6dbec43f80260d,0x3ec4bf6d3f35bf35,0xbef1bf622630bf80,0xbf7fbdc9bf55bf0e,0xbf623ef1bf80a630,0xbdc93f7fbf0e3f55
.quad 0x3f0e3f55a6543f80,0x3f7bbe483f6d3ec4,0x3f55bf0e3f802654,0xbe48bf7b3ec4bf6d,0xbf22bf462677bf80,0xbf623ef1bf7bbe48,0xbf463f22bf80a677,0x3ef13f62be483f7b
.quad 0x3f353f35a68d3f80,0x3f35bf353f80a654,0x3f35bf353f80268d,0xbf35bf35a654bf80,0xbf46bf22269fbf80,0xbef13f62bf7b3e48,0xbf223f46bf80a69f,0x3f623ef13e483f7b
.quad 0x3f553f0ea6b03f80,0x3e48bf7b3f6dbec4,0x3f0ebf553f8026b0,0xbf7bbe48bec4bf6d,0xbf62bef127b1bf80,0x3dc93f7fbf553f0e,0xbef13f62bf80a7b1,0x3f7fbdc93f0e3f55
.quad 0x3f6d3ec4a6d43f80,0xbec4bf6d3f35bf35,0x3ec4bf6d3f8026d4,0xbf6d3ec4bf35bf35,0xbf75be95a70dbf80,0x3f223f46bf0e3f55,0xbe953f75bf80270d,0x3f46bf223f553f0e
.quad 0x3f7b3e48a6f73f80,0xbf55bf0e3ec4bf6d,0x3e48bf7b3f8026f7,0xbf0e3f55bf6dbec4,0xbf7fbdc927c2bf80,0x3f753e95be483f7b,0xbdc93f7fbf80a7c2,0x3e95bf753f7b3e48
.quad 0x3f8000003f80,0x3f8000003f80,0x3f8080003f808000,0x3f8080003f808000,0xbef1bf62bec4bf6d,0xbf22bf46bf0ebf55,0xbf623ef1bf6d3ec4,0xbf463f22bf553f0e
.quad 0x3f553f0e3f353f35,0x3f7b3e483f6d3ec4,0x3f0ebf553f35bf35,0x3e48bf7b3ec4bf6d,0xbf7fbdc9bf6dbec4,0xbf623ef1bf7b3e48,0xbdc93f7fbec43f6d,0x3ef13f623e483f7b
.quad 0x3f6dbec43f80261f,0x3ec4bf6d3f35bf35,0xbec4bf6d261fbf80,0xbf6dbec4bf35bf35,0xbf223f46bf6d3ec4,0x3e953f75be483f7b,0x3f463f223ec43f6d,0x3f75be953f7b3e48
.quad 0x3e48bf7b3f35bf35,0xbf55bf0ebec4bf6d,0xbf7bbe48bf35bf35,0xbf0e3f55bf6d3ec4,0x3e953f75bec43f6d,0x3f7fbdc93f553f0e,0x3f75be953f6d3ec4,0xbdc9bf7f3f0ebf55
.quad 0xbf35bf35269fbf80,0xbf353f35bf80a754,0xbf353f35bf80a69f,0x3f353f35a7543f80,0x3f753e953ec43f6d,0x3dc9bf7f3f55bf0e,0x3e95bf753f6dbec4,0xbf7fbdc9bf0ebf55
.quad 0xbf7b3e48bf35bf35,0x3f0e3f55bec43f6d,0x3e483f7bbf353f35,0x3f55bf0e3f6d3ec4,0x3f46bf223f6d3ec4,0xbf75be95be48bf7b,0xbf22bf463ec4bf6d,0xbe953f75bf7b3e48
.quad 0xbec43f6dbf80a777,0x3f6dbec43f353f35,0x3f6d3ec4a7773f80,0xbec4bf6d3f35bf35,0xbdc9bf7f3f6dbec4,0xbef13f62bf7bbe48,0xbf7f3dc9bec4bf6d,0x3f623ef1be483f7b
.quad 0x3f0e3f55bf353f35,0xbe48bf7b3f6dbec4,0x3f55bf0e3f353f35,0xbf7b3e48bec4bf6d,0xbf62bef13ec4bf6d,0x3f463f22bf0e3f55,0xbef13f62bf6dbec4,0x3f22bf463f553f0e
.quad 0x3f8000003f80,0x3f8000003f80,0x3f8080003f808000,0x3f8080003f808000,0xbf46bf22bf35bf35,0xbf62bef1bf55bf0e,0xbf223f46bf353f35,0xbef13f62bf0e3f55
.quad 0x3f7bbe483f8025b0,0x3f55bf0e3f6dbec4,0xbe48bf7b25b0bf80,0xbf0ebf55bec4bf6d,0xbef13f62bf353f35,0x3dc93f7fbe483f7b,0x3f623ef13f353f35,0x3f7fbdc93f7b3e48
.quad 0xbec4bf6d2630bf80,0xbf6dbec4bf35bf35,0xbf6d3ec4bf80a630,0xbec43f6dbf353f35,0x3f753e953f353f35,0x3f46bf223f7bbe48,0x3e95bf753f35bf35,0xbf22bf46be48bf7b
.quad 0xbf553f0ebf80a742,0x3e483f7bbec43f6d,0x3f0e3f55a7423f80,0x3f7bbe483f6d3ec4,0x3dc9bf7f3f35bf35,0xbf75be95bf0ebf55,0xbf7fbdc9bf35bf35,0xbe953f75bf553f0e
.quad 0x3f353f35a6b03f80,0x3f35bf353f80a60d,0x3f35bf353f8026b0,0xbf35bf35a60dbf80,0xbf7f3dc9bf35bf35,0x3e953f75bf0e3f55,0x3dc93f7fbf353f35,0x3f75be953f553f0e
.quad 0x3f0ebf553f80a58e,0xbf7bbe48bec4bf6d,0xbf55bf0ea58ebf80,0xbe483f7bbf6d3ec4,0x3e953f75bf353f35,0x3f22bf463f7b3e48,0x3f75be953f353f35,0xbf46bf223e48bf7b
.quad 0xbf6dbec427c2bf80,0x3ec43f6dbf353f35,0xbec43f6dbf80a7c2,0x3f6dbec43f353f35,0x3f62bef13f353f35,0xbf7fbdc9be48bf7b,0xbef1bf623f35bf35,0xbdc93f7fbf7b3e48
.quad 0xbe483f7bbf80a78d,0x3f0ebf553f6d3ec4,0x3f7b3e48a78d3f80,0xbf55bf0e3ec4bf6d,0xbf22bf463f35bf35,0x3ef13f62bf553f0e,0xbf463f22bf35bf35,0x3f62bef13f0e3f55
.quad 0x3f8000003f80,0x3f8000003f80,0x3f8080003f808000,0x3f8080003f808000,0xbf75be95bf6dbec4,0xbf7fbdc9bf7bbe48,0xbe953f75bec43f6d,0xbdc93f7fbe483f7b
.quad 0x3f0ebf553f35bf35,0x3e48bf7b3ec4bf6d,0xbf55bf0ebf35bf35,0xbf7bbe48bf6dbec4,0x3f223f463ec43f6d,0x3f753e953f553f0e,0x3f46bf223f6dbec4,0x3e95bf753f0ebf55
.quad 0xbf6d3ec4bf80a731,0xbec43f6dbf353f35,0x3ec43f6da7313f80,0x3f6d3ec43f353f35,0xbdc9bf7f3ec4bf6d,0xbf62bef1bf0ebf55,0xbf7f3dc9bf6dbec4,0xbef13f62bf553f0e
.quad 0x3f7b3e483f353f35,0x3f0ebf553f6dbec4,0x3e48bf7b3f35bf35,0xbf55bf0ebec4bf6d,0xbef13f62bf6d3ec4,0x3f463f223e483f7b,0x3f623ef13ec43f6d,0x3f22bf463f7bbe48
.quad 0xbf35bf3527b1bf80,0xbf353f35bf80a765,0xbf353f35bf80a7b1,0x3f353f35a7653f80,0x3f62bef13f6d3ec4,0xbf22bf463e48bf7b,0xbef1bf623ec4bf6d,0xbf463f22bf7bbe48
.quad 0x3e483f7bbf353f35,0x3f55bf0e3f6d3ec4,0x3f7bbe483f353f35,0xbf0ebf553ec4bf6d,0xbf7fbdc9bec4bf6d,0x3ef13f62bf0e3f55,0xbdc93f7fbf6d3ec4,0x3f62bef13f553f0e
.quad 0x3ec4bf6d3f80258d,0xbf6d3ec4bf35bf35,0xbf6dbec4258dbf80,0x3ec43f6dbf353f35,0x3f463f22bec43f6d,0xbe95bf753f55bf0e,0x3f22bf463f6d3ec4,0xbf753e95bf0ebf55
.quad 0xbf553f0ebf35bf35,0x3f7bbe483ec43f6d,0x3f0e3f55bf353f35,0xbe48bf7b3f6dbec4,0xbe95bf753f6dbec4,0x3dc93f7fbf7b3e48,0xbf753e95bec4bf6d,0x3f7fbdc93e483f7b
.quad 0x3f8000003f80,0x3f8000003f80,0x3f8080003f808000,0x3f8080003f808000,0xbf7f3dc9bf80a554,0xbf753e95bf7b3e48,0x3dc93f7fa5543f80,0x3e953f753e483f7b
.quad 0xbe48bf7b25d4bf80,0xbf0ebf55bec4bf6d,0xbf7b3e48bf80a5d4,0xbf553f0ebf6d3ec4,0x3f75be953f80261f,0x3f22bf463f55bf0e,0xbe95bf75261fbf80,0xbf46bf22bf0ebf55
.quad 0x3ec43f6da6543f80,0x3f6d3ec43f353f35,0x3f6dbec43f802654,0x3ec4bf6d3f35bf35,0xbf623ef1bf80a742,0xbdc93f7fbf0e3f55,0x3ef13f62a7423f80,0x3f7f3dc93f553f0e
.quad 0xbf0ebf55269fbf80,0xbf7b3e48bf6dbec4,0xbf553f0ebf80a69f,0x3e483f7bbec43f6d,0x3f46bf223f80a60d,0xbef1bf623e48bf7b,0xbf22bf46a60dbf80,0xbf623ef1bf7bbe48
.quad 0x3f353f35a6d43f80,0x3f35bf353f80a58e,0x3f35bf353f8026d4,0xbf35bf35a58ebf80,0xbf223f46bf80a777,0x3f623ef13e483f7b,0x3f463f22a7773f80,0x3ef1bf623f7bbe48
.quad 0xbf55bf0e27c2bf80,0xbe483f7bbf6d3ec4,0xbf0e3f55bf80a7c2,0x3f7b3e483ec43f6d,0x3ef1bf623f802804,0xbf7f3dc9bf0ebf55,0xbf62bef12804bf80,0x3dc93f7fbf553f0e
.quad 0x3f6d3ec4a71f3f80,0xbec4bf6d3f35bf35,0x3ec4bf6d3f80271f,0xbf6d3ec4bf35bf35,0xbe953f75bf802754,0x3f46bf223f553f0e,0x3f753e9527543f80,0xbf22bf463f0ebf55
.quad 0xbf7bbe48a68dbf80,0x3f553f0ebec43f6d,0xbe483f7bbf80268d,0x3f0ebf553f6d3ec4,0x3dc9bf7f3f802889,0xbe953f75bf7bbe48,0xbf7fbdc92889bf80,0x3f753e95be483f7b
.quad 0x3f8000003f80,0x3f8000003f80,0x3f8080003f808000,0x3f8080003f808000,0xbf623ef1bf6d3ec4,0xbf463f22bf553f0e,0x3ef13f623ec43f6d,0x3f223f463f0e3f55
.quad 0xbf55bf0ebf35bf35,0xbf7bbe48bf6dbec4,0xbf0e3f55bf353f35,0xbe483f7bbec43f6d,0x3dc9bf7f3ec4bf6d,0xbef1bf62be48bf7b,0xbf7fbdc9bf6dbec4,0xbf623ef1bf7b3e48
.quad 0x3f6dbec43f80a68d,0x3ec4bf6d3f35bf35,0xbec4bf6da68dbf80,0xbf6dbec4bf35bf35,0x3f463f223ec43f6d,0x3f75be953f7b3e48,0x3f22bf463f6dbec4,0xbe95bf753e48bf7b
.quad 0xbe483f7bbf353f35,0x3f553f0e3ec43f6d,0x3f7b3e483f353f35,0x3f0ebf553f6dbec4,0xbf753e95bf6dbec4,0x3dc93f7fbf0e3f55,0x3e953f75bec43f6d,0x3f7fbdc93f553f0e
.quad 0xbf35bf35a70dbf80,0xbf353f35bf80a777,0xbf353f35bf80270d,0x3f353f35a7773f80,0x3e95bf753f6dbec4,0xbf7fbdc9bf0ebf55,0xbf75be95bec4bf6d,0xbdc93f7fbf553f0e
.quad 0x3f7bbe483f353f35,0xbf0ebf553ec4bf6d,0xbe48bf7b3f35bf35,0xbf553f0ebf6dbec4,0x3f223f46bec43f6d,0x3e95bf753f7bbe48,0x3f46bf223f6d3ec4,0xbf75be95be48bf7b
.quad 0xbec43f6dbf80a796,0x3f6dbec43f353f35,0x3f6d3ec4a7963f80,0xbec4bf6d3f35bf35,0xbf7f3dc9bec4bf6d,0x3f623ef1be483f7b,0x3dc93f7fbf6d3ec4,0x3ef1bf623f7b3e48
.quad 0xbf0ebf553f35bf35,0x3e483f7bbf6d3ec4,0xbf553f0ebf35bf35,0x3f7bbe483ec43f6d,0x3ef1bf623f6d3ec4,0xbf223f46bf55bf0e,0xbf62bef13ec4bf6d,0x3f463f22bf0e3f55
.quad 0x3f8000003f80,0x3f8000003f80,0x3f8080003f808000,0x3f8080003f808000,0xbf223f46bf353f35,0xbef13f62bf0e3f55,0x3f463f223f353f35,0x3f623ef13f553f0e
.quad 0xbf7b3e48bf80a5f7,0xbf553f0ebf6d3ec4,0x3e483f7ba5f73f80,0x3f0e3f553ec43f6d,0xbf62bef1bf35bf35,0xbf7f3dc9bf7bbe48,0xbef13f62bf353f35,0x3dc93f7fbe483f7b
.quad 0xbec4bf6d2677bf80,0xbf6dbec4bf35bf35,0xbf6d3ec4bf80a677,0xbec43f6dbf353f35,0x3e95bf753f35bf35,0xbf22bf46be48bf7b,0xbf75be95bf35bf35,0xbf463f22bf7b3e48
.quad 0x3f55bf0e3f80a60d,0xbe48bf7b3ec4bf6d,0xbf0ebf55a60dbf80,0xbf7b3e48bf6dbec4,0x3f7f3dc93f353f35,0x3e95bf753f55bf0e,0x3dc9bf7f3f35bf35,0xbf75be95bf0ebf55
.quad 0x3f353f35a6f73f80,0x3f35bf353f80a137,0x3f35bf353f8026f7,0xbf35bf35a137bf80,0x3dc93f7fbf353f35,0x3f75be953f553f0e,0x3f7fbdc93f353f35,0xbe95bf753f0ebf55
.quad 0xbf0e3f55bf80a78d,0x3f7b3e483ec43f6d,0x3f553f0ea78d3f80,0x3e48bf7b3f6dbec4,0xbf753e95bf35bf35,0x3f463f22be483f7b,0x3e953f75bf353f35,0x3f22bf463f7b3e48
.quad 0xbf6dbec4a68dbf80,0x3ec43f6dbf353f35,0xbec43f6dbf80268d,0x3f6dbec43f353f35,0xbef1bf623f35bf35,0xbdc93f7fbf7b3e48,0xbf623ef1bf35bf35,0x3f7f3dc93e483f7b
.quad 0x3e48bf7b3f802816,0xbf0e3f55bf6dbec4,0xbf7bbe482816bf80,0x3f553f0ebec43f6d,0x3f46bf223f353f35,0xbf623ef1bf0ebf55,0xbf22bf463f35bf35,0x3ef13f62bf553f0e
.quad 0x3f8000003f80,0x3f8000003f80,0x3f8080003f808000,0x3f8080003f808000,0xbe953f75bec43f6d,0xbdc93f7fbe483f7b,0x3f753e953f6d3ec4,0x3f7f3dc93f7b3e48
.quad 0xbf0e3f55bf353f35,0xbe483f7bbec43f6d,0x3f553f0e3f353f35,0x3f7b3e483f6d3ec4,0xbf463f22bf6d3ec4,0xbe953f75bf0e3f55,0x3f223f463ec43f6d,0x3f753e953f553f0e
.quad 0xbf6d3ec4bf80a742,0xbec43f6dbf353f35,0x3ec43f6da7423f80,0x3f6d3ec43f353f35,0xbf7f3dc9bf6dbec4,0xbef13f62bf553f0e,0x3dc93f7fbec43f6d,0x3f623ef13f0e3f55
.quad 0xbf7bbe48bf35bf35,0xbf0e3f55bf6d3ec4,0xbe483f7bbf353f35,0x3f553f0e3ec43f6d,0xbf62bef1bec4bf6d,0xbf223f46bf7b3e48,0xbef13f62bf6d3ec4,0x3f463f223e483f7b
.quad 0xbf35bf3527c2bf80,0xbf353f35bf80a784,0xbf353f35bf80a7c2,0x3f353f35a7843f80,0xbef1bf623ec4bf6d,0xbf463f22bf7bbe48,0xbf623ef1bf6dbec4,0x3f223f46be483f7b
.quad 0xbe48bf7b3f35bf35,0xbf553f0ebf6dbec4,0xbf7b3e48bf35bf35,0x3f0e3f55bec43f6d,0x3dc9bf7f3f6dbec4,0xbf623ef1bf55bf0e,0xbf7fbdc9bec4bf6d,0x3ef13f62bf0e3f55
.quad 0x3ec4bf6d3f80268d,0xbf6d3ec4bf35bf35,0xbf6dbec4268dbf80,0x3ec43f6dbf353f35,0x3f22bf463f6d3ec4,0xbf753e95bf0ebf55,0xbf46bf223ec4bf6d,0x3e953f75bf553f0e
.quad 0x3f55bf0e3f353f35,0xbf7b3e48bec4bf6d,0xbf0ebf553f35bf35,0x3e483f7bbf6d3ec4,0x3f75be953ec43f6d,0xbf7f3dc9be48bf7b,0xbe95bf753f6dbec4,0x3dc93f7fbf7b3e48
.quad 0x3f80248d00003f80,0xbf80a554250dbf80,0x248dbf803f808000,0xa5543f80bf80a50d,0x3f7fbdc900003f80,0xbf753e95be48bf7b,0xbdc9bf7f3f808000,0x3e953f75bf7b3e48
.quad 0x3f7bbe4800003f80,0xbf553f0ebec4bf6d,0xbe48bf7b3f808000,0x3f0e3f55bf6d3ec4,0x3f75be9500003f80,0xbf223f46bf0ebf55,0xbe95bf753f808000,0x3f463f22bf553f0e
.quad 0x3f6dbec400003f80,0xbec43f6dbf35bf35,0xbec4bf6d3f808000,0x3f6d3ec4bf353f35,0x3f62bef100003f80,0xbdc93f7fbf55bf0e,0xbef1bf623f808000,0x3f7f3dc9bf0e3f55
.quad 0x3f55bf0e00003f80,0x3e483f7bbf6dbec4,0xbf0ebf553f808000,0x3f7bbe48bec43f6d,0x3f46bf2200003f80,0x3ef13f62bf7bbe48,0xbf22bf463f808000,0x3f62bef1be483f7b
.quad 0x3f35bf3500003f80,0x3f353f35bf80a554,0xbf35bf353f808000,0x3f35bf35a5543f80,0x3f22bf4600003f80,0x3f623ef1bf7b3e48,0xbf46bf223f808000,0x3ef1bf623e483f7b
.quad 0x3f0ebf5500003f80,0x3f7b3e48bf6d3ec4,0xbf55bf0e3f808000,0x3e48bf7b3ec43f6d,0x3ef1bf6200003f80,0x3f7fbdc9bf553f0e,0xbf62bef13f808000,0xbdc9bf7f3f0e3f55
.quad 0x3ec4bf6d00003f80,0x3f6dbec4bf353f35,0xbf6dbec43f808000,0xbec4bf6d3f353f35,0x3e95bf7500003f80,0x3f46bf22bf0e3f55,0xbf75be953f808000,0xbf22bf463f553f0e
.quad 0x3e48bf7b00003f80,0x3f0ebf55bec43f6d,0xbf7bbe483f808000,0xbf55bf0e3f6d3ec4,0x3dc9bf7f00003f80,0x3e95bf75be483f7b,0xbf7fbdc93f808000,0xbf75be953f7b3e48
.quad 0x3f8025b0a58d3f80,0xbf80a5f725d4bf80,0x25b0bf803f80258d,0xa5f73f80bf80a5d4,0x3f62bef13ec43f6d,0xbf463f22bf0ebf55,0xbef1bf623f6dbec4,0x3f223f46bf553f0e
.quad 0x3f0ebf553f353f35,0xbe483f7bbf6dbec4,0xbf55bf0e3f35bf35,0x3f7b3e48bec43f6d,0x3dc9bf7f3f6d3ec4,0x3ef13f62bf7b3e48,0xbf7fbdc93ec4bf6d,0x3f62bef13e483f7b
.quad 0xbec4bf6d3f8025b0,0x3f6d3ec4bf353f35,0xbf6d3ec425b0bf80,0x3ec4bf6d3f353f35,0xbf46bf223f6dbec4,0x3f75be95be483f7b,0xbf223f46bec4bf6d,0xbe95bf753f7b3e48
.quad 0xbf7bbe483f35bf35,0x3f0ebf553ec43f6d,0xbe483f7bbf35bf35,0xbf55bf0e3f6dbec4,0xbf753e953ec4bf6d,0xbdc9bf7f3f553f0e,0x3e953f75bf6dbec4,0xbf7f3dc93f0ebf55
.quad 0xbf353f3525d4bf80,0xbf35bf353f80261f,0x3f353f35bf80a5d4,0xbf353f35261fbf80,0xbe953f75bec4bf6d,0xbf7fbdc93f55bf0e,0x3f753e95bf6d3ec4,0xbdc93f7fbf0ebf55
.quad 0x3e483f7bbf35bf35,0xbf553f0e3ec4bf6d,0x3f7bbe48bf353f35,0x3f0e3f55bf6dbec4,0x3f223f46bf6dbec4,0xbe953f75be48bf7b,0x3f46bf22bec43f6d,0x3f753e95bf7b3e48
.quad 0x3f6d3ec4bf80a5f7,0x3ec43f6dbf35bf35,0x3ec4bf6da5f73f80,0x3f6dbec4bf353f35,0x3f7fbdc9bf6d3ec4,0x3f623ef1bf7bbe48,0xbdc9bf7f3ec43f6d,0x3ef1bf62be483f7b
.quad 0x3f55bf0ebf353f35,0x3f7bbe48bf6d3ec4,0xbf0ebf553f353f35,0xbe48bf7b3ec43f6d,0x3ef1bf62bec43f6d,0x3f22bf46bf0e3f55,0xbf62bef13f6d3ec4,0xbf46bf223f553f0e
.quad 0x3f80261fa60d3f80,0xbf80a7312630bf80,0x261fbf803f80260d,0xa7313f80bf80a630,0x3f22bf463f353f35,0xbef13f62bf55bf0e,0xbf46bf223f35bf35,0x3f623ef1bf0e3f55
.quad 0xbe48bf7b3f80261f,0x3f0e3f55bf6d3ec4,0xbf7b3e48261fbf80,0x3f55bf0e3ec43f6d,0xbf62bef13f35bf35,0x3f7fbdc9be483f7b,0xbef13f62bf35bf35,0xbdc9bf7f3f7b3e48
.quad 0xbf6d3ec42630bf80,0x3ec4bf6d3f353f35,0x3ec43f6dbf80a630,0xbf6dbec43f35bf35,0xbe953f75bf35bf35,0xbf22bf463f7bbe48,0x3f753e95bf353f35,0xbf463f22be48bf7b
.quad 0x3f0e3f55bf80a731,0xbf7b3e483ec4bf6d,0x3f55bf0ea7313f80,0x3e483f7bbf6dbec4,0x3f7f3dc9bf353f35,0xbe953f75bf0ebf55,0x3dc9bf7f3f353f35,0x3f753e95bf553f0e
.quad 0x3f35bf35a6543f80,0x3f353f35bf80a742,0xbf35bf353f802654,0x3f35bf35a7423f80,0xbdc9bf7f3f353f35,0x3f75be95bf0e3f55,0xbf7f3dc93f35bf35,0xbe95bf753f553f0e
.quad 0xbf55bf0e3f80a68d,0x3e48bf7b3ec43f6d,0xbf0e3f55a68dbf80,0xbf7bbe483f6dbec4,0xbf753e953f35bf35,0xbf46bf223f7b3e48,0x3e953f75bf35bf35,0xbf223f463e48bf7b
.quad 0xbec43f6d2677bf80,0xbf6d3ec43f35bf35,0x3f6d3ec4bf80a677,0x3ec43f6dbf35bf35,0x3ef13f62bf35bf35,0xbdc93f7fbe48bf7b,0x3f62bef1bf353f35,0x3f7f3dc9bf7b3e48
.quad 0x3f7b3e48bf80a742,0x3f553f0ebf6dbec4,0x3e48bf7ba7423f80,0x3f0ebf55bec43f6d,0x3f46bf22bf353f35,0x3f62bef1bf553f0e,0xbf22bf463f353f35,0xbef1bf623f0e3f55
.quad 0x3f80a68da6543f80,0xbf80a7422677bf80,0xa68dbf803f802654,0xa7423f80bf80a677,0x3e95bf753f6d3ec4,0xbdc93f7fbf7bbe48,0xbf75be953ec4bf6d,0x3f7f3dc9be483f7b
.quad 0xbf55bf0e3f35bf35,0x3f7b3e48bec43f6d,0xbf0e3f55bf35bf35,0x3e48bf7b3f6d3ec4,0xbf463f22bec4bf6d,0x3e95bf753f553f0e,0x3f223f46bf6d3ec4,0xbf75be953f0ebf55
.quad 0x3ec43f6dbf80a742,0xbf6dbec43f35bf35,0x3f6dbec4a7423f80,0xbec43f6dbf35bf35,0x3f7fbdc9bec43f6d,0xbef13f62bf0ebf55,0xbdc9bf7f3f6d3ec4,0x3f623ef1bf553f0e
.quad 0x3e48bf7b3f353f35,0x3f553f0ebf6d3ec4,0xbf7bbe483f35bf35,0x3f0ebf553ec43f6d,0xbf62bef13f6dbec4,0x3f22bf463e483f7b,0xbef13f62bec4bf6d,0xbf46bf223f7bbe48
.quad 0xbf353f35269fbf80,0xbf35bf353f80a60d,0x3f353f35bf80a69f,0xbf353f35a60dbf80,0x3ef13f62bf6dbec4,0xbf463f223e48bf7b,0x3f62bef1bec43f6d,0x3f223f46bf7bbe48
.quad 0x3f7bbe48bf353f35,0x3f0e3f55bf6dbec4,0xbe48bf7b3f353f35,0x3f55bf0ebec43f6d,0x3dc9bf7f3ec43f6d,0x3f62bef1bf0e3f55,0xbf7fbdc93f6dbec4,0xbef1bf623f553f0e
.quad 0xbf6dbec43f80a60d,0xbec4bf6d3f353f35,0xbec43f6da60dbf80,0xbf6d3ec43f35bf35,0xbf223f463ec4bf6d,0xbf753e953f55bf0e,0x3f463f22bf6dbec4,0x3e953f75bf0ebf55
.quad 0x3f0e3f55bf35bf35,0x3e483f7bbec4bf6d,0x3f55bf0ebf353f35,0x3f7bbe48bf6d3ec4,0x3f75be95bf6d3ec4,0x3f7fbdc9bf7b3e48,0xbe95bf753ec43f6d,0xbdc9bf7f3e483f7b
.quad 0x3f80a654a68d3f80,0xbf80a754269fbf80,0xa654bf803f80268d,0xa7543f80bf80a69f,0xbdc9bf7f3f80a654,0x3e953f75bf7b3e48,0xbf7f3dc9a654bf80,0x3f75be953e483f7b
.quad 0xbf7b3e48269fbf80,0x3f55bf0e3ec43f6d,0x3e483f7bbf80a69f,0xbf0ebf553f6dbec4,0x3e953f75bf80a754,0xbf46bf223f55bf0e,0x3f75be95a7543f80,0xbf223f46bf0ebf55
.quad 0x3f6dbec4a6b03f80,0xbec43f6dbf35bf35,0xbec4bf6d3f8026b0,0x3f6d3ec4bf353f35,0xbef1bf623f80a60d,0x3f7f3dc9bf0e3f55,0xbf623ef1a60dbf80,0x3dc9bf7f3f553f0e
.quad 0xbf553f0e27b1bf80,0xbe48bf7b3f6d3ec4,0x3f0e3f55bf80a7b1,0xbf7b3e483ec4bf6d,0x3f223f46bf80a765,0xbf623ef13e48bf7b,0x3f46bf22a7653f80,0x3ef13f62bf7bbe48
.quad 0x3f35bf35a6d43f80,0x3f353f35bf80a777,0xbf35bf353f8026d4,0x3f35bf35a7773f80,0xbf46bf223f80a58e,0x3ef1bf623e483f7b,0xbf223f46a58ebf80,0xbf62bef13f7bbe48
.quad 0xbf0e3f55a70dbf80,0xbf7bbe483f6dbec4,0x3f553f0ebf80270d,0xbe483f7bbec4bf6d,0x3f623ef1bf80a777,0x3dc93f7fbf0ebf55,0x3ef1bf62a7773f80,0x3f7fbdc9bf553f0e
.quad 0x3ec4bf6da6f73f80,0x3f6dbec4bf353f35,0xbf6dbec43f8026f7,0xbec4bf6d3f353f35,0xbf75be953f80a137,0xbf22bf463f553f0e,0xbe953f75a137bf80,0xbf463f223f0ebf55
.quad 0xbe483f7b27c2bf80,0xbf0e3f553ec4bf6d,0x3f7b3e48bf80a7c2,0x3f553f0ebf6dbec4,0x3f7f3dc9bf80a784,0x3f753e95bf7bbe48,0x3dc9bf7fa7843f80,0x3e95bf75be483f7b
.quad 0x3f80a60da6b03f80,0xbf80a76527b1bf80,0xa60dbf803f8026b0,0xa7653f80bf80a7b1,0xbef1bf623f6dbec4,0x3f223f46bf553f0e,0xbf623ef1bec4bf6d,0x3f46bf223f0e3f55
.quad 0xbf0e3f55bf35bf35,0x3e48bf7b3f6d3ec4,0x3f553f0ebf353f35,0xbf7bbe483ec4bf6d,0x3f7f3dc9bec43f6d,0xbf623ef1be48bf7b,0x3dc9bf7f3f6d3ec4,0x3ef13f62bf7b3e48
.quad 0xbec4bf6d3f80a58e,0x3f6d3ec4bf353f35,0xbf6d3ec4a58ebf80,0x3ec4bf6d3f353f35,0xbf223f46bec4bf6d,0xbe95bf753f7b3e48,0x3f463f22bf6d3ec4,0xbf753e953e48bf7b
.quad 0x3f7b3e48bf353f35,0xbf0e3f55bec4bf6d,0x3e48bf7b3f353f35,0x3f553f0ebf6d3ec4,0xbe95bf753f6d3ec4,0x3f7fbdc9bf0e3f55,0xbf753e953ec4bf6d,0xbdc9bf7f3f553f0e
.quad 0xbf353f3527c2bf80,0xbf35bf353f80258d,0x3f353f35bf80a7c2,0xbf353f35258dbf80,0x3f753e95bf6d3ec4,0xbdc93f7fbf0ebf55,0x3e95bf753ec43f6d,0x3f7f3dc9bf553f0e
.quad 0xbe48bf7b3f353f35,0x3f55bf0ebec43f6d,0xbf7b3e483f35bf35,0xbf0ebf553f6d3ec4,0xbf463f223ec4bf6d,0xbf75be953f7bbe48,0x3f223f46bf6dbec4,0xbe953f75be48bf7b
.quad 0x3f6d3ec4bf80a78d,0x3ec43f6dbf35bf35,0x3ec4bf6da78d3f80,0x3f6dbec4bf353f35,0xbdc9bf7f3ec43f6d,0x3ef1bf62be483f7b,0xbf7f3dc93f6dbec4,0xbf62bef13f7b3e48
.quad 0xbf553f0e3f35bf35,0xbf7b3e483f6dbec4,0x3f0e3f55bf35bf35,0x3e483f7bbec4bf6d,0x3f623ef1bf6dbec4,0x3f463f22bf55bf0e,0x3ef1bf62bec43f6d,0x3f22bf46bf0e3f55
.quad 0x3f80a58ea6d43f80,0xbf80a777a70dbf80,0xa58ebf803f8026d4,0xa7773f80bf80270d,0xbf46bf223f35bf35,0x3f623ef1bf0e3f55,0xbf223f46bf35bf35,0x3ef1bf623f553f0e
.quad 0x3e483f7bbf80a777,0xbf0ebf553f6dbec4,0x3f7bbe48a7773f80,0xbf553f0ebec4bf6d,0x3ef1bf623f353f35,0x3dc93f7fbf7bbe48,0xbf62bef13f35bf35,0x3f7fbdc9be483f7b
.quad 0xbf6d3ec427c2bf80,0x3ec4bf6d3f353f35,0x3ec43f6dbf80a7c2,0xbf6dbec43f35bf35,0x3f753e95bf353f35,0xbf463f22be48bf7b,0x3e95bf753f353f35,0x3f223f46bf7b3e48
.quad 0xbf0ebf553f802804,0x3f7bbe48bec43f6d,0xbf553f0e2804bf80,0xbe48bf7b3f6d3ec4,0xbdc93f7fbf35bf35,0xbf75be953f55bf0e,0x3f7f3dc9bf353f35,0xbe953f75bf0ebf55
.quad 0x3f35bf35a71f3f80,0x3f353f35bf80a796,0xbf35bf353f80271f,0x3f35bf35a7963f80,0xbf7f3dc93f35bf35,0xbe95bf753f553f0e,0x3dc93f7fbf35bf35,0xbf753e953f0ebf55
.quad 0x3f553f0ebf802754,0xbe483f7bbec4bf6d,0x3f0ebf5527543f80,0x3f7b3e48bf6d3ec4,0xbe95bf753f353f35,0x3f22bf46be483f7b,0xbf753e953f35bf35,0xbf46bf223f7b3e48
.quad 0xbec43f6da68dbf80,0xbf6d3ec43f35bf35,0x3f6d3ec4bf80268d,0x3ec43f6dbf35bf35,0x3f62bef1bf353f35,0x3f7f3dc9bf7b3e48,0xbef1bf623f353f35,0x3dc9bf7f3e483f7b
.quad 0xbf7bbe483f802889,0xbf55bf0e3f6d3ec4,0xbe483f7b2889bf80,0xbf0e3f553ec4bf6d,0x3f223f46bf35bf35,0x3ef13f62bf0ebf55,0x3f46bf22bf353f35,0x3f62bef1bf553f0e
.quad 0x3f80a137a6f73f80,0xbf80a78427c2bf80,0xa137bf803f8026f7,0xa7843f80bf80a7c2,0xbf75be953ec4bf6d,0x3f7f3dc9be483f7b,0xbe953f75bf6dbec4,0x3dc9bf7f3f7b3e48
.quad 0x3f553f0ebf353f35,0xbf7bbe483ec4bf6d,0x3f0ebf553f353f35,0xbe483f7bbf6dbec4,0xbf22bf463f6dbec4,0x3f753e95bf0e3f55,0xbf463f22bec4bf6d,0x3e95bf753f553f0e
.quad 0x3ec43f6dbf80a78d,0xbf6dbec43f35bf35,0x3f6dbec4a78d3f80,0xbec43f6dbf35bf35,0xbdc9bf7f3f6d3ec4,0x3f623ef1bf553f0e,0xbf7f3dc93ec4bf6d,0x3ef1bf623f0e3f55
.quad 0xbe483f7bbf35bf35,0xbf55bf0e3f6dbec4,0x3f7b3e48bf353f35,0xbf0e3f55bec4bf6d,0x3ef1bf623ec43f6d,0x3f463f22bf7b3e48,0xbf62bef13f6dbec4,0x3f22bf463e483f7b
.quad 0xbf353f35a68dbf80,0xbf35bf353f80268d,0x3f353f35bf80268d,0xbf353f35268dbf80,0x3f62bef1bec43f6d,0x3f223f46bf7bbe48,0xbef1bf623f6d3ec4,0x3f46bf22be483f7b
.quad 0xbf7b3e483f35bf35,0xbf0ebf553f6d3ec4,0x3e483f7bbf35bf35,0xbf553f0e3ec4bf6d,0x3f7f3dc9bf6d3ec4,0x3ef13f62bf55bf0e,0x3dc9bf7f3ec43f6d,0x3f62bef1bf0e3f55
.quad 0xbf6dbec43f802816,0xbec4bf6d3f353f35,0xbec43f6d2816bf80,0xbf6d3ec43f35bf35,0x3f463f22bf6dbec4,0x3e953f75bf0ebf55,0x3f22bf46bec43f6d,0x3f75be95bf553f0e
.quad 0xbf0ebf553f353f35,0xbe48bf7b3ec43f6d,0xbf553f0e3f35bf35,0xbf7b3e483f6dbec4,0x3e953f75bec4bf6d,0x3dc93f7fbe48bf7b,0x3f75be95bf6d3ec4,0x3f7fbdc9bf7b3e48
.quad 0x3f80258da70d3f80,0xbf80a78da6d4bf80,0x258dbf803f80270d,0xa78d3f80bf8026d4,0xbf7f3dc9a6d4bf80,0x3f75be953e483f7b,0x3dc93f7fbf8026d4,0xbe95bf753f7bbe48
.quad 0x3f7bbe48a71f3f80,0xbf553f0ebec4bf6d,0xbe48bf7b3f80271f,0x3f0e3f55bf6d3ec4,0xbf753e9527d4bf80,0x3f22bf463f0e3f55,0x3e953f75bf80a7d4,0xbf46bf223f55bf0e
.quad 0x3f6dbec4a7303f80,0xbec43f6dbf35bf35,0xbec4bf6d3f802730,0x3f6d3ec4bf353f35,0xbf623ef1a68dbf80,0x3dc9bf7f3f553f0e,0x3ef13f62bf80268d,0xbf7fbdc93f0ebf55
.quad 0x3f55bf0ea8313f80,0x3e483f7bbf6dbec4,0xbf0ebf553f802831,0x3f7bbe48bec43f6d,0xbf463f2227e5bf80,0xbef1bf623f7b3e48,0x3f223f46bf80a7e5,0xbf623ef13e48bf7b
.quad 0x3f35bf35a7543f80,0x3f353f35bf80a7b1,0xbf35bf353f802754,0x3f35bf35a7b13f80,0xbf223f46a60ebf80,0xbf62bef13f7bbe48,0x3f463f22bf80260e,0xbef13f62be48bf7b
.quad 0x3f0ebf55278d3f80,0x3f7b3e48bf6d3ec4,0xbf55bf0e3f80a78d,0x3e48bf7b3ec43f6d,0xbef13f6227f7bf80,0xbf7f3dc93f55bf0e,0x3f623ef1bf80a7f7,0x3dc93f7fbf0ebf55
.quad 0x3ec4bf6da7773f80,0x3f6dbec4bf353f35,0xbf6dbec43f802777,0xbec4bf6d3f353f35,0xbe953f75a1b7bf80,0xbf463f223f0ebf55,0x3f753e95bf8021b7,0x3f223f46bf55bf0e
.quad 0x3e48bf7ba8423f80,0x3f0ebf55bec43f6d,0xbf7bbe483f802842,0xbf55bf0e3f6d3ec4,0xbdc93f7f2804bf80,0xbe953f753e48bf7b,0x3f7f3dc9bf80a804,0x3f753e95bf7bbe48
.quad 0x3f80260da71f3f80,0xbf80a79627d4bf80,0x260dbf803f80271f,0xa7963f80bf80a7d4,0xbf623ef1bec4bf6d,0x3f46bf223f0e3f55,0x3ef13f62bf6d3ec4,0xbf22bf463f55bf0e
.quad 0x3f0ebf553f353f35,0xbe483f7bbf6dbec4,0xbf55bf0e3f35bf35,0x3f7b3e48bec43f6d,0xbdc93f7fbf6dbec4,0xbef1bf623f7bbe48,0x3f7f3dc9bec43f6d,0xbf623ef1be48bf7b
.quad 0xbec4bf6d3f80268d,0x3f6d3ec4bf353f35,0xbf6d3ec4268dbf80,0x3ec4bf6d3f353f35,0x3f463f22bf6d3ec4,0xbf753e953e48bf7b,0x3f22bf463ec43f6d,0x3e953f75bf7bbe48
.quad 0xbf7bbe483f35bf35,0x3f0ebf553ec43f6d,0xbe483f7bbf35bf35,0xbf55bf0e3f6dbec4,0x3f75be95bec43f6d,0x3dc93f7fbf55bf0e,0xbe95bf753f6d3ec4,0x3f7fbdc9bf0e3f55
.quad 0xbf353f3527f7bf80,0xbf35bf353f80281f,0x3f353f35bf80a7f7,0xbf353f35281fbf80,0x3e95bf753ec43f6d,0x3f7f3dc9bf553f0e,0xbf75be953f6dbec4,0x3dc9bf7f3f0e3f55
.quad 0x3e483f7bbf35bf35,0xbf553f0e3ec4bf6d,0x3f7bbe48bf353f35,0x3f0e3f55bf6dbec4,0xbf22bf463f6d3ec4,0x3e95bf753e483f7b,0xbf463f223ec4bf6d,0xbf75be953f7bbe48
.quad 0x3f6d3ec4bf8026d4,0x3ec43f6dbf35bf35,0x3ec4bf6d26d43f80,0x3f6dbec4bf353f35,0xbf7f3dc93f6dbec4,0xbf62bef13f7b3e48,0x3dc93f7fbec4bf6d,0xbef13f623e48bf7b
.quad 0x3f55bf0ebf353f35,0x3f7bbe48bf6d3ec4,0xbf0ebf553f353f35,0xbe48bf7b3ec43f6d,0xbef13f623ec4bf6d,0xbf223f463f0ebf55,0x3f623ef1bf6dbec4,0x3f463f22bf55bf0e
.quad 0x3f80280da7303f80,0xbf80a79fa68dbf80,0x280dbf803f802730,0xa79f3f80bf80268d,0xbf223f46bf35bf35,0x3ef1bf623f553f0e,0x3f463f22bf353f35,0xbf62bef13f0ebf55
.quad 0xbe48bf7b3f80268d,0x3f0e3f55bf6d3ec4,0xbf7b3e48268dbf80,0x3f55bf0e3ec43f6d,0x3f623ef1bf353f35,0xbf7f3dc93e48bf7b,0x3ef1bf623f353f35,0x3dc93f7fbf7bbe48
.quad 0xbf6d3ec4a60ebf80,0x3ec4bf6d3f353f35,0x3ec43f6dbf80260e,0xbf6dbec43f35bf35,0x3e95bf753f353f35,0x3f223f46bf7b3e48,0xbf75be953f35bf35,0x3f46bf223e483f7b
.quad 0x3f0e3f55bf80a85d,0xbf7b3e483ec4bf6d,0x3f55bf0ea85d3f80,0x3e483f7bbf6dbec4,0xbf7fbdc93f35bf35,0x3e95bf753f0e3f55,0xbdc93f7fbf35bf35,0xbf75be953f55bf0e
.quad 0x3f35bf35a8423f80,0x3f353f35bf8026d4,0xbf35bf353f802842,0x3f35bf3526d43f80,0x3dc93f7fbf35bf35,0xbf753e953f0ebf55,0x3f7fbdc9bf353f35,0x3e953f75bf55bf0e
.quad 0xbf55bf0e3f80a7b1,0x3e48bf7b3ec43f6d,0xbf0e3f55a7b1bf80,0xbf7bbe483f6dbec4,0x3f75be95bf353f35,0x3f463f22bf7bbe48,0xbe95bf753f353f35,0x3f22bf46be483f7b
.quad 0xbec43f6d280dbf80,0xbf6d3ec43f35bf35,0x3f6d3ec4bf80a80d,0x3ec43f6dbf35bf35,0xbef1bf623f353f35,0x3dc9bf7f3e483f7b,0xbf623ef13f35bf35,0xbf7fbdc93f7bbe48
.quad 0x3f7b3e48bf80a7e5,0x3f553f0ebf6dbec4,0x3e48bf7ba7e53f80,0x3f0ebf55bec43f6d,0xbf463f223f35bf35,0xbf623ef13f55bf0e,0x3f223f46bf35bf35,0x3ef13f62bf0ebf55
.quad 0x3f80268da8313f80,0xbf80273127e5bf80,0x268dbf803f802831,0x27313f80bf80a7e5,0xbe953f75bf6dbec4,0x3dc9bf7f3f7b3e48,0x3f753e95bec43f6d,0xbf7fbdc93e48bf7b
.quad 0xbf55bf0e3f35bf35,0x3f7b3e48bec43f6d,0xbf0e3f55bf35bf35,0x3e48bf7b3f6d3ec4,0x3f46bf223ec43f6d,0xbe953f75bf55bf0e,0xbf22bf463f6dbec4,0x3f753e95bf0e3f55
.quad 0x3ec43f6dbf80270d,0xbf6dbec43f35bf35,0x3f6dbec4270d3f80,0xbec43f6dbf35bf35,0xbf7f3dc93ec4bf6d,0x3ef1bf623f0e3f55,0x3dc93f7fbf6dbec4,0xbf62bef13f55bf0e
.quad 0x3e48bf7b3f353f35,0x3f553f0ebf6d3ec4,0xbf7bbe483f35bf35,0x3f0ebf553ec43f6d,0x3f623ef1bf6d3ec4,0xbf223f46be48bf7b,0x3ef1bf623ec43f6d,0x3f463f22bf7b3e48
.quad 0xbf353f35260dbf80,0xbf35bf353f802730,0x3f353f35bf80a60d,0xbf353f352730bf80,0xbef1bf623f6d3ec4,0x3f46bf22be483f7b,0xbf623ef13ec4bf6d,0xbf22bf463f7b3e48
.quad 0x3f7bbe48bf353f35,0x3f0e3f55bf6dbec4,0xbe48bf7b3f353f35,0x3f55bf0ebec43f6d,0xbdc93f7fbec4bf6d,0xbf623ef13f0ebf55,0x3f7f3dc9bf6d3ec4,0x3ef13f62bf55bf0e
.quad 0xbf6dbec43f802754,0xbec4bf6d3f353f35,0xbec43f6d2754bf80,0xbf6d3ec43f35bf35,0x3f22bf46bec43f6d,0x3f75be95bf553f0e,0xbf46bf223f6d3ec4,0xbe95bf753f0e3f55
.quad 0x3f0e3f55bf35bf35,0x3e483f7bbec4bf6d,0x3f55bf0ebf353f35,0x3f7bbe48bf6d3ec4,0xbf753e953f6dbec4,0xbf7f3dc93f7bbe48,0x3e953f75bec4bf6d,0x3dc93f7fbe48bf7b
.quad 0x3f802816a7543f80,0xbf80a7b1a60ebf80,0x2816bf803f802754,0xa7b13f80bf80260e,0x3dc93f7fbf802828,0xbe95bf753f7bbe48,0x3f7fbdc928283f80,0xbf753e95be48bf7b
.quad 0xbf7b3e4827f7bf80,0x3f55bf0e3ec43f6d,0x3e483f7bbf80a7f7,0xbf0ebf553f6dbec4,0xbe95bf753f80281f,0x3f463f22bf553f0e,0xbf753e95281fbf80,0x3f22bf463f0e3f55
.quad 0x3f6dbec4a8423f80,0xbec43f6dbf35bf35,0xbec4bf6d3f802842,0x3f6d3ec4bf353f35,0x3ef13f62bf8026d4,0xbf7fbdc93f0ebf55,0x3f62bef126d43f80,0xbdc93f7fbf55bf0e
.quad 0xbf553f0e2884bf80,0xbe48bf7b3f6d3ec4,0x3f0e3f55bf80a884,0xbf7b3e483ec4bf6d,0xbf22bf463f802730,0x3f62bef1be483f7b,0xbf463f222730bf80,0xbef1bf623f7b3e48
.quad 0x3f35bf35a79f3f80,0x3f353f35bf80a7e5,0xbf35bf353f80279f,0x3f35bf35a7e53f80,0x3f463f22bf80a7e5,0xbef13f62be48bf7b,0x3f22bf46a7e53f80,0x3f623ef1bf7b3e48
.quad 0xbf0e3f55a7d4bf80,0xbf7bbe483f6dbec4,0x3f553f0ebf8027d4,0xbe483f7bbec4bf6d,0xbf62bef13f802839,0xbdc9bf7f3f0e3f55,0xbef13f622839bf80,0xbf7f3dc93f55bf0e
.quad 0x3ec4bf6d270d3f80,0x3f6dbec4bf353f35,0xbf6dbec43f80a70d,0xbec4bf6d3f353f35,0x3f753e95bf80a880,0x3f223f46bf55bf0e,0x3e95bf75a8803f80,0x3f46bf22bf0e3f55
.quad 0xbe483f7b2909bf80,0xbf0e3f553ec4bf6d,0x3f7b3e48bf80a909,0x3f553f0ebf6dbec4,0xbf7fbdc93f8028a3,0xbf75be953f7b3e48,0xbdc93f7f28a3bf80,0xbe953f753e48bf7b
.quad 0x3f8026d4278d3f80,0xbf80270d27f7bf80,0x26d4bf803f80a78d,0x270d3f80bf80a7f7,0x3ef13f62bf6d3ec4,0xbf22bf463f55bf0e,0x3f62bef13ec43f6d,0xbf463f22bf0ebf55
.quad 0xbf0e3f55bf35bf35,0x3e48bf7b3f6d3ec4,0x3f553f0ebf353f35,0xbf7bbe483ec4bf6d,0xbf7fbdc93ec4bf6d,0x3f62bef13e483f7b,0xbdc93f7fbf6dbec4,0xbef1bf623f7bbe48
.quad 0xbec4bf6d3f802828,0x3f6d3ec4bf353f35,0xbf6d3ec42828bf80,0x3ec4bf6d3f353f35,0x3f22bf463ec43f6d,0x3e953f75bf7bbe48,0xbf46bf223f6dbec4,0x3f75be95be483f7b
.quad 0x3f7b3e48bf353f35,0xbf0e3f55bec4bf6d,0x3e48bf7b3f353f35,0x3f553f0ebf6d3ec4,0x3e953f75bf6dbec4,0xbf7f3dc93f0ebf55,0x3f75be95bec43f6d,0x3dc93f7fbf55bf0e
.quad 0xbf353f352816bf80,0xbf35bf353f802839,0x3f353f35bf80a816,0xbf353f352839bf80,0xbf75be953f6dbec4,0x3dc9bf7f3f0e3f55,0xbe953f75bec4bf6d,0xbf7fbdc93f55bf0e
.quad 0xbe48bf7b3f353f35,0x3f55bf0ebec43f6d,0xbf7b3e483f35bf35,0xbf0ebf553f6d3ec4,0x3f46bf22bec43f6d,0x3f753e95bf7b3e48,0xbf22bf463f6d3ec4,0x3e95bf753e483f7b
.quad 0x3f6d3ec4bf80a804,0x3ec43f6dbf35bf35,0x3ec4bf6da8043f80,0x3f6dbec4bf353f35,0x3dc93f7fbec4bf6d,0xbef13f623e48bf7b,0x3f7fbdc9bf6d3ec4,0x3f623ef1bf7bbe48
.quad 0xbf553f0e3f35bf35,0xbf7b3e483f6dbec4,0x3f0e3f55bf35bf35,0x3e483f7bbec4bf6d,0xbf62bef13f6d3ec4,0xbf46bf223f553f0e,0xbef13f623ec4bf6d,0xbf223f463f0ebf55
.quad 0x3f80281fa7773f80,0xbf80a7c2a1b7bf80,0x281fbf803f802777,0xa7c23f80bf8021b7,0x3f463f22bf353f35,0xbf62bef13f0ebf55,0x3f22bf463f353f35,0xbef13f62bf55bf0e
.quad 0x3e483f7bbf8026d4,0xbf0ebf553f6dbec4,0x3f7bbe4826d43f80,0xbf553f0ebec4bf6d,0xbef13f62bf35bf35,0xbdc9bf7f3f7b3e48,0x3f623ef1bf353f35,0xbf7f3dc93e48bf7b
.quad 0xbf6d3ec4280dbf80,0x3ec4bf6d3f353f35,0x3ec43f6dbf80a80d,0xbf6dbec43f35bf35,0xbf75be953f35bf35,0x3f46bf223e483f7b,0xbe953f75bf35bf35,0xbf22bf463f7bbe48
.quad 0xbf0ebf553f80289a,0x3f7bbe48bec43f6d,0xbf553f0e289abf80,0xbe48bf7b3f6d3ec4,0x3dc9bf7f3f353f35,0x3f753e95bf553f0e,0xbf7fbdc93f35bf35,0x3e95bf753f0e3f55
.quad 0x3f35bf35270d3f80,0x3f353f35bf80a880,0xbf35bf353f80a70d,0x3f35bf35a8803f80,0x3f7fbdc9bf353f35,0x3e953f75bf55bf0e,0xbdc9bf7f3f353f35,0x3f75be95bf0e3f55
.quad 0x3f553f0ebf8028be,0xbe483f7bbec4bf6d,0x3f0ebf5528be3f80,0x3f7b3e48bf6d3ec4,0x3e953f75bf35bf35,0xbf223f463e48bf7b,0x3f75be95bf353f35,0x3f463f22bf7bbe48
.quad 0xbec43f6d2896bf80,0xbf6d3ec43f35bf35,0x3f6d3ec4bf80a896,0x3ec43f6dbf35bf35,0xbf623ef13f35bf35,0xbf7fbdc93f7bbe48,0x3ef13f62bf35bf35,0xbdc93f7fbe48bf7b
.quad 0xbf7bbe483f8028ea,0xbf55bf0e3f6d3ec4,0xbe483f7b28eabf80,0xbf0e3f553ec4bf6d,0xbf22bf463f353f35,0xbef1bf623f0e3f55,0xbf463f223f35bf35,0xbf623ef13f55bf0e
.quad 0x3f80270da8423f80,0xbf8026d42804bf80,0x270dbf803f802842,0x26d43f80bf80a804,0x3f753e95bec43f6d,0xbf7fbdc93e48bf7b,0x3e95bf753f6d3ec4,0xbdc93f7fbf7bbe48
.quad 0x3f553f0ebf353f35,0xbf7bbe483ec4bf6d,0x3f0ebf553f353f35,0xbe483f7bbf6dbec4,0x3f223f46bf6d3ec4,0xbf75be953f0ebf55,0x3f46bf223ec43f6d,0xbe953f75bf55bf0e
.quad 0x3ec43f6dbf80a7e5,0xbf6dbec43f35bf35,0x3f6dbec4a7e53f80,0xbec43f6dbf35bf35,0x3dc93f7fbf6dbec4,0xbf62bef13f55bf0e,0x3f7fbdc9bec43f6d,0xbef13f62bf0ebf55
.quad 0xbe483f7bbf35bf35,0xbf55bf0e3f6dbec4,0x3f7b3e48bf353f35,0xbf0e3f55bec4bf6d,0xbef13f62bec4bf6d,0xbf46bf223f7bbe48,0x3f623ef1bf6d3ec4,0xbf223f46be48bf7b
.quad 0xbf353f35270dbf80,0xbf35bf353f8028a3,0x3f353f35bf80a70d,0xbf353f3528a3bf80,0xbf623ef13ec4bf6d,0xbf22bf463f7b3e48,0x3ef13f62bf6dbec4,0xbf463f223e48bf7b
.quad 0xbf7b3e483f35bf35,0xbf0ebf553f6d3ec4,0x3e483f7bbf35bf35,0xbf553f0e3ec4bf6d,0xbf7fbdc93f6dbec4,0xbef1bf623f553f0e,0xbdc93f7fbec4bf6d,0xbf623ef13f0ebf55
.quad 0xbf6dbec43f80a731,0xbec4bf6d3f353f35,0xbec43f6da731bf80,0xbf6d3ec43f35bf35,0xbf46bf223f6d3ec4,0xbe95bf753f0e3f55,0xbf223f463ec4bf6d,0xbf753e953f55bf0e
.quad 0xbf0ebf553f353f35,0xbe48bf7b3ec43f6d,0xbf553f0e3f35bf35,0xbf7b3e483f6dbec4,0xbe95bf753ec43f6d,0xbdc9bf7f3e483f7b,0xbf753e953f6dbec4,0xbf7f3dc93f7bbe48
.quad 0x250dbf8000003f80,0x25d4bf80a58d3f80,0xbf80a50d3f808000,0xbf80a5d43f80258d,0xbdc9bf7f00003f80,0xbe95bf753e483f7b,0xbf7f3dc93f808000,0xbf753e953f7bbe48
.quad 0xbe48bf7b00003f80,0xbf0ebf553ec43f6d,0xbf7b3e483f808000,0xbf553f0e3f6dbec4,0xbe95bf7500003f80,0xbf46bf223f0e3f55,0xbf753e953f808000,0xbf223f463f55bf0e
.quad 0xbec4bf6d00003f80,0xbf6dbec43f353f35,0xbf6d3ec43f808000,0xbec43f6d3f35bf35,0xbef1bf6200003f80,0xbf7fbdc93f553f0e,0xbf623ef13f808000,0xbdc93f7f3f0ebf55
.quad 0xbf0ebf5500003f80,0xbf7b3e483f6d3ec4,0xbf553f0e3f808000,0x3e483f7b3ec4bf6d,0xbf22bf4600003f80,0xbf623ef13f7b3e48,0xbf463f223f808000,0x3ef13f623e48bf7b
.quad 0xbf35bf3500003f80,0xbf353f353f8025b0,0xbf353f353f808000,0x3f353f3525b0bf80,0xbf46bf2200003f80,0xbef13f623f7bbe48,0xbf223f463f808000,0x3f623ef1be48bf7b
.quad 0xbf55bf0e00003f80,0xbe483f7b3f6dbec4,0xbf0e3f553f808000,0x3f7b3e48bec4bf6d,0xbf62bef100003f80,0x3dc93f7f3f55bf0e,0xbef13f623f808000,0x3f7fbdc9bf0ebf55
.quad 0xbf6dbec400003f80,0x3ec43f6d3f35bf35,0xbec43f6d3f808000,0x3f6dbec4bf35bf35,0xbf75be9500003f80,0x3f223f463f0ebf55,0xbe953f753f808000,0x3f46bf22bf55bf0e
.quad 0xbf7bbe4800003f80,0x3f553f0e3ec4bf6d,0xbe483f7b3f808000,0x3f0ebf55bf6dbec4,0xbf7fbdc900003f80,0x3f753e953e48bf7b,0xbdc93f7f3f808000,0x3e95bf75bf7bbe48
.quad 0x2630bf80a60d3f80,0x2677bf80a6543f80,0xbf80a6303f80260d,0xbf80a6773f802654,0xbef1bf623ec43f6d,0xbf22bf463f0e3f55,0xbf623ef13f6dbec4,0xbf463f223f55bf0e
.quad 0xbf55bf0e3f353f35,0xbf7bbe483f6d3ec4,0xbf0e3f553f35bf35,0xbe483f7b3ec4bf6d,0xbf7fbdc93f6d3ec4,0xbf623ef13f7bbe48,0xbdc93f7f3ec4bf6d,0x3ef13f62be48bf7b
.quad 0xbf6d3ec43f80261f,0xbec43f6d3f35bf35,0x3ec43f6d261fbf80,0x3f6d3ec4bf35bf35,0xbf223f463f6dbec4,0x3e953f753e48bf7b,0x3f463f22bec4bf6d,0x3f75be95bf7bbe48
.quad 0xbe483f7b3f35bf35,0x3f553f0ebec4bf6d,0x3f7b3e48bf35bf35,0x3f0ebf55bf6d3ec4,0x3e953f753ec4bf6d,0x3f7fbdc9bf55bf0e,0x3f75be95bf6dbec4,0xbdc9bf7fbf0e3f55
.quad 0x3f353f352630bf80,0x3f35bf35bf80a742,0x3f35bf35bf80a630,0xbf35bf35a7423f80,0x3f753e95bec4bf6d,0x3dc9bf7fbf553f0e,0x3e95bf75bf6d3ec4,0xbf7fbdc93f0e3f55
.quad 0x3f7bbe48bf35bf35,0xbf0ebf55bec43f6d,0xbe48bf7bbf353f35,0xbf553f0e3f6d3ec4,0x3f46bf22bf6dbec4,0xbf75be953e483f7b,0xbf22bf46bec43f6d,0xbe953f753f7bbe48
.quad 0x3ec4bf6dbf80a731,0xbf6d3ec43f353f35,0xbf6dbec4a7313f80,0x3ec43f6d3f35bf35,0xbdc9bf7fbf6d3ec4,0xbef13f623f7b3e48,0xbf7f3dc93ec43f6d,0x3f623ef13e48bf7b
.quad 0xbf0ebf55bf353f35,0x3e483f7b3f6dbec4,0xbf553f0e3f353f35,0x3f7bbe48bec4bf6d,0xbf62bef1bec43f6d,0x3f463f223f0ebf55,0xbef13f623f6d3ec4,0x3f22bf46bf55bf0e
.quad 0x269fbf80a68d3f80,0x27b1bf80a6b03f80,0xbf80a69f3f80268d,0xbf80a7b13f8026b0,0xbf46bf223f353f35,0xbf62bef13f553f0e,0xbf223f463f35bf35,0xbef13f623f0ebf55
.quad 0xbf7b3e483f80a654,0xbf553f0e3f6dbec4,0x3e483f7ba654bf80,0x3f0e3f55bec4bf6d,0xbef13f623f35bf35,0x3dc93f7f3e48bf7b,0x3f623ef1bf35bf35,0x3f7fbdc9bf7bbe48
.quad 0x3ec43f6d269fbf80,0x3f6d3ec4bf35bf35,0x3f6dbec4bf80a69f,0x3ec4bf6dbf353f35,0x3f753e95bf35bf35,0x3f46bf22bf7b3e48,0x3e95bf75bf353f35,0xbf22bf463e483f7b
.quad 0x3f55bf0ebf80a754,0xbe48bf7bbec43f6d,0xbf0ebf55a7543f80,0xbf7b3e483f6d3ec4,0x3dc9bf7fbf353f35,0xbf75be953f0e3f55,0xbf7fbdc93f353f35,0xbe953f753f55bf0e
.quad 0xbf35bf35a6b03f80,0xbf353f353f80a58e,0xbf353f353f8026b0,0x3f353f35a58ebf80,0xbf7f3dc93f353f35,0x3e953f753f0ebf55,0x3dc93f7f3f35bf35,0x3f75be95bf55bf0e
.quad 0xbf0e3f553f80a60d,0x3f7b3e48bec4bf6d,0x3f553f0ea60dbf80,0x3e48bf7bbf6d3ec4,0x3e953f753f35bf35,0x3f22bf46bf7bbe48,0x3f75be95bf35bf35,0xbf46bf22be483f7b
.quad 0x3f6d3ec427b1bf80,0xbec4bf6dbf353f35,0x3ec4bf6dbf80a7b1,0xbf6d3ec43f353f35,0x3f62bef1bf35bf35,0xbf7fbdc93e483f7b,0xbef1bf62bf353f35,0xbdc93f7f3f7bbe48
.quad 0x3e48bf7bbf80a765,0xbf0e3f553f6d3ec4,0xbf7bbe48a7653f80,0x3f553f0e3ec4bf6d,0xbf22bf46bf353f35,0x3ef13f623f55bf0e,0xbf463f223f353f35,0x3f62bef1bf0ebf55
.quad 0xa70dbf80a6d43f80,0x27c2bf80a6f73f80,0xbf80270d3f8026d4,0xbf80a7c23f8026f7,0xbf75be953f6d3ec4,0xbf7fbdc93f7b3e48,0xbe953f753ec4bf6d,0xbdc93f7f3e48bf7b
.quad 0xbf0e3f553f35bf35,0xbe483f7b3ec4bf6d,0x3f553f0ebf35bf35,0x3f7b3e48bf6dbec4,0x3f223f46bec4bf6d,0x3f753e95bf55bf0e,0x3f46bf22bf6d3ec4,0x3e95bf75bf0e3f55
.quad 0x3f6dbec4bf80a777,0x3ec4bf6dbf353f35,0xbec4bf6da7773f80,0xbf6dbec43f353f35,0xbdc9bf7fbec43f6d,0xbf62bef13f0e3f55,0xbf7f3dc93f6d3ec4,0xbef13f623f55bf0e
.quad 0xbf7bbe483f353f35,0xbf0e3f553f6dbec4,0xbe483f7b3f35bf35,0x3f553f0ebec4bf6d,0xbef13f623f6dbec4,0x3f463f22be48bf7b,0x3f623ef1bec4bf6d,0x3f22bf46bf7b3e48
.quad 0x3f353f3527c2bf80,0x3f35bf35bf80a78d,0x3f35bf35bf80a7c2,0xbf35bf35a78d3f80,0x3f62bef1bf6dbec4,0xbf22bf46be483f7b,0xbef1bf62bec43f6d,0xbf463f223f7b3e48
.quad 0xbe48bf7bbf353f35,0xbf553f0e3f6d3ec4,0xbf7b3e483f353f35,0x3f0e3f553ec4bf6d,0xbf7fbdc93ec43f6d,0x3ef13f623f0ebf55,0xbdc93f7f3f6dbec4,0x3f62bef1bf55bf0e
.quad 0xbec43f6d3f802804,0x3f6dbec4bf35bf35,0x3f6d3ec42804bf80,0xbec4bf6dbf353f35,0x3f463f223ec4bf6d,0xbe95bf75bf553f0e,0x3f22bf46bf6dbec4,0xbf753e953f0e3f55
.quad 0x3f55bf0ebf35bf35,0xbf7b3e483ec43f6d,0xbf0ebf55bf353f35,0x3e483f7b3f6dbec4,0xbe95bf75bf6d3ec4,0x3dc93f7f3f7bbe48,0xbf753e953ec43f6d,0x3f7fbdc9be48bf7b
.quad 0xa6d4bf80a70d3f80,0x27d4bf80a71f3f80,0xbf8026d43f80270d,0xbf80a7d43f80271f,0xbf7f3dc93f80258d,0xbf753e953f7bbe48,0x3dc93f7f258dbf80,0x3e953f75be48bf7b
.quad 0x3e483f7ba6d4bf80,0x3f0e3f55bec4bf6d,0x3f7bbe48bf8026d4,0x3f55bf0ebf6d3ec4,0x3f75be95bf80a78d,0x3f22bf46bf553f0e,0xbe95bf75a78d3f80,0xbf46bf223f0e3f55
.quad 0xbec4bf6da71f3f80,0xbf6dbec43f353f35,0xbf6d3ec43f80271f,0xbec43f6d3f35bf35,0xbf623ef13f80260d,0xbdc93f7f3f0ebf55,0x3ef13f62260dbf80,0x3f7f3dc9bf55bf0e
.quad 0x3f0e3f5527d4bf80,0x3f7bbe48bf6dbec4,0x3f55bf0ebf80a7d4,0xbe48bf7bbec43f6d,0x3f46bf22bf80a796,0xbef1bf62be483f7b,0xbf22bf46a7963f80,0xbf623ef13f7b3e48
.quad 0xbf35bf35a7303f80,0xbf353f353f80268d,0xbf353f353f802730,0x3f353f35268dbf80,0xbf223f463f80280d,0x3f623ef1be48bf7b,0x3f463f22280dbf80,0x3ef1bf62bf7b3e48
.quad 0x3f553f0ea68dbf80,0x3e48bf7bbf6d3ec4,0x3f0ebf55bf80268d,0xbf7bbe483ec43f6d,0x3ef1bf62bf80a79f,0xbf7f3dc93f0e3f55,0xbf62bef1a79f3f80,0x3dc93f7f3f55bf0e
.quad 0xbf6dbec4a8313f80,0x3ec43f6d3f35bf35,0xbec43f6d3f802831,0x3f6dbec4bf35bf35,0xbe953f753f80268d,0x3f46bf22bf55bf0e,0x3f753e95268dbf80,0xbf22bf46bf0e3f55
.quad 0x3f7b3e4827e5bf80,0xbf55bf0ebec43f6d,0x3e48bf7bbf80a7e5,0xbf0e3f553f6d3ec4,0x3dc9bf7fbf802731,0xbe953f753f7b3e48,0xbf7fbdc927313f80,0x3f753e953e48bf7b
.quad 0xa68dbf80a7303f80,0x27e5bf80a8313f80,0xbf80268d3f802730,0xbf80a7e53f802831,0xbf623ef13f6dbec4,0xbf463f223f55bf0e,0x3ef13f62bec4bf6d,0x3f223f46bf0ebf55
.quad 0x3f553f0ebf35bf35,0x3f7b3e48bf6dbec4,0x3f0ebf55bf353f35,0x3e48bf7bbec43f6d,0x3dc9bf7fbec43f6d,0xbef1bf623e483f7b,0xbf7fbdc93f6d3ec4,0xbf623ef13f7bbe48
.quad 0xbf6d3ec43f80268d,0xbec43f6d3f35bf35,0x3ec43f6d268dbf80,0x3f6d3ec4bf35bf35,0x3f463f22bec4bf6d,0x3f75be95bf7bbe48,0x3f22bf46bf6d3ec4,0xbe95bf75be483f7b
.quad 0x3e48bf7bbf353f35,0xbf55bf0e3ec43f6d,0xbf7bbe483f353f35,0xbf0e3f553f6dbec4,0xbf753e953f6d3ec4,0x3dc93f7f3f0ebf55,0x3e953f753ec4bf6d,0x3f7fbdc9bf55bf0e
.quad 0x3f353f35a60ebf80,0x3f35bf35bf80270d,0x3f35bf35bf80260e,0xbf35bf35270d3f80,0x3e95bf75bf6d3ec4,0xbf7fbdc93f0e3f55,0xbf75be953ec43f6d,0xbdc93f7f3f55bf0e
.quad 0xbf7b3e483f353f35,0x3f0e3f553ec4bf6d,0x3e483f7b3f35bf35,0x3f55bf0ebf6dbec4,0x3f223f463ec4bf6d,0x3e95bf75bf7b3e48,0x3f46bf22bf6dbec4,0xbf75be953e483f7b
.quad 0x3ec4bf6dbf80a85d,0xbf6d3ec43f353f35,0xbf6dbec4a85d3f80,0x3ec43f6d3f35bf35,0xbf7f3dc93ec43f6d,0x3f623ef13e48bf7b,0x3dc93f7f3f6dbec4,0x3ef1bf62bf7bbe48
.quad 0x3f0e3f553f35bf35,0xbe48bf7bbf6d3ec4,0x3f55bf0ebf35bf35,0xbf7b3e483ec43f6d,0x3ef1bf62bf6dbec4,0xbf223f463f553f0e,0xbf62bef1bec43f6d,0x3f463f223f0ebf55
.quad 0xa60ebf80a7543f80,0x27f7bf80278d3f80,0xbf80260e3f802754,0xbf80a7f73f80a78d,0xbf223f463f35bf35,0xbef13f623f0ebf55,0x3f463f22bf35bf35,0x3f623ef1bf55bf0e
.quad 0x3f7bbe48bf802828,0x3f55bf0ebf6d3ec4,0xbe48bf7b28283f80,0xbf0ebf553ec43f6d,0xbf62bef13f353f35,0xbf7f3dc93f7b3e48,0xbef13f623f35bf35,0x3dc93f7f3e48bf7b
.quad 0x3ec43f6d27f7bf80,0x3f6d3ec4bf35bf35,0x3f6dbec4bf80a7f7,0x3ec4bf6dbf353f35,0x3e95bf75bf353f35,0xbf22bf463e483f7b,0xbf75be953f353f35,0xbf463f223f7bbe48
.quad 0xbf553f0e3f80281f,0x3e483f7b3ec4bf6d,0x3f0e3f55281fbf80,0x3f7bbe48bf6dbec4,0x3f7f3dc9bf35bf35,0x3e95bf75bf553f0e,0x3dc9bf7fbf353f35,0xbf75be953f0e3f55
.quad 0xbf35bf35a8423f80,0xbf353f353f802828,0xbf353f353f802842,0x3f353f352828bf80,0x3dc93f7f3f35bf35,0x3f75be95bf55bf0e,0x3f7fbdc9bf35bf35,0xbe95bf75bf0e3f55
.quad 0x3f0ebf55bf8026d4,0xbf7bbe483ec43f6d,0xbf55bf0e26d43f80,0xbe483f7b3f6dbec4,0xbf753e953f353f35,0x3f463f223e48bf7b,0x3e953f753f35bf35,0x3f22bf46bf7bbe48
.quad 0x3f6d3ec42884bf80,0xbec4bf6dbf353f35,0x3ec4bf6dbf80a884,0xbf6d3ec43f353f35,0xbef1bf62bf353f35,0xbdc93f7f3f7bbe48,0xbf623ef13f353f35,0x3f7f3dc9be48bf7b
.quad 0xbe483f7b3f802730,0x3f0ebf55bf6dbec4,0x3f7b3e482730bf80,0xbf55bf0ebec43f6d,0x3f46bf22bf35bf35,0xbf623ef13f0e3f55,0xbf22bf46bf353f35,0x3ef13f623f55bf0e
.quad 0xa1b7bf80a7773f80,0x2804bf80a8423f80,0xbf8021b73f802777,0xbf80a8043f802842,0xbe953f753ec4bf6d,0xbdc93f7f3e48bf7b,0x3f753e95bf6dbec4,0x3f7f3dc9bf7bbe48
.quad 0x3f0ebf55bf353f35,0x3e48bf7bbec43f6d,0xbf55bf0e3f353f35,0xbf7bbe483f6d3ec4,0xbf463f223f6dbec4,0xbe953f753f0ebf55,0x3f223f46bec4bf6d,0x3f753e95bf55bf0e
.quad 0x3f6dbec4bf8026d4,0x3ec4bf6dbf353f35,0xbec4bf6d26d43f80,0xbf6dbec43f353f35,0xbf7f3dc93f6d3ec4,0xbef13f623f55bf0e,0x3dc93f7f3ec4bf6d,0x3f623ef1bf0ebf55
.quad 0x3f7b3e48bf35bf35,0x3f0ebf55bf6d3ec4,0x3e48bf7bbf353f35,0xbf55bf0e3ec43f6d,0xbf62bef13ec43f6d,0xbf223f463f7bbe48,0xbef13f623f6dbec4,0x3f463f22be48bf7b
.quad 0x3f353f35280dbf80,0x3f35bf35bf80a7e5,0x3f35bf35bf80a80d,0xbf35bf35a7e53f80,0xbef1bf62bec43f6d,0xbf463f223f7b3e48,0xbf623ef13f6d3ec4,0x3f223f463e48bf7b
.quad 0x3e483f7b3f35bf35,0x3f55bf0ebf6dbec4,0x3f7bbe48bf35bf35,0xbf0ebf55bec43f6d,0x3dc9bf7fbf6d3ec4,0xbf623ef13f553f0e,0xbf7fbdc93ec43f6d,0x3ef13f623f0ebf55
.quad 0xbec43f6d3f80289a,0x3f6dbec4bf35bf35,0x3f6d3ec4289abf80,0xbec4bf6dbf353f35,0x3f22bf46bf6dbec4,0xbf753e953f0e3f55,0xbf46bf22bec43f6d,0x3e953f753f55bf0e
.quad 0xbf553f0e3f353f35,0x3f7bbe48bec4bf6d,0x3f0e3f553f35bf35,0xbe48bf7bbf6d3ec4,0x3f75be95bec4bf6d,0xbf7f3dc93e483f7b,0xbe95bf75bf6d3ec4,0x3dc93f7f3f7bbe48
.quad 0x260dbf80a78d3f80,0x280dbf8027543f80,0xbf80a60d3f80278d,0xbf80a80d3f80a754,0x3dc93f7f260dbf80,0x3e953f75be48bf7b,0x3f7fbdc9bf80a60d,0x3f75be95bf7b3e48
.quad 0xbe48bf7b27543f80,0xbf0ebf553ec43f6d,0xbf7b3e483f80a754,0xbf553f0e3f6dbec4,0x3e953f75280dbf80,0x3f463f22bf0ebf55,0x3f75be95bf80a80d,0x3f22bf46bf553f0e
.quad 0xbec4bf6da79f3f80,0xbf6dbec43f353f35,0xbf6d3ec43f80279f,0xbec43f6d3f35bf35,0x3ef13f62268dbf80,0x3f7f3dc9bf55bf0e,0x3f62bef1bf80a68d,0x3dc9bf7fbf0e3f55
.quad 0xbf0ebf55a8543f80,0xbf7b3e483f6d3ec4,0xbf553f0e3f802854,0x3e483f7b3ec4bf6d,0x3f223f462816bf80,0x3f62bef1bf7bbe48,0x3f46bf22bf80a816,0xbef1bf62be483f7b
.quad 0xbf35bf35a7b03f80,0xbf353f353f802777,0xbf353f353f8027b0,0x3f353f352777bf80,0x3f463f22288dbf80,0x3ef1bf62bf7b3e48,0x3f22bf46bf80a88d,0xbf62bef13e483f7b
.quad 0xbf55bf0e270d3f80,0xbe483f7b3f6dbec4,0xbf0e3f553f80a70d,0x3f7b3e48bec4bf6d,0x3f623ef1281fbf80,0xbdc9bf7fbf553f0e,0x3ef1bf62bf80a81f,0xbf7f3dc93f0e3f55
.quad 0xbf6dbec4a8b13f80,0x3ec43f6d3f35bf35,0xbec43f6d3f8028b1,0x3f6dbec4bf35bf35,0x3f753e95270dbf80,0xbf22bf46bf0e3f55,0x3e95bf75bf80a70d,0xbf463f223f553f0e
.quad 0xbf7bbe48a8653f80,0x3f553f0e3ec4bf6d,0xbe483f7b3f802865,0x3f0ebf55bf6dbec4,0x3f7f3dc9a7b1bf80,0xbf75be95be483f7b,0x3dc9bf7fbf8027b1,0xbe953f753f7b3e48
.quad 0x268dbf80a79f3f80,0x2816bf80a8543f80,0xbf80a68d3f80279f,0xbf80a8163f802854,0x3ef13f62bec4bf6d,0x3f223f46bf0ebf55,0x3f62bef1bf6d3ec4,0x3f46bf22bf553f0e
.quad 0xbf55bf0e3f353f35,0xbf7bbe483f6d3ec4,0xbf0e3f553f35bf35,0xbe483f7b3ec4bf6d,0x3f7f3dc9bf6dbec4,0x3f62bef1bf7b3e48,0x3dc9bf7fbec43f6d,0xbef1bf623e483f7b
.quad 0xbf6d3ec43f802839,0xbec43f6d3f35bf35,0x3ec43f6d2839bf80,0x3f6d3ec4bf35bf35,0x3f22bf46bf6d3ec4,0xbe95bf75be483f7b,0xbf46bf223ec43f6d,0xbf753e953f7b3e48
.quad 0xbe483f7b3f35bf35,0x3f553f0ebec4bf6d,0x3f7b3e48bf35bf35,0x3f0ebf55bf6d3ec4,0xbe95bf75bec43f6d,0xbf7f3dc93f553f0e,0xbf753e953f6d3ec4,0x3dc93f7f3f0ebf55
.quad 0x3f353f35270dbf80,0x3f35bf35bf80a60d,0x3f35bf35bf80a70d,0xbf35bf35a60d3f80,0xbf75be953ec43f6d,0xbdc93f7f3f55bf0e,0xbe953f753f6dbec4,0x3f7f3dc9bf0ebf55
.quad 0x3f7bbe48bf35bf35,0xbf0ebf55bec43f6d,0xbe48bf7bbf353f35,0xbf553f0e3f6d3ec4,0xbf463f223f6d3ec4,0x3f753e95be48bf7b,0x3f223f463ec4bf6d,0x3e95bf75bf7b3e48
.quad 0x3ec4bf6dbf80a8c7,0xbf6d3ec43f353f35,0xbf6dbec4a8c73f80,0x3ec43f6d3f35bf35,0x3dc93f7f3f6dbec4,0x3ef1bf62bf7bbe48,0x3f7fbdc9bec4bf6d,0xbf62bef1be483f7b
.quad 0xbf0ebf55bf353f35,0x3e483f7b3f6dbec4,0xbf553f0e3f353f35,0x3f7bbe48bec4bf6d,0x3f623ef13ec4bf6d,0xbf46bf22bf0e3f55,0x3ef1bf62bf6dbec4,0xbf223f463f553f0e
.quad 0x288dbf80a7b03f80,0x281fbf80270d3f80,0xbf80a88d3f8027b0,0xbf80a81f3f80a70d,0x3f463f22bf35bf35,0x3f623ef1bf55bf0e,0x3f22bf46bf353f35,0x3ef1bf62bf0e3f55
.quad 0xbf7b3e483f802777,0xbf553f0e3f6dbec4,0x3e483f7b2777bf80,0x3f0e3f55bec4bf6d,0x3ef1bf62bf353f35,0xbdc9bf7fbe483f7b,0xbf62bef13f353f35,0xbf7f3dc93f7b3e48
.quad 0x3ec43f6d270dbf80,0x3f6d3ec4bf35bf35,0x3f6dbec4bf80a70d,0x3ec4bf6dbf353f35,0xbf75be953f353f35,0xbf463f223f7bbe48,0xbe953f753f35bf35,0x3f223f46be48bf7b
.quad 0x3f55bf0ebf80a60d,0xbe48bf7bbec43f6d,0xbf0ebf55a60d3f80,0xbf7b3e483f6d3ec4,0xbdc93f7f3f35bf35,0x3f753e95bf0ebf55,0x3f7f3dc9bf35bf35,0x3e95bf75bf553f0e
.quad 0xbf35bf35268e3f80,0xbf353f353f80a731,0xbf353f353f80a68e,0x3f353f35a731bf80,0x3f7fbdc9bf35bf35,0xbe95bf75bf0e3f55,0xbdc9bf7fbf353f35,0xbf753e953f553f0e
.quad 0xbf0e3f553f80a731,0x3f7b3e48bec4bf6d,0x3f553f0ea731bf80,0x3e48bf7bbf6d3ec4,0xbe95bf75bf353f35,0xbf223f463f7b3e48,0xbf753e953f353f35,0x3f463f223e48bf7b
.quad 0x3f6d3ec428ddbf80,0xbec4bf6dbf353f35,0x3ec4bf6dbf80a8dd,0xbf6d3ec43f353f35,0xbf623ef13f353f35,0x3f7f3dc9be48bf7b,0x3ef13f623f35bf35,0x3dc9bf7fbf7b3e48
.quad 0x3e48bf7bbf80a8cf,0xbf0e3f553f6d3ec4,0xbf7bbe48a8cf3f80,0x3f553f0e3ec4bf6d,0x3f223f463f35bf35,0xbef1bf62bf553f0e,0x3f46bf22bf35bf35,0xbf623ef13f0e3f55
.quad 0x270dbf80a8b13f80,0xa7b1bf80a8653f80,0xbf80a70d3f8028b1,0xbf8027b13f802865,0x3f753e95bf6dbec4,0x3f7f3dc9bf7bbe48,0x3e95bf75bec43f6d,0x3dc9bf7fbe483f7b
.quad 0xbf0e3f553f35bf35,0xbe483f7b3ec4bf6d,0x3f553f0ebf35bf35,0x3f7b3e48bf6dbec4,0xbf22bf463ec43f6d,0xbf75be953f553f0e,0xbf463f223f6dbec4,0xbe953f753f0ebf55
.quad 0x3f6dbec4bf8027e6,0x3ec4bf6dbf353f35,0xbec4bf6d27e63f80,0xbf6dbec43f353f35,0x3dc93f7f3ec4bf6d,0x3f623ef1bf0ebf55,0x3f7fbdc9bf6dbec4,0x3ef1bf62bf553f0e
.quad 0xbf7bbe483f353f35,0xbf0e3f553f6dbec4,0xbe483f7b3f35bf35,0x3f553f0ebec4bf6d,0x3ef1bf62bf6d3ec4,0xbf46bf223e483f7b,0xbf62bef13ec43f6d,0xbf223f463f7bbe48
.quad 0x3f353f35a78dbf80,0x3f35bf35bf8027c2,0x3f35bf35bf80278d,0xbf35bf3527c23f80,0xbf623ef13f6d3ec4,0x3f223f463e48bf7b,0x3ef13f623ec4bf6d,0x3f46bf22bf7bbe48
.quad 0xbe48bf7bbf353f35,0xbf553f0e3f6d3ec4,0xbf7b3e483f353f35,0x3f0e3f553ec4bf6d,0x3f7f3dc9bec4bf6d,0xbef1bf62bf0e3f55,0x3dc9bf7fbf6d3ec4,0xbf623ef13f553f0e
.quad 0xbec43f6d3f8028f3,0x3f6dbec4bf35bf35,0x3f6d3ec428f3bf80,0xbec4bf6dbf353f35,0xbf46bf22bec43f6d,0x3e953f753f55bf0e,0xbf223f463f6d3ec4,0x3f75be95bf0ebf55
.quad 0x3f55bf0ebf35bf35,0xbf7b3e483ec43f6d,0xbf0ebf55bf353f35,0x3e483f7b3f6dbec4,0x3e953f753f6dbec4,0xbdc9bf7fbf7b3e48,0x3f75be95bec4bf6d,0xbf7f3dc93e483f7b
.quad 0x2896bf80a7d43f80,0x2831bf80268e3f80,0xbf80a8963f8027d4,0xbf80a8313f80a68e,0x3f7fbdc9bf8027e6,0x3f75be95bf7b3e48,0xbdc9bf7f27e63f80,0xbe95bf753e483f7b
.quad 0x3e483f7ba8a8bf80,0x3f0e3f55bec4bf6d,0x3f7bbe48bf8028a8,0x3f55bf0ebf6d3ec4,0xbf753e953f80a731,0xbf223f463f55bf0e,0x3e953f75a731bf80,0x3f463f22bf0ebf55
.quad 0xbec4bf6da8773f80,0xbf6dbec43f353f35,0xbf6d3ec43f802877,0xbec43f6d3f35bf35,0x3f62bef1bf80a6d4,0x3dc9bf7fbf0e3f55,0xbef1bf62a6d43f80,0xbf7fbdc93f553f0e
.quad 0x3f0e3f55289fbf80,0x3f7bbe48bf6dbec4,0x3f55bf0ebf80a89f,0xbe48bf7bbec43f6d,0xbf463f223f8027c2,0x3ef13f623e48bf7b,0x3f223f4627c2bf80,0x3f62bef1bf7bbe48
.quad 0xbf35bf35a8c23f80,0xbf353f353f8028b5,0xbf353f353f8028c2,0x3f353f3528b5bf80,0x3f22bf46bf80a92a,0xbf62bef13e483f7b,0xbf46bf22a92a3f80,0xbef13f623f7bbe48
.quad 0x3f553f0ea754bf80,0x3e48bf7bbf6d3ec4,0x3f0ebf55bf802754,0xbf7bbe483ec43f6d,0xbef13f623f80286e,0x3f7fbdc9bf0ebf55,0x3f623ef1286ebf80,0xbdc9bf7fbf553f0e
.quad 0xbf6dbec4a9043f80,0x3ec43f6d3f35bf35,0xbec43f6d3f802904,0x3f6dbec4bf35bf35,0x3e95bf75bf80284b,0xbf463f223f553f0e,0xbf75be95284b3f80,0x3f223f463f0ebf55
.quad 0x3f7b3e4827b0bf80,0xbf55bf0ebec43f6d,0x3e48bf7bbf80a7b0,0xbf0e3f553f6d3ec4,0xbdc93f7f3f80a804,0x3e95bf75bf7bbe48,0x3f7f3dc9a804bf80,0xbf75be95be483f7b
.quad 0x2754bf80280d3f80,0xa78dbf80a8773f80,0xbf80a7543f80a80d,0xbf80278d3f802877,0x3f62bef1bf6d3ec4,0x3f46bf22bf553f0e,0xbef1bf623ec43f6d,0xbf22bf463f0e3f55
.quad 0x3f553f0ebf35bf35,0x3f7b3e48bf6dbec4,0x3f0ebf55bf353f35,0x3e48bf7bbec43f6d,0xbdc93f7f3ec4bf6d,0x3ef13f62be48bf7b,0x3f7f3dc9bf6dbec4,0x3f62bef1bf7b3e48
.quad 0xbf6d3ec43f8027c2,0xbec43f6d3f35bf35,0x3ec43f6d27c2bf80,0x3f6d3ec4bf35bf35,0xbf46bf223ec43f6d,0xbf753e953f7b3e48,0xbf223f463f6dbec4,0x3e953f753e48bf7b
.quad 0x3e48bf7bbf353f35,0xbf55bf0e3ec43f6d,0xbf7bbe483f353f35,0xbf0e3f553f6dbec4,0x3f75be95bf6dbec4,0xbdc9bf7fbf0e3f55,0xbe95bf75bec43f6d,0xbf7f3dc93f553f0e
.quad 0x3f353f3528a8bf80,0x3f35bf35bf80a89a,0x3f35bf35bf80a8a8,0xbf35bf35a89a3f80,0xbe953f753f6dbec4,0x3f7f3dc9bf0ebf55,0x3f753e95bec4bf6d,0x3dc9bf7fbf553f0e
.quad 0xbf7b3e483f353f35,0x3f0e3f553ec4bf6d,0x3e483f7b3f35bf35,0x3f55bf0ebf6dbec4,0xbf22bf46bec43f6d,0xbe953f753f7bbe48,0xbf463f223f6d3ec4,0x3f753e95be48bf7b
.quad 0x3ec4bf6dbf80a90f,0xbf6d3ec43f353f35,0xbf6dbec4a90f3f80,0x3ec43f6d3f35bf35,0x3f7fbdc9bec4bf6d,0xbf62bef1be483f7b,0xbdc9bf7fbf6d3ec4,0xbef13f623f7b3e48
.quad 0x3f0e3f553f35bf35,0xbe48bf7bbf6d3ec4,0x3f55bf0ebf35bf35,0xbf7b3e483ec43f6d,0xbef13f623f6d3ec4,0x3f22bf46bf55bf0e,0x3f623ef13ec4bf6d,0xbf46bf22bf0e3f55
.quad 0x289fbf80a7f73f80,0x2842bf8022373f80,0xbf80a89f3f8027f7,0xbf80a8423f80a237,0x3f22bf46bf353f35,0x3ef1bf62bf0e3f55,0xbf46bf223f353f35,0xbf62bef13f553f0e
.quad 0x3f7bbe48bf80285d,0x3f55bf0ebf6d3ec4,0xbe48bf7b285d3f80,0xbf0ebf553ec43f6d,0x3f623ef1bf35bf35,0x3f7fbdc9bf7bbe48,0x3ef1bf62bf353f35,0xbdc9bf7fbe483f7b
.quad 0x3ec43f6da754bf80,0x3f6d3ec4bf35bf35,0x3f6dbec4bf802754,0x3ec4bf6dbf353f35,0xbe953f753f35bf35,0x3f223f46be48bf7b,0x3f753e95bf35bf35,0x3f46bf22bf7b3e48
.quad 0xbf553f0e3f80291d,0x3e483f7b3ec4bf6d,0x3f0e3f55291dbf80,0x3f7bbe48bf6dbec4,0xbf7fbdc93f353f35,0xbe953f753f55bf0e,0xbdc93f7f3f35bf35,0x3f753e95bf0ebf55
.quad 0xbf35bf35a88d3f80,0xbf353f353f802880,0xbf353f353f80288d,0x3f353f352880bf80,0xbdc9bf7fbf353f35,0xbf753e953f553f0e,0xbf7f3dc93f353f35,0x3e953f753f0ebf55
.quad 0x3f0ebf55bf802777,0xbf7bbe483ec43f6d,0xbf55bf0e27773f80,0xbe483f7b3f6dbec4,0x3f75be95bf35bf35,0xbf46bf22be483f7b,0xbe95bf75bf353f35,0xbf223f463f7b3e48
.quad 0x3f6d3ec4291abf80,0xbec4bf6dbf353f35,0x3ec4bf6dbf80a91a,0xbf6d3ec43f353f35,0x3ef13f623f35bf35,0x3dc9bf7fbf7b3e48,0x3f62bef1bf35bf35,0xbf7fbdc93e483f7b
.quad 0xbe483f7b3f802889,0x3f0ebf55bf6dbec4,0x3f7b3e482889bf80,0xbf55bf0ebec43f6d,0xbf463f223f353f35,0x3f62bef1bf0ebf55,0x3f223f463f35bf35,0xbef1bf62bf553f0e
.quad 0x278dbf80a8c23f80,0xa754bf80a8843f80,0xbf80a78d3f8028c2,0xbf8027543f802884,0x3e95bf75bec43f6d,0x3dc9bf7fbe483f7b,0xbf75be953f6d3ec4,0xbf7fbdc93f7b3e48
.quad 0x3f0ebf55bf353f35,0x3e48bf7bbec43f6d,0xbf55bf0e3f353f35,0xbf7bbe483f6d3ec4,0x3f46bf22bf6d3ec4,0x3e95bf75bf0e3f55,0xbf22bf463ec43f6d,0xbf75be953f553f0e
.quad 0x3f6dbec4bf80a89a,0x3ec4bf6dbf353f35,0xbec4bf6da89a3f80,0xbf6dbec43f353f35,0x3f7fbdc9bf6dbec4,0x3ef1bf62bf553f0e,0xbdc9bf7fbec43f6d,0xbf62bef13f0e3f55
.quad 0x3f7b3e48bf35bf35,0x3f0ebf55bf6d3ec4,0x3e48bf7bbf353f35,0xbf55bf0e3ec43f6d,0x3f623ef1bec4bf6d,0x3f22bf46bf7b3e48,0x3ef1bf62bf6d3ec4,0xbf46bf223e483f7b
.quad 0x3f353f352865bf80,0x3f35bf35bf80a84b,0x3f35bf35bf80a865,0xbf35bf35a84b3f80,0x3ef13f623ec4bf6d,0x3f46bf22bf7bbe48,0x3f62bef1bf6dbec4,0xbf22bf46be483f7b
.quad 0x3e483f7b3f35bf35,0x3f55bf0ebf6dbec4,0x3f7bbe48bf35bf35,0xbf0ebf55bec43f6d,0xbdc93f7f3f6dbec4,0x3f62bef1bf55bf0e,0x3f7f3dc9bec4bf6d,0xbef1bf62bf0e3f55
.quad 0xbec43f6d3f802926,0x3f6dbec4bf35bf35,0x3f6d3ec42926bf80,0xbec4bf6dbf353f35,0xbf223f463f6d3ec4,0x3f75be95bf0ebf55,0x3f463f223ec4bf6d,0xbe95bf75bf553f0e
.quad 0xbf553f0e3f353f35,0x3f7bbe48bec4bf6d,0x3f0e3f553f35bf35,0xbe48bf7bbf6d3ec4,0xbf753e953ec43f6d,0x3f7fbdc9be48bf7b,0x3e953f753f6dbec4,0xbdc9bf7fbf7b3e48
.quad 0xbf80a55400003f80,0x3f80261f25d4bf80,0xa5543f803f808000,0x261fbf80bf80a5d4,0xbf7f3dc900003f80,0x3f75be95be48bf7b,0x3dc93f7f3f808000,0xbe95bf75bf7b3e48
.quad 0xbf7b3e4800003f80,0x3f55bf0ebec4bf6d,0x3e483f7b3f808000,0xbf0ebf55bf6d3ec4,0xbf753e9500003f80,0x3f22bf46bf0ebf55,0x3e953f753f808000,0xbf46bf22bf553f0e
.quad 0xbf6d3ec400003f80,0x3ec4bf6dbf35bf35,0x3ec43f6d3f808000,0xbf6dbec4bf353f35,0xbf623ef100003f80,0x3dc9bf7fbf55bf0e,0x3ef13f623f808000,0xbf7fbdc9bf0e3f55
.quad 0xbf553f0e00003f80,0xbe48bf7bbf6dbec4,0x3f0e3f553f808000,0xbf7b3e48bec43f6d,0xbf463f2200003f80,0xbef1bf62bf7bbe48,0x3f223f463f808000,0xbf623ef1be483f7b
.quad 0xbf353f3500003f80,0xbf35bf35bf80a5f7,0x3f353f353f808000,0xbf353f35a5f73f80,0xbf223f4600003f80,0xbf62bef1bf7b3e48,0x3f463f223f808000,0xbef13f623e483f7b
.quad 0xbf0e3f5500003f80,0xbf7bbe48bf6d3ec4,0x3f553f0e3f808000,0xbe483f7b3ec43f6d,0xbef13f6200003f80,0xbf7f3dc9bf553f0e,0x3f623ef13f808000,0x3dc93f7f3f0e3f55
.quad 0xbec43f6d00003f80,0xbf6d3ec4bf353f35,0x3f6d3ec43f808000,0x3ec43f6d3f353f35,0xbe953f7500003f80,0xbf463f22bf0e3f55,0x3f753e953f808000,0x3f223f463f553f0e
.quad 0xbe483f7b00003f80,0xbf0e3f55bec43f6d,0x3f7b3e483f808000,0x3f553f0e3f6d3ec4,0xbdc93f7f00003f80,0xbe953f75be483f7b,0x3f7f3dc93f808000,0x3f753e953f7b3e48
.quad 0xbf80a742a6543f80,0x3f80a60d269fbf80,0xa7423f803f802654,0xa60dbf80bf80a69f,0xbf623ef13ec43f6d,0x3f46bf22bf0ebf55,0x3ef13f623f6dbec4,0xbf22bf46bf553f0e
.quad 0xbf0e3f553f353f35,0x3e48bf7bbf6dbec4,0x3f553f0e3f35bf35,0xbf7bbe48bec43f6d,0xbdc93f7f3f6d3ec4,0xbef1bf62bf7b3e48,0x3f7f3dc93ec4bf6d,0xbf623ef13e483f7b
.quad 0x3ec43f6d3f80a68d,0xbf6dbec4bf353f35,0x3f6dbec4a68dbf80,0xbec43f6d3f353f35,0x3f463f223f6dbec4,0xbf753e95be483f7b,0x3f22bf46bec4bf6d,0x3e953f753f7b3e48
.quad 0x3f7b3e483f35bf35,0xbf0e3f553ec43f6d,0x3e48bf7bbf35bf35,0x3f553f0e3f6dbec4,0x3f75be953ec4bf6d,0x3dc93f7f3f553f0e,0xbe95bf75bf6dbec4,0x3f7fbdc93f0ebf55
.quad 0x3f35bf352677bf80,0x3f353f353f80a60d,0xbf35bf35bf80a677,0x3f35bf35a60dbf80,0x3e95bf75bec4bf6d,0x3f7f3dc93f55bf0e,0xbf75be95bf6d3ec4,0x3dc9bf7fbf0ebf55
.quad 0xbe48bf7bbf35bf35,0x3f55bf0e3ec4bf6d,0xbf7b3e48bf353f35,0xbf0ebf55bf6dbec4,0xbf22bf46bf6dbec4,0x3e95bf75be48bf7b,0xbf463f22bec43f6d,0xbf75be95bf7b3e48
.quad 0xbf6dbec4bf80a742,0xbec4bf6dbf35bf35,0xbec43f6da7423f80,0xbf6d3ec4bf353f35,0xbf7f3dc9bf6d3ec4,0xbf62bef1bf7bbe48,0x3dc93f7f3ec43f6d,0xbef13f62be483f7b
.quad 0xbf553f0ebf353f35,0xbf7b3e48bf6d3ec4,0x3f0e3f553f353f35,0x3e483f7b3ec43f6d,0xbef13f62bec43f6d,0xbf223f46bf0e3f55,0x3f623ef13f6d3ec4,0x3f463f223f553f0e
.quad 0xbf80a777a6d43f80,0x3f80258d27c2bf80,0xa7773f803f8026d4,0x258dbf80bf80a7c2,0xbf223f463f353f35,0x3ef1bf62bf55bf0e,0x3f463f223f35bf35,0xbf62bef1bf0e3f55
.quad 0x3e483f7b3f80a58e,0xbf0ebf55bf6d3ec4,0x3f7bbe48a58ebf80,0xbf553f0e3ec43f6d,0x3f623ef13f35bf35,0xbf7f3dc9be483f7b,0x3ef1bf62bf35bf35,0x3dc93f7f3f7b3e48
.quad 0x3f6dbec4a70dbf80,0xbec43f6d3f353f35,0xbec4bf6dbf80270d,0x3f6d3ec43f35bf35,0x3e95bf75bf35bf35,0x3f223f463f7bbe48,0xbf75be95bf353f35,0x3f46bf22be48bf7b
.quad 0xbf0ebf55bf80a777,0x3f7bbe483ec4bf6d,0xbf553f0ea7773f80,0xbe48bf7bbf6dbec4,0xbf7fbdc9bf353f35,0x3e95bf75bf0ebf55,0xbdc93f7f3f353f35,0xbf75be95bf553f0e
.quad 0xbf353f35a6f73f80,0xbf35bf35bf80a78d,0x3f353f353f8026f7,0xbf353f35a78d3f80,0x3dc93f7f3f353f35,0xbf753e95bf0e3f55,0x3f7fbdc93f35bf35,0x3e953f753f553f0e
.quad 0x3f553f0e3f80a137,0xbe483f7b3ec43f6d,0x3f0ebf55a137bf80,0x3f7b3e483f6dbec4,0x3f75be953f35bf35,0x3f463f223f7b3e48,0xbe95bf75bf35bf35,0x3f22bf463e48bf7b
.quad 0x3ec4bf6d27c2bf80,0x3f6dbec43f35bf35,0xbf6dbec4bf80a7c2,0xbec4bf6dbf35bf35,0xbef1bf62bf35bf35,0x3dc9bf7fbe48bf7b,0xbf623ef1bf353f35,0xbf7fbdc9bf7b3e48
.quad 0xbf7bbe48bf80a784,0xbf55bf0ebf6dbec4,0xbe483f7ba7843f80,0xbf0e3f55bec43f6d,0xbf463f22bf353f35,0xbf623ef1bf553f0e,0x3f223f463f353f35,0x3ef13f623f0e3f55
.quad 0xbf80a796a71f3f80,0x3f80268da68dbf80,0xa7963f803f80271f,0x268dbf80bf80268d,0xbe953f753f6d3ec4,0x3dc9bf7fbf7bbe48,0x3f753e953ec4bf6d,0xbf7fbdc9be483f7b
.quad 0x3f553f0e3f35bf35,0xbf7bbe48bec43f6d,0x3f0ebf55bf35bf35,0xbe483f7b3f6d3ec4,0x3f46bf22bec4bf6d,0xbe953f753f553f0e,0xbf22bf46bf6d3ec4,0x3f753e953f0ebf55
.quad 0xbec4bf6dbf802754,0x3f6d3ec43f35bf35,0xbf6d3ec427543f80,0x3ec4bf6dbf35bf35,0xbf7f3dc9bec43f6d,0x3ef1bf62bf0ebf55,0x3dc93f7f3f6d3ec4,0xbf62bef1bf553f0e
.quad 0xbe483f7b3f353f35,0xbf55bf0ebf6d3ec4,0x3f7b3e483f35bf35,0xbf0e3f553ec43f6d,0x3f623ef13f6dbec4,0xbf223f463e483f7b,0x3ef1bf62bec4bf6d,0x3f463f223f7bbe48
.quad 0x3f35bf35a68dbf80,0x3f353f353f802816,0xbf35bf35bf80268d,0x3f35bf352816bf80,0xbef1bf62bf6dbec4,0x3f46bf223e48bf7b,0xbf623ef1bec43f6d,0xbf22bf46bf7bbe48
.quad 0xbf7b3e48bf353f35,0xbf0ebf55bf6dbec4,0x3e483f7b3f353f35,0xbf553f0ebec43f6d,0xbdc93f7f3ec43f6d,0xbf623ef1bf0e3f55,0x3f7f3dc93f6dbec4,0x3ef13f623f553f0e
.quad 0x3f6d3ec43f802889,0x3ec43f6d3f353f35,0x3ec4bf6d2889bf80,0x3f6dbec43f35bf35,0x3f22bf463ec4bf6d,0x3f75be953f55bf0e,0xbf46bf22bf6dbec4,0xbe95bf75bf0ebf55
.quad 0xbf0ebf55bf35bf35,0xbe48bf7bbec4bf6d,0xbf553f0ebf353f35,0xbf7b3e48bf6d3ec4,0xbf753e95bf6d3ec4,0xbf7f3dc9bf7b3e48,0x3e953f753ec43f6d,0x3dc93f7f3e483f7b
.quad 0xbf80a7b1a7543f80,0x3f80281f27f7bf80,0xa7b13f803f802754,0x281fbf80bf80a7f7,0x3dc93f7f3f802816,0xbe95bf75bf7b3e48,0x3f7fbdc92816bf80,0xbf753e953e483f7b
.quad 0x3f7bbe48a60ebf80,0xbf553f0e3ec43f6d,0xbe48bf7bbf80260e,0x3f0e3f553f6dbec4,0xbe95bf75bf80a7b1,0x3f463f223f55bf0e,0xbf753e95a7b13f80,0x3f22bf46bf0ebf55
.quad 0xbf6d3ec4278d3f80,0x3ec4bf6dbf35bf35,0x3ec43f6d3f80a78d,0xbf6dbec4bf353f35,0x3ef13f623f8026d4,0xbf7fbdc9bf0e3f55,0x3f62bef126d4bf80,0xbdc93f7f3f553f0e
.quad 0x3f55bf0e27f7bf80,0x3e483f7b3f6d3ec4,0xbf0ebf55bf80a7f7,0x3f7bbe483ec4bf6d,0xbf22bf46bf80270d,0x3f62bef13e48bf7b,0xbf463f22270d3f80,0xbef1bf62bf7bbe48
.quad 0xbf353f35a7773f80,0xbf35bf35bf8026d4,0x3f353f353f802777,0xbf353f3526d43f80,0x3f463f223f80281f,0xbef13f623e483f7b,0x3f22bf46281fbf80,0x3f623ef13f7bbe48
.quad 0x3f0ebf55a1b7bf80,0x3f7b3e483f6dbec4,0xbf55bf0ebf8021b7,0x3e48bf7bbec4bf6d,0xbf62bef1bf80a7c2,0xbdc9bf7fbf0ebf55,0xbef13f62a7c23f80,0xbf7f3dc9bf553f0e
.quad 0xbec43f6da8423f80,0xbf6d3ec4bf353f35,0x3f6d3ec43f802842,0x3ec43f6d3f353f35,0x3f753e953f80270d,0x3f223f463f553f0e,0x3e95bf75270dbf80,0x3f46bf223f0ebf55
.quad 0x3e48bf7b2804bf80,0x3f0ebf553ec4bf6d,0xbf7bbe48bf80a804,0xbf55bf0ebf6dbec4,0xbf7fbdc9bf8026d4,0xbf75be95bf7bbe48,0xbdc93f7f26d43f80,0xbe953f75be483f7b
.quad 0xbf8026d4a8423f80,0x3f802730260dbf80,0x26d43f803f802842,0x2730bf80bf80a60d,0x3ef13f623f6dbec4,0xbf22bf46bf553f0e,0x3f62bef1bec4bf6d,0xbf463f223f0e3f55
.quad 0x3f0ebf55bf35bf35,0xbe483f7b3f6d3ec4,0xbf55bf0ebf353f35,0x3f7b3e483ec4bf6d,0xbf7fbdc9bec43f6d,0x3f62bef1be48bf7b,0xbdc93f7f3f6d3ec4,0xbef1bf62bf7b3e48
.quad 0x3ec43f6d3f80a7b1,0xbf6dbec4bf353f35,0x3f6dbec4a7b1bf80,0xbec43f6d3f353f35,0x3f22bf46bec4bf6d,0x3e953f753f7b3e48,0xbf46bf22bf6d3ec4,0x3f75be953e48bf7b
.quad 0xbf7bbe48bf353f35,0x3f0ebf55bec4bf6d,0xbe483f7b3f353f35,0xbf55bf0ebf6d3ec4,0x3e953f753f6d3ec4,0xbf7f3dc9bf0e3f55,0x3f75be953ec4bf6d,0x3dc93f7f3f553f0e
.quad 0x3f35bf35280dbf80,0x3f353f353f802754,0xbf35bf35bf80a80d,0x3f35bf352754bf80,0xbf75be95bf6d3ec4,0x3dc9bf7fbf0ebf55,0xbe953f753ec43f6d,0xbf7fbdc9bf553f0e
.quad 0x3e483f7b3f353f35,0xbf553f0ebec43f6d,0x3f7bbe483f35bf35,0x3f0e3f553f6d3ec4,0x3f46bf223ec4bf6d,0x3f753e953f7bbe48,0xbf22bf46bf6dbec4,0x3e95bf75be48bf7b
.quad 0xbf6dbec4bf80a7e5,0xbec4bf6dbf35bf35,0xbec43f6da7e53f80,0xbf6d3ec4bf353f35,0x3dc93f7f3ec43f6d,0xbef13f62be483f7b,0x3f7fbdc93f6dbec4,0x3f623ef13f7b3e48
.quad 0x3f55bf0e3f35bf35,0x3f7bbe483f6dbec4,0xbf0ebf55bf35bf35,0xbe48bf7bbec4bf6d,0xbf62bef1bf6dbec4,0xbf46bf22bf55bf0e,0xbef13f62bec43f6d,0xbf223f46bf0e3f55
.quad 0xbf80a7e5a79f3f80,0x3f8028392816bf80,0xa7e53f803f80279f,0x2839bf80bf80a816,0x3f463f223f35bf35,0xbf62bef1bf0e3f55,0x3f22bf46bf35bf35,0xbef13f623f553f0e
.quad 0xbe48bf7bbf80a7e5,0x3f0e3f553f6dbec4,0xbf7b3e48a7e53f80,0x3f55bf0ebec4bf6d,0xbef13f623f353f35,0xbdc9bf7fbf7bbe48,0x3f623ef13f35bf35,0xbf7f3dc9be483f7b
.quad 0x3f6dbec4a7d4bf80,0xbec43f6d3f353f35,0xbec4bf6dbf8027d4,0x3f6d3ec43f35bf35,0xbf75be95bf353f35,0x3f46bf22be48bf7b,0xbe953f753f353f35,0xbf22bf46bf7b3e48
.quad 0x3f0e3f553f802839,0xbf7b3e48bec43f6d,0x3f55bf0e2839bf80,0x3e483f7b3f6d3ec4,0x3dc9bf7fbf35bf35,0x3f753e953f55bf0e,0xbf7fbdc9bf353f35,0x3e95bf75bf0ebf55
.quad 0xbf353f35270d3f80,0xbf35bf35bf80a804,0x3f353f353f80a70d,0xbf353f35a8043f80,0x3f7fbdc93f35bf35,0x3e953f753f553f0e,0xbdc9bf7fbf35bf35,0x3f75be953f0ebf55
.quad 0xbf55bf0ebf80a880,0x3e48bf7bbec4bf6d,0xbf0e3f55a8803f80,0xbf7bbe48bf6d3ec4,0x3e953f753f353f35,0xbf223f46be483f7b,0x3f75be953f35bf35,0x3f463f223f7b3e48
.quad 0x3ec4bf6d2909bf80,0x3f6dbec43f35bf35,0xbf6dbec4bf80a909,0xbec4bf6dbf35bf35,0xbf623ef1bf353f35,0xbf7fbdc9bf7b3e48,0x3ef13f623f353f35,0xbdc93f7f3e483f7b
.quad 0x3f7b3e483f8028a3,0x3f553f0e3f6d3ec4,0x3e48bf7b28a3bf80,0x3f0ebf553ec4bf6d,0xbf22bf46bf35bf35,0xbef1bf62bf0ebf55,0xbf463f22bf353f35,0xbf623ef1bf553f0e
.quad 0xbf80a880270d3f80,0x3f8028a3270dbf80,0xa8803f803f80a70d,0x28a3bf80bf80a70d,0x3f753e953ec4bf6d,0xbf7fbdc9be483f7b,0x3e95bf75bf6dbec4,0xbdc93f7f3f7b3e48
.quad 0xbf55bf0ebf353f35,0x3f7b3e483ec4bf6d,0xbf0e3f553f353f35,0x3e48bf7bbf6dbec4,0x3f223f463f6dbec4,0xbf75be95bf0e3f55,0x3f46bf22bec4bf6d,0xbe953f753f553f0e
.quad 0xbec4bf6dbf8028be,0x3f6d3ec43f35bf35,0xbf6d3ec428be3f80,0x3ec4bf6dbf35bf35,0x3dc93f7f3f6d3ec4,0xbf62bef1bf553f0e,0x3f7fbdc93ec4bf6d,0xbef13f623f0e3f55
.quad 0x3e48bf7bbf35bf35,0x3f553f0e3f6dbec4,0xbf7bbe48bf353f35,0x3f0ebf55bec4bf6d,0xbef13f623ec43f6d,0xbf46bf22bf7b3e48,0x3f623ef13f6dbec4,0xbf223f463e483f7b
.quad 0x3f35bf352896bf80,0x3f353f353f80a731,0xbf35bf35bf80a896,0x3f35bf35a731bf80,0xbf623ef1bec43f6d,0xbf22bf46bf7bbe48,0x3ef13f623f6d3ec4,0xbf463f22be483f7b
.quad 0x3f7bbe483f35bf35,0x3f0e3f553f6d3ec4,0xbe48bf7bbf35bf35,0x3f55bf0e3ec4bf6d,0xbf7fbdc9bf6d3ec4,0xbef1bf62bf55bf0e,0xbdc93f7f3ec43f6d,0xbf623ef1bf0e3f55
.quad 0x3f6d3ec43f8028ea,0x3ec43f6d3f353f35,0x3ec4bf6d28eabf80,0x3f6dbec43f35bf35,0xbf46bf22bf6dbec4,0xbe95bf75bf0ebf55,0xbf223f46bec43f6d,0xbf753e95bf553f0e
.quad 0x3f0e3f553f353f35,0x3e483f7b3ec43f6d,0x3f55bf0e3f35bf35,0x3f7bbe483f6dbec4,0xbe95bf75bec4bf6d,0xbdc9bf7fbe48bf7b,0xbf753e95bf6d3ec4,0xbf7f3dc9bf7b3e48
.quad 0xbf8027e6a7d43f80,0x3f80a7312831bf80,0x27e63f803f8027d4,0xa731bf80bf80a831,0x3f7fbdc92896bf80,0xbf753e953e483f7b,0xbdc9bf7fbf80a896,0x3e953f753f7bbe48
.quad 0xbf7b3e48268e3f80,0x3f55bf0ebec4bf6d,0x3e483f7b3f80a68e,0xbf0ebf55bf6d3ec4,0x3f75be952831bf80,0xbf223f463f0e3f55,0xbe95bf75bf80a831,0x3f463f223f55bf0e
.quad 0xbf6d3ec4280d3f80,0x3ec4bf6dbf35bf35,0x3ec43f6d3f80a80d,0xbf6dbec4bf353f35,0x3f62bef12754bf80,0xbdc93f7f3f553f0e,0xbef1bf62bf80a754,0x3f7f3dc93f0ebf55
.quad 0xbf553f0ea8773f80,0xbe48bf7bbf6dbec4,0x3f0e3f553f802877,0xbf7b3e48bec43f6d,0x3f46bf22a78dbf80,0x3ef13f623f7b3e48,0xbf22bf46bf80278d,0x3f62bef13e48bf7b
.quad 0xbf353f35a7f73f80,0xbf35bf35bf80a892,0x3f353f353f8027f7,0xbf353f35a8923f80,0x3f22bf46289fbf80,0x3f623ef13f7bbe48,0xbf46bf22bf80a89f,0x3ef1bf62be48bf7b
.quad 0xbf0e3f5522373f80,0xbf7bbe48bf6d3ec4,0x3f553f0e3f80a237,0xbe483f7b3ec43f6d,0x3ef1bf622842bf80,0x3f7fbdc93f55bf0e,0xbf62bef1bf80a842,0xbdc9bf7fbf0ebf55
.quad 0xbec43f6da8c23f80,0xbf6d3ec4bf353f35,0x3f6d3ec43f8028c2,0x3ec43f6d3f353f35,0x3e95bf75278dbf80,0x3f46bf223f0ebf55,0xbf75be95bf80a78d,0xbf22bf46bf55bf0e
.quad 0xbe483f7ba8843f80,0xbf0e3f55bec43f6d,0x3f7b3e483f802884,0x3f553f0e3f6d3ec4,0x3dc9bf7fa754bf80,0x3e95bf753e48bf7b,0xbf7fbdc9bf802754,0xbf75be95bf7bbe48
.quad 0xbf80a6d4a8773f80,0x3f8027c2289fbf80,0xa6d43f803f802877,0x27c2bf80bf80a89f,0x3f62bef1bec4bf6d,0xbf463f223f0e3f55,0xbef1bf62bf6d3ec4,0x3f223f463f55bf0e
.quad 0xbf0e3f553f353f35,0x3e48bf7bbf6dbec4,0x3f553f0e3f35bf35,0xbf7bbe48bec43f6d,0x3dc9bf7fbf6dbec4,0x3ef13f623f7bbe48,0xbf7fbdc9bec43f6d,0x3f62bef1be48bf7b
.quad 0x3ec43f6d3f8027c2,0xbf6dbec4bf353f35,0x3f6dbec427c2bf80,0xbec43f6d3f353f35,0xbf46bf22bf6d3ec4,0x3f75be953e48bf7b,0xbf223f463ec43f6d,0xbe95bf75bf7bbe48
.quad 0x3f7b3e483f35bf35,0xbf0e3f553ec43f6d,0x3e48bf7bbf35bf35,0x3f553f0e3f6dbec4,0xbf753e95bec43f6d,0xbdc9bf7fbf55bf0e,0x3e953f753f6d3ec4,0xbf7f3dc9bf0e3f55
.quad 0x3f35bf35a754bf80,0x3f353f353f8027e5,0xbf35bf35bf802754,0x3f35bf3527e5bf80,0xbe953f753ec43f6d,0xbf7fbdc9bf553f0e,0x3f753e953f6dbec4,0xbdc93f7f3f0e3f55
.quad 0xbe48bf7bbf35bf35,0x3f55bf0e3ec4bf6d,0xbf7b3e48bf353f35,0xbf0ebf55bf6dbec4,0x3f223f463f6d3ec4,0xbe953f753e483f7b,0x3f46bf223ec4bf6d,0x3f753e953f7bbe48
.quad 0xbf6dbec4bf80a89a,0xbec4bf6dbf35bf35,0xbec43f6da89a3f80,0xbf6d3ec4bf353f35,0x3f7fbdc93f6dbec4,0x3f623ef13f7b3e48,0xbdc9bf7fbec4bf6d,0x3ef1bf623e48bf7b
.quad 0xbf553f0ebf353f35,0xbf7b3e48bf6d3ec4,0x3f0e3f553f353f35,0x3e483f7b3ec43f6d,0x3ef1bf623ec4bf6d,0x3f22bf463f0ebf55,0xbf62bef1bf6dbec4,0xbf46bf22bf55bf0e
.quad 0xbf80a828a8c23f80,0x3f80286ea754bf80,0xa8283f803f8028c2,0x286ebf80bf802754,0x3f22bf46bf35bf35,0xbef13f623f553f0e,0xbf46bf22bf353f35,0x3f623ef13f0ebf55
.quad 0x3e483f7b3f80a816,0xbf0ebf55bf6d3ec4,0x3f7bbe48a816bf80,0xbf553f0e3ec43f6d,0xbf62bef1bf353f35,0x3f7fbdc93e48bf7b,0xbef13f623f353f35,0xbdc9bf7fbf7bbe48
.quad 0x3f6dbec4a831bf80,0xbec43f6d3f353f35,0xbec4bf6dbf802831,0x3f6d3ec43f35bf35,0xbe953f753f353f35,0xbf22bf46bf7b3e48,0x3f753e953f35bf35,0xbf463f223e483f7b
.quad 0xbf0ebf55bf80a89a,0x3f7bbe483ec4bf6d,0xbf553f0ea89a3f80,0xbe48bf7bbf6dbec4,0x3f7f3dc93f35bf35,0xbe953f753f0e3f55,0x3dc9bf7fbf35bf35,0x3f753e953f55bf0e
.quad 0xbf353f35a88d3f80,0xbf35bf35bf802777,0x3f353f353f80288d,0xbf353f3527773f80,0xbdc9bf7fbf35bf35,0x3f75be953f0ebf55,0xbf7f3dc9bf353f35,0xbe95bf75bf55bf0e
.quad 0x3f553f0e3f80a880,0xbe483f7b3ec43f6d,0x3f0ebf55a880bf80,0x3f7b3e483f6dbec4,0xbf753e95bf353f35,0xbf46bf22bf7bbe48,0x3e953f753f353f35,0xbf223f46be483f7b
.quad 0x3ec4bf6d2865bf80,0x3f6dbec43f35bf35,0xbf6dbec4bf80a865,0xbec4bf6dbf35bf35,0x3ef13f623f353f35,0xbdc93f7f3e483f7b,0x3f62bef13f35bf35,0x3f7f3dc93f7bbe48
.quad 0xbf7bbe48bf80a84b,0xbf55bf0ebf6dbec4,0xbe483f7ba84b3f80,0xbf0e3f55bec43f6d,0x3f46bf223f35bf35,0x3f62bef13f55bf0e,0xbf22bf46bf35bf35,0xbef1bf62bf0ebf55
.quad 0xbf80a89aa68d3f80,0x3f8028be27b0bf80,0xa89a3f803f80268d,0x28bebf80bf80a7b0,0x3e95bf75bf6dbec4,0xbdc93f7f3f7b3e48,0xbf75be95bec43f6d,0x3f7f3dc93e48bf7b
.quad 0x3f553f0e3f35bf35,0xbf7bbe48bec43f6d,0x3f0ebf55bf35bf35,0xbe483f7b3f6d3ec4,0xbf463f223ec43f6d,0x3e95bf75bf55bf0e,0x3f223f463f6dbec4,0xbf75be95bf0e3f55
.quad 0xbec4bf6dbf8028e1,0x3f6d3ec43f35bf35,0xbf6d3ec428e13f80,0x3ec4bf6dbf35bf35,0x3f7fbdc93ec4bf6d,0xbef13f623f0e3f55,0xbdc9bf7fbf6dbec4,0x3f623ef13f55bf0e
.quad 0xbe483f7b3f353f35,0xbf55bf0ebf6d3ec4,0x3f7b3e483f35bf35,0xbf0e3f553ec43f6d,0xbf62bef1bf6d3ec4,0x3f22bf46be48bf7b,0xbef13f623ec43f6d,0xbf46bf22bf7b3e48
.quad 0x3f35bf3527d4bf80,0x3f353f353f802889,0xbf35bf35bf80a7d4,0x3f35bf352889bf80,0x3ef13f623f6d3ec4,0xbf463f22be483f7b,0x3f62bef13ec4bf6d,0x3f223f463f7b3e48
.quad 0xbf7b3e48bf353f35,0xbf0ebf55bf6dbec4,0x3e483f7b3f353f35,0xbf553f0ebec43f6d,0x3dc9bf7fbec4bf6d,0x3f62bef13f0ebf55,0xbf7fbdc9bf6d3ec4,0xbef1bf62bf55bf0e
.quad 0x3f6d3ec43f802926,0x3ec43f6d3f353f35,0x3ec4bf6d2926bf80,0x3f6dbec43f35bf35,0xbf223f46bec43f6d,0xbf753e95bf553f0e,0x3f463f223f6d3ec4,0x3e953f753f0e3f55
.quad 0xbf0ebf55bf35bf35,0xbe48bf7bbec4bf6d,0xbf553f0ebf353f35,0xbf7b3e48bf6d3ec4,0x3f75be953f6dbec4,0x3f7fbdc93f7bbe48,0xbe95bf75bec4bf6d,0xbdc9bf7fbe48bf7b
.quad 0xbf802777a81f3f80,0x3f80260c2865bf80,0x27773f803f80281f,0x260cbf80bf80a865,0xbdc9bf7fbf80a8e1,0x3e953f753f7bbe48,0xbf7f3dc9a8e13f80,0x3f75be95be48bf7b
.quad 0x3f7bbe482865bf80,0xbf553f0e3ec43f6d,0xbe48bf7bbf80a865,0x3f0e3f553f6dbec4,0x3e953f753f802902,0xbf46bf22bf553f0e,0x3f75be952902bf80,0xbf223f463f0e3f55
.quad 0xbf6d3ec428543f80,0x3ec4bf6dbf35bf35,0x3ec43f6d3f80a854,0xbf6dbec4bf353f35,0xbef1bf62bf80a79f,0x3f7f3dc93f0ebf55,0xbf623ef1a79f3f80,0x3dc9bf7fbf55bf0e
.quad 0x3f55bf0e28b9bf80,0x3e483f7b3f6d3ec4,0xbf0ebf55bf80a8b9,0x3f7bbe483ec4bf6d,0x3f223f463f80a8b5,0xbf623ef1be483f7b,0x3f46bf22a8b5bf80,0x3ef13f623f7b3e48
.quad 0xbf353f35278d3f80,0xbf35bf35bf80a918,0x3f353f353f80a78d,0xbf353f35a9183f80,0xbf46bf22bf80a85d,0x3ef1bf62be48bf7b,0xbf223f46a85d3f80,0xbf62bef1bf7b3e48
.quad 0x3f0ebf552900bf80,0x3f7b3e483f6dbec4,0xbf55bf0ebf80a900,0x3e48bf7bbec4bf6d,0x3f623ef13f80a85d,0x3dc93f7f3f0e3f55,0x3ef1bf62a85dbf80,0x3f7fbdc93f55bf0e
.quad 0xbec43f6da9893f80,0xbf6d3ec4bf353f35,0x3f6d3ec43f802989,0x3ec43f6d3f353f35,0xbf75be95bf80a8b5,0xbf22bf46bf55bf0e,0xbe953f75a8b53f80,0xbf463f22bf0e3f55
.quad 0x3e48bf7b2923bf80,0x3f0ebf553ec4bf6d,0xbf7bbe48bf80a923,0xbf55bf0ebf6dbec4,0x3f7f3dc93f80a79f,0x3f753e953f7b3e48,0x3dc9bf7fa79fbf80,0x3e95bf753e48bf7b
.quad 0xbf80a79fa8963f80,0x3f80292628b9bf80,0xa79f3f803f802896,0x2926bf80bf80a8b9,0xbef1bf62bf6d3ec4,0x3f223f463f55bf0e,0xbf623ef13ec43f6d,0x3f46bf22bf0ebf55
.quad 0x3f0ebf55bf35bf35,0xbe483f7b3f6d3ec4,0xbf55bf0ebf353f35,0x3f7b3e483ec4bf6d,0x3f7f3dc93ec4bf6d,0xbf623ef13e483f7b,0x3dc9bf7fbf6dbec4,0x3ef13f623f7bbe48
.quad 0x3ec43f6d3f8026d3,0xbf6dbec4bf353f35,0x3f6dbec426d3bf80,0xbec43f6d3f353f35,0xbf223f463ec43f6d,0xbe95bf75bf7bbe48,0x3f463f223f6dbec4,0xbf753e95be483f7b
.quad 0xbf7bbe48bf353f35,0x3f0ebf55bec4bf6d,0xbe483f7b3f353f35,0xbf55bf0ebf6d3ec4,0xbe95bf75bf6dbec4,0x3f7fbdc93f0ebf55,0xbf753e95bec43f6d,0xbdc9bf7fbf55bf0e
.quad 0x3f35bf352884bf80,0x3f353f353f80a79f,0xbf35bf35bf80a884,0x3f35bf35a79fbf80,0x3f753e953f6dbec4,0xbdc93f7f3f0e3f55,0x3e95bf75bec4bf6d,0x3f7f3dc93f55bf0e
.quad 0x3e483f7b3f353f35,0xbf553f0ebec43f6d,0x3f7bbe483f35bf35,0x3f0e3f553f6d3ec4,0xbf463f22bec43f6d,0xbf75be95bf7b3e48,0x3f223f463f6d3ec4,0xbe953f753e483f7b
.quad 0xbf6dbec4bf80a8fc,0xbec4bf6dbf35bf35,0xbec43f6da8fc3f80,0xbf6d3ec4bf353f35,0xbdc9bf7fbec4bf6d,0x3ef1bf623e48bf7b,0xbf7f3dc9bf6d3ec4,0xbf62bef1bf7bbe48
.quad 0x3f55bf0e3f35bf35,0x3f7bbe483f6dbec4,0xbf0ebf55bf35bf35,0xbe48bf7bbec4bf6d,0x3f623ef13f6d3ec4,0x3f463f223f553f0e,0x3ef1bf623ec4bf6d,0x3f22bf463f0ebf55
.quad 0xbf80a85d278d3f80,0x3f80a85d2900bf80,0xa85d3f803f80a78d,0xa85dbf80bf80a900,0xbf46bf22bf353f35,0x3f623ef13f0ebf55,0xbf223f463f353f35,0x3ef1bf62bf55bf0e
.quad 0xbe48bf7bbf8028cf,0x3f0e3f553f6dbec4,0xbf7b3e4828cf3f80,0x3f55bf0ebec4bf6d,0x3ef1bf62bf35bf35,0x3dc93f7f3f7b3e48,0xbf62bef1bf353f35,0x3f7fbdc93e48bf7b
.quad 0x3f6dbec4a93ebf80,0xbec43f6d3f353f35,0xbec4bf6dbf80293e,0x3f6d3ec43f35bf35,0x3f753e953f35bf35,0xbf463f223e483f7b,0x3e95bf75bf35bf35,0x3f223f463f7bbe48
.quad 0x3f0e3f553f80296c,0xbf7b3e48bec43f6d,0x3f55bf0e296cbf80,0x3e483f7b3f6d3ec4,0xbdc93f7f3f353f35,0xbf75be95bf553f0e,0x3f7f3dc93f35bf35,0xbe953f753f0e3f55
.quad 0xbf353f35a9163f80,0xbf35bf35bf80a880,0x3f353f353f802916,0xbf353f35a8803f80,0xbf7f3dc9bf353f35,0xbe95bf75bf55bf0e,0x3dc93f7f3f353f35,0xbf753e95bf0e3f55
.quad 0xbf55bf0ebf80a880,0x3e48bf7bbec4bf6d,0xbf0e3f55a8803f80,0xbf7bbe48bf6d3ec4,0xbe95bf75bf35bf35,0x3f22bf463e48bf7b,0xbf753e95bf353f35,0xbf46bf22bf7bbe48
.quad 0x3ec4bf6d296abf80,0x3f6dbec43f35bf35,0xbf6dbec4bf80a96a,0xbec4bf6dbf35bf35,0x3f62bef13f35bf35,0x3f7f3dc93f7bbe48,0xbef1bf62bf35bf35,0x3dc9bf7fbe48bf7b
.quad 0x3f7b3e483f802914,0x3f553f0e3f6d3ec4,0x3e48bf7b2914bf80,0x3f0ebf553ec4bf6d,0x3f223f463f353f35,0x3ef13f623f0e3f55,0x3f46bf223f35bf35,0x3f62bef13f55bf0e
.quad 0xbf80a8b5a78d3f80,0x3f80a79f2923bf80,0xa8b53f803f80278d,0xa79fbf80bf80a923,0xbf75be95bec43f6d,0x3f7f3dc93e48bf7b,0xbe953f753f6d3ec4,0x3dc9bf7fbf7bbe48
.quad 0xbf55bf0ebf353f35,0x3f7b3e483ec4bf6d,0xbf0e3f553f353f35,0x3e48bf7bbf6dbec4,0xbf22bf46bf6d3ec4,0x3f753e953f0ebf55,0xbf463f223ec43f6d,0x3e95bf75bf55bf0e
.quad 0xbec4bf6dbf802902,0x3f6d3ec43f35bf35,0xbf6d3ec429023f80,0x3ec4bf6dbf35bf35,0xbdc9bf7fbf6dbec4,0x3f623ef13f55bf0e,0xbf7f3dc9bec43f6d,0x3ef1bf62bf0ebf55
.quad 0x3e48bf7bbf35bf35,0x3f553f0e3f6dbec4,0xbf7bbe48bf353f35,0x3f0ebf55bec4bf6d,0x3ef1bf62bec4bf6d,0x3f463f223f7bbe48,0xbf62bef1bf6d3ec4,0x3f22bf46be48bf7b
.quad 0x3f35bf35a7b1bf80,0x3f353f353f802914,0xbf35bf35bf8027b1,0x3f35bf352914bf80,0x3f62bef13ec4bf6d,0x3f223f463f7b3e48,0xbef1bf62bf6dbec4,0x3f46bf223e48bf7b
.quad 0x3f7bbe483f35bf35,0x3f0e3f553f6d3ec4,0xbe48bf7bbf35bf35,0x3f55bf0e3ec4bf6d,0x3f7f3dc93f6dbec4,0x3ef13f623f553f0e,0x3dc9bf7fbec4bf6d,0x3f62bef13f0ebf55
.quad 0x3f6d3ec43f8028ac,0x3ec43f6d3f353f35,0x3ec4bf6d28acbf80,0x3f6dbec43f35bf35,0x3f463f223f6d3ec4,0x3e953f753f0e3f55,0x3f22bf463ec4bf6d,0x3f75be953f55bf0e
.quad 0x3f0e3f553f353f35,0x3e483f7b3ec43f6d,0x3f55bf0e3f35bf35,0x3f7bbe483f6dbec4,0x3e953f753ec43f6d,0x3dc93f7f3e483f7b,0x3f75be953f6dbec4,0x3f7fbdc93f7bbe48
```
